```python
import torch

def _softmax(x, axis=-1):
    return torch.softmax(x, dim=axis)
def _gelu(x):
    return torch.nn.functional.gelu(x, approximate="tanh")
def _silu(x):
    return torch.nn.functional.silu(x)
def _sigmoid(x):
    return torch.sigmoid(x)
def _layernorm(x, axis=-1, eps=1e-5):
    m = x.mean(dim=axis, keepdim=True)
    v = x.var(dim=axis, keepdim=True, unbiased=False)
    return (x - m) / torch.sqrt(v + eps)
def _scatter_add(tgt, idx, src, axis=0):
    return tgt.clone().index_add_(axis, idx, src)
def _segment_sum(src, seg, n):
    out = torch.zeros((n,) + src.shape[1:], dtype=src.dtype)
    return out.index_add_(0, seg, src)
def _pad(x, pw):
    flat = tuple(v for pair in reversed(pw) for v in pair)
    return torch.nn.functional.pad(x, flat)

kernel_name = 'standalone__sliding_block_cached__sampling'

def setup_inputs():

    _w = (lambda a: (lambda t: t.to(torch.bfloat16) if t.is_floating_point() else t)(torch.as_tensor(a)))
    B, Sq, D = 32, 32, 512
    Hq, Hkv, Sk, Dh = 32, 8, 2048, 128
    assert Hq % Hkv == 0, (Hq, Hkv)
    return {
        "x": _w((lambda *s: torch.randn(*s, dtype=torch.bfloat16) * 0.8)(B, Sq, D)),
        "k_cache": _w((lambda *s: torch.randn(*s, dtype=torch.bfloat16) * 0.8)(B, Hkv, Sk, Dh)),
        "v_cache": _w((lambda *s: torch.randn(*s, dtype=torch.bfloat16) * 0.05)(B, Hkv, Sk, Dh)),
        "wq": _w((lambda *s: torch.randn(*s, dtype=torch.bfloat16) * 0.8)(D, Hq * Dh) * (D ** -0.5)),
        "wo": _w((lambda *s: torch.randn(*s, dtype=torch.bfloat16) * 0.05)(Hq * Dh, D) * ((Hq * Dh) ** -0.5)),
    }

def reference(x, k_cache, v_cache, wq, wo):
    B, Sq, D = x.shape
    Hq, Dh = 32, 128
    Hkv, Sk = k_cache.shape[1], k_cache.shape[2]
    W = min(4096, max(256, Sk // 4))
    rep = Hq // Hkv
    q = (lambda x, *d: x.permute(*d))((x @ wq).reshape(B, Sq, Hq, Dh), 0, 2, 1, 3)
    k = (lambda x, n, axis: torch.repeat_interleave(x, n, dim=axis))(k_cache[:, :, Sk - W:, :], rep, axis=1)
    v = (lambda x, n, axis: torch.repeat_interleave(x, n, dim=axis))(v_cache[:, :, Sk - W:, :], rep, axis=1)
    scores = torch.einsum("bhqd,bhkd->bhqk", q, k) * (Dh ** -0.5)
    p = _softmax(scores, axis=-1)
    o = torch.einsum("bhqk,bhkd->bhqd", p, v)
    return (lambda x, *d: x.permute(*d))(o, 0, 2, 1, 3).reshape(B, Sq, Hq * Dh) @ wo
```

```asm
; @launch grid=(256,1,1) block=(256,1,1) lds=163840
.amdgcn_target "amdgcn-amd-amdhsa--gfx950"
.text
.globl standalone__sliding_block_cached__sampling_kernel
.p2align 8
.type standalone__sliding_block_cached__sampling_kernel,@function
standalone__sliding_block_cached__sampling_kernel:
    s_cmp_ge_u32 s2, 256
    s_cbranch_scc1 L_end
    s_load_dwordx4 s[44:47], s[0:1], 0
    s_load_dwordx4 s[48:51], s[0:1], 16
    s_load_dwordx4 s[52:55], s[0:1], 32
    s_load_dwordx4 s[56:59], s[0:1], 48
    s_memrealtime s[98:99]
    v_and_b32 v1, 63, v0
    v_lshrrev_b32 v2, 6, v0
    s_nop 0
    v_readfirstlane_b32 s38, v2
    s_lshr_b32 s36, s2, 3
    s_and_b32 s37, s2, 7
    s_and_b32 s39, s36, 15
    s_nop 0
    s_and_b32 s33, s38, 1
    s_lshl_b32 s33, s33, 3
    v_xor_b32 v28, s33, v1
    v_xor_b32 v128, 0, v28
    v_lshlrev_b32 v128, 4, v128
    v_xor_b32 v129, 1, v28
    v_lshlrev_b32 v129, 4, v129
    v_xor_b32 v130, 2, v28
    v_lshlrev_b32 v130, 4, v130
    v_xor_b32 v131, 3, v28
    v_lshlrev_b32 v131, 4, v131
    v_xor_b32 v132, 4, v28
    v_lshlrev_b32 v132, 4, v132
    v_xor_b32 v133, 5, v28
    v_lshlrev_b32 v133, 4, v133
    v_xor_b32 v134, 6, v28
    v_lshlrev_b32 v134, 4, v134
    v_xor_b32 v135, 7, v28
    v_lshlrev_b32 v135, 4, v135
    v_and_b32 v28, 15, v1
    v_lshrrev_b32 v29, 4, v1
    v_xor_b32 v30, v28, v29
    v_lshlrev_b32 v30, 4, v30
    v_lshl_add_u32 v2, v29, 8, v30
    v_xor_b32 v3, 64, v2
    v_xor_b32 v4, 128, v2
    v_xor_b32 v5, 192, v2
    v_lshlrev_b32 v30, 2, v29
    v_xor_b32 v30, v28, v30
    v_lshlrev_b32 v30, 4, v30
    v_lshl_add_u32 v6, v29, 8, v30
    v_lshlrev_b32 v30, 16, v29
    v_lshl_add_u32 v30, v28, 4, v30
    s_lshl_b32 s34, s37, 10
    s_lshl_b32 s35, s38, 8
    s_add_u32 s34, s34, s35
    v_add_u32 v240, s34, v30
    v_add_u32 v241, 8192, v240
    v_add_u32 v242, 16384, v240
    v_add_u32 v243, 24576, v240
    v_add_u32 v244, 32768, v240
    v_add_u32 v245, 40960, v240
    v_add_u32 v246, 49152, v240
    v_add_u32 v247, 57344, v240
    s_lshl_b32 s34, s38, 13
    s_lshl_b32 s43, s38, 12
    v_lshlrev_b32 v7, 4, v1
    s_and_b32 s35, s36, 7
    s_lshr_b32 s35, 170, s35
    s_and_b32 s35, s35, 1
    s_lshl_b32 s33, s2, 19
    s_add_u32 s33, s33, 393216
    s_waitcnt lgkmcnt(0)
    s_add_u32 s46, s46, s33
    s_addc_u32 s47, s47, 0
    s_mov_b32 s12, s46
    s_and_b32 s13, s47, 0xffff
    s_mov_b32 s14, 131072
    s_mov_b32 s15, 0x20000
    s_add_u32 s48, s48, s33
    s_addc_u32 s49, s49, 0
    s_mov_b32 s16, s48
    s_and_b32 s17, s49, 0xffff
    s_mov_b32 s18, 131072
    s_mov_b32 s19, 0x20000
    s_cmp_eq_u32 s35, 1
    s_cbranch_scc1 L_q1
    s_mov_b32 s20, s50
    s_and_b32 s21, s51, 0xffff
    s_mov_b32 s22, 4194304
    s_mov_b32 s23, 0x20000
    s_lshl_b32 s33, s36, 2
    s_add_u32 s33, s33, s38
    s_lshl_b32 s33, s33, 15
    s_lshl_b32 s32, s37, 10
    s_add_u32 s33, s33, s32
    buffer_load_dwordx4 a[128:131], v7, s[20:23], s33 offen
    s_add_u32 s33, s33, 8192
    buffer_load_dwordx4 a[132:135], v7, s[20:23], s33 offen
    s_add_u32 s33, s33, 8192
    buffer_load_dwordx4 a[136:139], v7, s[20:23], s33 offen
    s_add_u32 s33, s33, 8192
    buffer_load_dwordx4 a[140:143], v7, s[20:23], s33 offen
    s_add_u32 m0, s43, 0
    s_add_u32 s47, s43, 0
    buffer_load_dwordx4 v2, s[12:15], s47 offen nt lds
    buffer_load_dwordx4 v3, s[12:15], s47 offen offset:1024 nt lds
    buffer_load_dwordx4 v4, s[12:15], s47 offen offset:2048 nt lds
    buffer_load_dwordx4 v5, s[12:15], s47 offen offset:3072 nt lds
    s_add_u32 m0, s43, 16384
    s_add_u32 s47, s43, 16384
    buffer_load_dwordx4 v2, s[12:15], s47 offen nt lds
    buffer_load_dwordx4 v3, s[12:15], s47 offen offset:1024 nt lds
    buffer_load_dwordx4 v4, s[12:15], s47 offen offset:2048 nt lds
    buffer_load_dwordx4 v5, s[12:15], s47 offen offset:3072 nt lds
    s_add_u32 m0, s43, 49152
    s_add_u32 s47, s43, 0
    buffer_load_dwordx4 v6, s[16:19], s47 offen nt lds
    buffer_load_dwordx4 v6, s[16:19], s47 offen offset:1024 nt lds
    buffer_load_dwordx4 v6, s[16:19], s47 offen offset:2048 nt lds
    buffer_load_dwordx4 v6, s[16:19], s47 offen offset:3072 nt lds
    s_add_u32 m0, s43, 32768
    s_add_u32 s47, s43, 32768
    buffer_load_dwordx4 v2, s[12:15], s47 offen nt lds
    buffer_load_dwordx4 v3, s[12:15], s47 offen offset:1024 nt lds
    buffer_load_dwordx4 v4, s[12:15], s47 offen offset:2048 nt lds
    buffer_load_dwordx4 v5, s[12:15], s47 offen offset:3072 nt lds
    s_lshl_b32 s33, s36, 15
    s_add_u32 s44, s44, s33
    s_addc_u32 s45, s45, 0
    s_mov_b32 s8, s44
    s_and_b32 s9, s45, 0xffff
    s_mov_b32 s10, 32768
    s_mov_b32 s11, 0x20000
    s_add_u32 m0, s34, 131072
    s_add_u32 s32, s34, 0
    buffer_load_dwordx4 v128, s[8:11], s32 offen lds
    buffer_load_dwordx4 v129, s[8:11], s32 offen offset:1024 lds
    buffer_load_dwordx4 v130, s[8:11], s32 offen offset:2048 lds
    buffer_load_dwordx4 v131, s[8:11], s32 offen offset:3072 lds
    s_add_u32 m0, s34, 135168
    s_add_u32 s32, s34, 4096
    buffer_load_dwordx4 v132, s[8:11], s32 offen lds
    buffer_load_dwordx4 v133, s[8:11], s32 offen offset:1024 lds
    buffer_load_dwordx4 v134, s[8:11], s32 offen offset:2048 lds
    buffer_load_dwordx4 v135, s[8:11], s32 offen offset:3072 lds
    s_add_u32 m0, s43, 81920
    s_add_u32 s47, s43, 16384
    buffer_load_dwordx4 v6, s[16:19], s47 offen nt lds
    buffer_load_dwordx4 v6, s[16:19], s47 offen offset:1024 nt lds
    buffer_load_dwordx4 v6, s[16:19], s47 offen offset:2048 nt lds
    buffer_load_dwordx4 v6, s[16:19], s47 offen offset:3072 nt lds
    s_add_u32 m0, s43, 65536
    s_add_u32 s47, s43, 49152
    buffer_load_dwordx4 v2, s[12:15], s47 offen nt lds
    buffer_load_dwordx4 v3, s[12:15], s47 offen offset:1024 nt lds
    buffer_load_dwordx4 v4, s[12:15], s47 offen offset:2048 nt lds
    buffer_load_dwordx4 v5, s[12:15], s47 offen offset:3072 nt lds
    s_add_u32 m0, s43, 114688
    s_add_u32 s47, s43, 32768
    buffer_load_dwordx4 v6, s[16:19], s47 offen nt lds
    buffer_load_dwordx4 v6, s[16:19], s47 offen offset:1024 nt lds
    buffer_load_dwordx4 v6, s[16:19], s47 offen offset:2048 nt lds
    buffer_load_dwordx4 v6, s[16:19], s47 offen offset:3072 nt lds
    s_add_u32 m0, s43, 98304
    s_add_u32 s47, s43, 65536
    buffer_load_dwordx4 v2, s[12:15], s47 offen nt lds
    buffer_load_dwordx4 v3, s[12:15], s47 offen offset:1024 nt lds
    buffer_load_dwordx4 v4, s[12:15], s47 offen offset:2048 nt lds
    buffer_load_dwordx4 v5, s[12:15], s47 offen offset:3072 nt lds
    s_or_b32 s33, s37, s38
    s_or_b32 s98, s98, 1
    s_lshl_b32 s32, s36, 3
    v_mov_b32 v30, s32
    v_mov_b32 v31, s98
    s_cmp_lg_u32 s33, 0
    s_cbranch_scc1 L_nolead1
    s_mov_b64 exec, 1
    global_store_dword v30, v31, s[56:57] sc1
    s_mov_b64 exec, -1
L_nolead1:
    s_lshl_b32 s33, s37, 19
    s_add_u32 s52, s52, s33
    s_addc_u32 s53, s53, 0
    s_mov_b32 s24, s52
    s_and_b32 s25, s53, 0xffff
    s_mov_b32 s26, 524288
    s_mov_b32 s27, 0x20000
    s_lshl_b32 s33, s2, 16
    s_add_u32 s50, s58, s33
    s_addc_u32 s51, s59, 0
    s_mov_b32 s28, s50
    s_and_b32 s29, s51, 0xffff
    s_mov_b32 s30, 65536
    s_mov_b32 s31, 0x20000
    s_mov_b32 s92, s56
    s_mov_b32 s93, s57
    s_mov_b32 s94, s58
    s_mov_b32 s95, s59
    s_mov_b32 s96, s54
    s_mov_b32 s97, s55
    s_getpc_b64 s[32:33]
L_pc1:
    s_sub_u32 s32, s32, L_pc1-standalone__sliding_block_cached__sampling_kernel
    s_subb_u32 s33, s33, 0
    s_and_b32 s50, s36, 7
    s_lshl_b32 s50, s50, 13
    v_lshlrev_b32 v30, 7, v1
    v_add_u32 v30, s50, v30
    v_min_u32 v30, L_code_end-standalone__sliding_block_cached__sampling_kernel-4, v30
    global_load_dword a148, v30, s[32:33]
    s_mov_b32 s40, 0x05040100
    s_mov_b32 s41, 0x07060302
    s_mov_b32 s42, 0x3e0293ee
    s_lshl_b32 s48, s38, 13
    v_lshlrev_b32 v22, 10, v28
    v_lshrrev_b32 v30, 2, v28
    v_lshl_add_u32 v22, v30, 6, v22
    v_and_b32 v30, 3, v28
    v_xor_b32 v30, v30, v29
    v_lshl_add_u32 v22, v30, 4, v22
    v_add_u32 v22, 131072, v22
    v_and_b32 v30, 31, v1
    v_lshrrev_b32 v31, 5, v1
    v_lshlrev_b32 v8, 3, v31
    v_xor_b32 v8, v8, v28
    v_lshlrev_b32 v8, 4, v8
    v_lshl_add_u32 v8, v30, 8, v8
    v_xor_b32 v9, 16, v8
    v_xor_b32 v10, 32, v8
    v_xor_b32 v11, 48, v8
    v_xor_b32 v12, 64, v8
    v_xor_b32 v13, 80, v8
    v_xor_b32 v14, 96, v8
    v_xor_b32 v15, 112, v8
    v_lshrrev_b32 v30, 2, v28
    v_lshl_add_u32 v16, v31, 2, v30
    v_lshlrev_b32 v16, 8, v16
    v_lshl_add_u32 v16, v30, 6, v16
    v_and_b32 v30, 1, v29
    v_lshl_add_u32 v16, v30, 5, v16
    v_and_b32 v30, 2, v28
    v_lshl_add_u32 v16, v30, 3, v16
    v_and_b32 v30, 1, v28
    v_lshl_add_u32 v16, v30, 3, v16
    v_xor_b32 v17, 64, v16
    v_xor_b32 v18, 128, v16
    v_xor_b32 v19, 192, v16
    s_add_u32 s44, s39, 0
    s_and_b32 s44, s44, 15
    s_lshl_b32 s44, s44, 18
    buffer_load_dwordx4 v[32:35], v240, s[20:23], s44 offen
    buffer_load_dwordx4 v[36:39], v241, s[20:23], s44 offen
    buffer_load_dwordx4 v[40:43], v242, s[20:23], s44 offen
    buffer_load_dwordx4 v[44:47], v243, s[20:23], s44 offen
    buffer_load_dwordx4 v[48:51], v244, s[20:23], s44 offen
    buffer_load_dwordx4 v[52:55], v245, s[20:23], s44 offen
    buffer_load_dwordx4 v[56:59], v246, s[20:23], s44 offen
    buffer_load_dwordx4 v[60:63], v247, s[20:23], s44 offen
    s_waitcnt vmcnt(25)
    s_barrier
    s_add_u32 s44, s39, 0
    s_and_b32 s44, s44, 15
    s_lshl_b32 s44, s44, 6
    v_xor_b32 v23, s44, v22
    ds_read_b128 a[0:3], v23
    ds_read_b128 a[4:7], v23 offset:16384
    s_add_u32 s44, s39, 1
    s_and_b32 s44, s44, 15
    s_lshl_b32 s44, s44, 6
    v_xor_b32 v23, s44, v22
    ds_read_b128 a[8:11], v23
    ds_read_b128 a[12:15], v23 offset:16384
    s_add_u32 s44, s39, 2
    s_and_b32 s44, s44, 15
    s_lshl_b32 s44, s44, 6
    v_xor_b32 v23, s44, v22
    ds_read_b128 a[16:19], v23
    ds_read_b128 a[20:23], v23 offset:16384
    s_add_u32 s44, s39, 3
    s_and_b32 s44, s44, 15
    s_lshl_b32 s44, s44, 6
    v_xor_b32 v23, s44, v22
    ds_read_b128 a[24:27], v23
    ds_read_b128 a[28:31], v23 offset:16384
    s_add_u32 s44, s39, 1
    s_and_b32 s44, s44, 15
    s_lshl_b32 s44, s44, 18
    buffer_load_dwordx4 v[64:67], v240, s[20:23], s44 offen
    buffer_load_dwordx4 v[68:71], v241, s[20:23], s44 offen
    buffer_load_dwordx4 v[72:75], v242, s[20:23], s44 offen
    buffer_load_dwordx4 v[76:79], v243, s[20:23], s44 offen
    buffer_load_dwordx4 v[80:83], v244, s[20:23], s44 offen
    buffer_load_dwordx4 v[84:87], v245, s[20:23], s44 offen
    buffer_load_dwordx4 v[88:91], v246, s[20:23], s44 offen
    buffer_load_dwordx4 v[92:95], v247, s[20:23], s44 offen
    s_add_u32 s44, s39, 4
    s_and_b32 s44, s44, 15
    s_lshl_b32 s44, s44, 6
    v_xor_b32 v23, s44, v22
    ds_read_b128 a[32:35], v23
    ds_read_b128 a[36:39], v23 offset:16384
    s_add_u32 s44, s39, 5
    s_and_b32 s44, s44, 15
    s_lshl_b32 s44, s44, 6
    v_xor_b32 v23, s44, v22
    ds_read_b128 a[40:43], v23
    ds_read_b128 a[44:47], v23 offset:16384
    s_add_u32 s44, s39, 6
    s_and_b32 s44, s44, 15
    s_lshl_b32 s44, s44, 6
    v_xor_b32 v23, s44, v22
    ds_read_b128 a[48:51], v23
    ds_read_b128 a[52:55], v23 offset:16384
    s_add_u32 s44, s39, 7
    s_and_b32 s44, s44, 15
    s_lshl_b32 s44, s44, 6
    v_xor_b32 v23, s44, v22
    ds_read_b128 a[56:59], v23
    ds_read_b128 a[60:63], v23 offset:16384
    s_add_u32 s44, s39, 8
    s_and_b32 s44, s44, 15
    s_lshl_b32 s44, s44, 6
    v_xor_b32 v23, s44, v22
    ds_read_b128 a[64:67], v23
    ds_read_b128 a[68:71], v23 offset:16384
    s_add_u32 s44, s39, 9
    s_and_b32 s44, s44, 15
    s_lshl_b32 s44, s44, 6
    v_xor_b32 v23, s44, v22
    ds_read_b128 a[72:75], v23
    ds_read_b128 a[76:79], v23 offset:16384
    s_add_u32 s44, s39, 2
    s_and_b32 s44, s44, 15
    s_lshl_b32 s44, s44, 18
    buffer_load_dwordx4 v[96:99], v240, s[20:23], s44 offen
    buffer_load_dwordx4 v[100:103], v241, s[20:23], s44 offen
    buffer_load_dwordx4 v[104:107], v242, s[20:23], s44 offen
    buffer_load_dwordx4 v[108:111], v243, s[20:23], s44 offen
    buffer_load_dwordx4 v[112:115], v244, s[20:23], s44 offen
    buffer_load_dwordx4 v[116:119], v245, s[20:23], s44 offen
    buffer_load_dwordx4 v[120:123], v246, s[20:23], s44 offen
    buffer_load_dwordx4 v[124:127], v247, s[20:23], s44 offen
    s_add_u32 s44, s39, 10
    s_and_b32 s44, s44, 15
    s_lshl_b32 s44, s44, 6
    v_xor_b32 v23, s44, v22
    ds_read_b128 a[80:83], v23
    ds_read_b128 a[84:87], v23 offset:16384
    s_add_u32 s44, s39, 11
    s_and_b32 s44, s44, 15
    s_lshl_b32 s44, s44, 6
    v_xor_b32 v23, s44, v22
    ds_read_b128 a[88:91], v23
    ds_read_b128 a[92:95], v23 offset:16384
    s_add_u32 s44, s39, 12
    s_and_b32 s44, s44, 15
    s_lshl_b32 s44, s44, 6
    v_xor_b32 v23, s44, v22
    ds_read_b128 a[96:99], v23
    ds_read_b128 a[100:103], v23 offset:16384
    s_add_u32 s44, s39, 13
    s_and_b32 s44, s44, 15
    s_lshl_b32 s44, s44, 6
    v_xor_b32 v23, s44, v22
    ds_read_b128 a[104:107], v23
    ds_read_b128 a[108:111], v23 offset:16384
    s_add_u32 s44, s39, 14
    s_and_b32 s44, s44, 15
    s_lshl_b32 s44, s44, 6
    v_xor_b32 v23, s44, v22
    ds_read_b128 a[112:115], v23
    ds_read_b128 a[116:119], v23 offset:16384
    s_add_u32 s44, s39, 15
    s_and_b32 s44, s44, 15
    s_lshl_b32 s44, s44, 6
    v_xor_b32 v23, s44, v22
    ds_read_b128 a[120:123], v23
    ds_read_b128 a[124:127], v23 offset:16384
    v_lshlrev_b32 v30, 2, v29
    v_xor_b32 v30, v28, v30
    v_lshlrev_b32 v30, 4, v30
    v_lshl_add_u32 v30, v29, 10, v30
    s_lshl_b32 s45, s38, 8
    v_add_u32 v20, s45, v30
    v_add_u32 v21, 3072, v20
    v_add_u32 v22, 6144, v20
    v_add_u32 v23, 9216, v20
    s_waitcnt vmcnt(16)
    s_waitcnt lgkmcnt(15)
    v_perm_b32 v160, v36, v32, s40
    v_perm_b32 v161, v44, v40, s40
    v_perm_b32 v162, v52, v48, s40
    v_perm_b32 v163, v60, v56, s40
    v_perm_b32 v164, v36, v32, s41
    v_perm_b32 v165, v44, v40, s41
    v_mfma_f32_16x16x32_bf16 v[176:179], v[160:163], a[0:3], 0
    v_perm_b32 v166, v52, v48, s41
    v_perm_b32 v167, v60, v56, s41
    v_mfma_f32_16x16x32_bf16 v[180:183], v[160:163], a[4:7], 0
    s_add_u32 s44, s39, 3
    s_and_b32 s44, s44, 15
    s_lshl_b32 s44, s44, 18
    buffer_load_dwordx4 v[128:131], v240, s[20:23], s44 offen
    v_perm_b32 v168, v37, v33, s40
    v_perm_b32 v169, v45, v41, s40
    v_mfma_f32_16x16x32_bf16 v[184:187], v[164:167], a[0:3], 0
    v_perm_b32 v170, v53, v49, s40
    v_perm_b32 v171, v61, v57, s40
    v_mfma_f32_16x16x32_bf16 v[188:191], v[164:167], a[4:7], 0
    buffer_load_dwordx4 v[132:135], v241, s[20:23], s44 offen
    v_perm_b32 v172, v37, v33, s41
    v_perm_b32 v173, v45, v41, s41
    v_mfma_f32_16x16x32_bf16 v[192:195], v[168:171], a[0:3], 0
    v_perm_b32 v174, v53, v49, s41
    v_perm_b32 v175, v61, v57, s41
    v_mfma_f32_16x16x32_bf16 v[196:199], v[168:171], a[4:7], 0
    buffer_load_dwordx4 v[136:139], v242, s[20:23], s44 offen
    v_perm_b32 v160, v38, v34, s40
    v_perm_b32 v161, v46, v42, s40
    v_mfma_f32_16x16x32_bf16 v[200:203], v[172:175], a[0:3], 0
    v_perm_b32 v162, v54, v50, s40
    v_perm_b32 v163, v62, v58, s40
    v_mfma_f32_16x16x32_bf16 v[204:207], v[172:175], a[4:7], 0
    buffer_load_dwordx4 v[140:143], v243, s[20:23], s44 offen
    v_perm_b32 v164, v38, v34, s41
    v_perm_b32 v165, v46, v42, s41
    v_mfma_f32_16x16x32_bf16 v[208:211], v[160:163], a[0:3], 0
    v_perm_b32 v166, v54, v50, s41
    v_perm_b32 v167, v62, v58, s41
    v_mfma_f32_16x16x32_bf16 v[212:215], v[160:163], a[4:7], 0
    buffer_load_dwordx4 v[144:147], v244, s[20:23], s44 offen
    v_perm_b32 v168, v39, v35, s40
    v_perm_b32 v169, v47, v43, s40
    v_mfma_f32_16x16x32_bf16 v[216:219], v[164:167], a[0:3], 0
    v_perm_b32 v170, v55, v51, s40
    v_perm_b32 v171, v63, v59, s40
    v_mfma_f32_16x16x32_bf16 v[220:223], v[164:167], a[4:7], 0
    buffer_load_dwordx4 v[148:151], v245, s[20:23], s44 offen
    v_perm_b32 v172, v39, v35, s41
    v_perm_b32 v173, v47, v43, s41
    v_mfma_f32_16x16x32_bf16 v[224:227], v[168:171], a[0:3], 0
    v_perm_b32 v174, v55, v51, s41
    v_perm_b32 v175, v63, v59, s41
    v_mfma_f32_16x16x32_bf16 v[228:231], v[168:171], a[4:7], 0
    buffer_load_dwordx4 v[152:155], v246, s[20:23], s44 offen
    v_mfma_f32_16x16x32_bf16 v[232:235], v[172:175], a[0:3], 0
    v_mfma_f32_16x16x32_bf16 v[236:239], v[172:175], a[4:7], 0
    buffer_load_dwordx4 v[156:159], v247, s[20:23], s44 offen
    s_waitcnt vmcnt(16)
    v_perm_b32 v160, v68, v64, s40
    v_perm_b32 v161, v76, v72, s40
    v_perm_b32 v162, v84, v80, s40
    v_perm_b32 v163, v92, v88, s40
    v_perm_b32 v164, v68, v64, s41
    v_perm_b32 v165, v76, v72, s41
    v_mfma_f32_16x16x32_bf16 v[176:179], v[160:163], a[8:11], v[176:179]
    v_perm_b32 v166, v84, v80, s41
    v_perm_b32 v167, v92, v88, s41
    v_mfma_f32_16x16x32_bf16 v[180:183], v[160:163], a[12:15], v[180:183]
    s_add_u32 s44, s39, 4
    s_and_b32 s44, s44, 15
    s_lshl_b32 s44, s44, 18
    buffer_load_dwordx4 v[32:35], v240, s[20:23], s44 offen
    v_perm_b32 v168, v69, v65, s40
    v_perm_b32 v169, v77, v73, s40
    v_mfma_f32_16x16x32_bf16 v[184:187], v[164:167], a[8:11], v[184:187]
    v_perm_b32 v170, v85, v81, s40
    v_perm_b32 v171, v93, v89, s40
    v_mfma_f32_16x16x32_bf16 v[188:191], v[164:167], a[12:15], v[188:191]
    buffer_load_dwordx4 v[36:39], v241, s[20:23], s44 offen
    v_perm_b32 v172, v69, v65, s41
    v_perm_b32 v173, v77, v73, s41
    v_mfma_f32_16x16x32_bf16 v[192:195], v[168:171], a[8:11], v[192:195]
    v_perm_b32 v174, v85, v81, s41
    v_perm_b32 v175, v93, v89, s41
    v_mfma_f32_16x16x32_bf16 v[196:199], v[168:171], a[12:15], v[196:199]
    buffer_load_dwordx4 v[40:43], v242, s[20:23], s44 offen
    v_perm_b32 v160, v70, v66, s40
    v_perm_b32 v161, v78, v74, s40
    v_mfma_f32_16x16x32_bf16 v[200:203], v[172:175], a[8:11], v[200:203]
    v_perm_b32 v162, v86, v82, s40
    v_perm_b32 v163, v94, v90, s40
    v_mfma_f32_16x16x32_bf16 v[204:207], v[172:175], a[12:15], v[204:207]
    buffer_load_dwordx4 v[44:47], v243, s[20:23], s44 offen
    v_perm_b32 v164, v70, v66, s41
    v_perm_b32 v165, v78, v74, s41
    v_mfma_f32_16x16x32_bf16 v[208:211], v[160:163], a[8:11], v[208:211]
    v_perm_b32 v166, v86, v82, s41
    v_perm_b32 v167, v94, v90, s41
    v_mfma_f32_16x16x32_bf16 v[212:215], v[160:163], a[12:15], v[212:215]
    buffer_load_dwordx4 v[48:51], v244, s[20:23], s44 offen
    v_perm_b32 v168, v71, v67, s40
    v_perm_b32 v169, v79, v75, s40
    v_mfma_f32_16x16x32_bf16 v[216:219], v[164:167], a[8:11], v[216:219]
    v_perm_b32 v170, v87, v83, s40
    v_perm_b32 v171, v95, v91, s40
    v_mfma_f32_16x16x32_bf16 v[220:223], v[164:167], a[12:15], v[220:223]
    buffer_load_dwordx4 v[52:55], v245, s[20:23], s44 offen
    v_perm_b32 v172, v71, v67, s41
    v_perm_b32 v173, v79, v75, s41
    v_mfma_f32_16x16x32_bf16 v[224:227], v[168:171], a[8:11], v[224:227]
    v_perm_b32 v174, v87, v83, s41
    v_perm_b32 v175, v95, v91, s41
    v_mfma_f32_16x16x32_bf16 v[228:231], v[168:171], a[12:15], v[228:231]
    buffer_load_dwordx4 v[56:59], v246, s[20:23], s44 offen
    v_mfma_f32_16x16x32_bf16 v[232:235], v[172:175], a[8:11], v[232:235]
    v_mfma_f32_16x16x32_bf16 v[236:239], v[172:175], a[12:15], v[236:239]
    buffer_load_dwordx4 v[60:63], v247, s[20:23], s44 offen
    s_waitcnt vmcnt(16)
    v_perm_b32 v160, v100, v96, s40
    v_perm_b32 v161, v108, v104, s40
    v_perm_b32 v162, v116, v112, s40
    v_perm_b32 v163, v124, v120, s40
    v_perm_b32 v164, v100, v96, s41
    v_perm_b32 v165, v108, v104, s41
    v_mfma_f32_16x16x32_bf16 v[176:179], v[160:163], a[16:19], v[176:179]
    v_perm_b32 v166, v116, v112, s41
    v_perm_b32 v167, v124, v120, s41
    v_mfma_f32_16x16x32_bf16 v[180:183], v[160:163], a[20:23], v[180:183]
    s_add_u32 s44, s39, 5
    s_and_b32 s44, s44, 15
    s_lshl_b32 s44, s44, 18
    buffer_load_dwordx4 v[64:67], v240, s[20:23], s44 offen
    v_perm_b32 v168, v101, v97, s40
    v_perm_b32 v169, v109, v105, s40
    v_mfma_f32_16x16x32_bf16 v[184:187], v[164:167], a[16:19], v[184:187]
    v_perm_b32 v170, v117, v113, s40
    v_perm_b32 v171, v125, v121, s40
    v_mfma_f32_16x16x32_bf16 v[188:191], v[164:167], a[20:23], v[188:191]
    buffer_load_dwordx4 v[68:71], v241, s[20:23], s44 offen
    v_perm_b32 v172, v101, v97, s41
    v_perm_b32 v173, v109, v105, s41
    v_mfma_f32_16x16x32_bf16 v[192:195], v[168:171], a[16:19], v[192:195]
    v_perm_b32 v174, v117, v113, s41
    v_perm_b32 v175, v125, v121, s41
    v_mfma_f32_16x16x32_bf16 v[196:199], v[168:171], a[20:23], v[196:199]
    buffer_load_dwordx4 v[72:75], v242, s[20:23], s44 offen
    v_perm_b32 v160, v102, v98, s40
    v_perm_b32 v161, v110, v106, s40
    v_mfma_f32_16x16x32_bf16 v[200:203], v[172:175], a[16:19], v[200:203]
    v_perm_b32 v162, v118, v114, s40
    v_perm_b32 v163, v126, v122, s40
    v_mfma_f32_16x16x32_bf16 v[204:207], v[172:175], a[20:23], v[204:207]
    buffer_load_dwordx4 v[76:79], v243, s[20:23], s44 offen
    v_perm_b32 v164, v102, v98, s41
    v_perm_b32 v165, v110, v106, s41
    v_mfma_f32_16x16x32_bf16 v[208:211], v[160:163], a[16:19], v[208:211]
    v_perm_b32 v166, v118, v114, s41
    v_perm_b32 v167, v126, v122, s41
    v_mfma_f32_16x16x32_bf16 v[212:215], v[160:163], a[20:23], v[212:215]
    buffer_load_dwordx4 v[80:83], v244, s[20:23], s44 offen
    v_perm_b32 v168, v103, v99, s40
    v_perm_b32 v169, v111, v107, s40
    v_mfma_f32_16x16x32_bf16 v[216:219], v[164:167], a[16:19], v[216:219]
    v_perm_b32 v170, v119, v115, s40
    v_perm_b32 v171, v127, v123, s40
    v_mfma_f32_16x16x32_bf16 v[220:223], v[164:167], a[20:23], v[220:223]
    buffer_load_dwordx4 v[84:87], v245, s[20:23], s44 offen
    v_perm_b32 v172, v103, v99, s41
    v_perm_b32 v173, v111, v107, s41
    v_mfma_f32_16x16x32_bf16 v[224:227], v[168:171], a[16:19], v[224:227]
    v_perm_b32 v174, v119, v115, s41
    v_perm_b32 v175, v127, v123, s41
    v_mfma_f32_16x16x32_bf16 v[228:231], v[168:171], a[20:23], v[228:231]
    buffer_load_dwordx4 v[88:91], v246, s[20:23], s44 offen
    v_mfma_f32_16x16x32_bf16 v[232:235], v[172:175], a[16:19], v[232:235]
    v_mfma_f32_16x16x32_bf16 v[236:239], v[172:175], a[20:23], v[236:239]
    buffer_load_dwordx4 v[92:95], v247, s[20:23], s44 offen
    s_waitcnt vmcnt(16)
    v_perm_b32 v160, v132, v128, s40
    v_perm_b32 v161, v140, v136, s40
    v_perm_b32 v162, v148, v144, s40
    v_perm_b32 v163, v156, v152, s40
    v_perm_b32 v164, v132, v128, s41
    v_perm_b32 v165, v140, v136, s41
    v_mfma_f32_16x16x32_bf16 v[176:179], v[160:163], a[24:27], v[176:179]
    v_perm_b32 v166, v148, v144, s41
    v_perm_b32 v167, v156, v152, s41
    v_mfma_f32_16x16x32_bf16 v[180:183], v[160:163], a[28:31], v[180:183]
    s_add_u32 s44, s39, 6
    s_and_b32 s44, s44, 15
    s_lshl_b32 s44, s44, 18
    buffer_load_dwordx4 v[96:99], v240, s[20:23], s44 offen
    v_perm_b32 v168, v133, v129, s40
    v_perm_b32 v169, v141, v137, s40
    v_mfma_f32_16x16x32_bf16 v[184:187], v[164:167], a[24:27], v[184:187]
    v_perm_b32 v170, v149, v145, s40
    v_perm_b32 v171, v157, v153, s40
    v_mfma_f32_16x16x32_bf16 v[188:191], v[164:167], a[28:31], v[188:191]
    buffer_load_dwordx4 v[100:103], v241, s[20:23], s44 offen
    v_perm_b32 v172, v133, v129, s41
    v_perm_b32 v173, v141, v137, s41
    v_mfma_f32_16x16x32_bf16 v[192:195], v[168:171], a[24:27], v[192:195]
    v_perm_b32 v174, v149, v145, s41
    v_perm_b32 v175, v157, v153, s41
    v_mfma_f32_16x16x32_bf16 v[196:199], v[168:171], a[28:31], v[196:199]
    buffer_load_dwordx4 v[104:107], v242, s[20:23], s44 offen
    v_perm_b32 v160, v134, v130, s40
    v_perm_b32 v161, v142, v138, s40
    v_mfma_f32_16x16x32_bf16 v[200:203], v[172:175], a[24:27], v[200:203]
    v_perm_b32 v162, v150, v146, s40
    v_perm_b32 v163, v158, v154, s40
    v_mfma_f32_16x16x32_bf16 v[204:207], v[172:175], a[28:31], v[204:207]
    buffer_load_dwordx4 v[108:111], v243, s[20:23], s44 offen
    v_perm_b32 v164, v134, v130, s41
    v_perm_b32 v165, v142, v138, s41
    v_mfma_f32_16x16x32_bf16 v[208:211], v[160:163], a[24:27], v[208:211]
    v_perm_b32 v166, v150, v146, s41
    v_perm_b32 v167, v158, v154, s41
    v_mfma_f32_16x16x32_bf16 v[212:215], v[160:163], a[28:31], v[212:215]
    buffer_load_dwordx4 v[112:115], v244, s[20:23], s44 offen
    v_perm_b32 v168, v135, v131, s40
    v_perm_b32 v169, v143, v139, s40
    v_mfma_f32_16x16x32_bf16 v[216:219], v[164:167], a[24:27], v[216:219]
    v_perm_b32 v170, v151, v147, s40
    v_perm_b32 v171, v159, v155, s40
    v_mfma_f32_16x16x32_bf16 v[220:223], v[164:167], a[28:31], v[220:223]
    buffer_load_dwordx4 v[116:119], v245, s[20:23], s44 offen
    v_perm_b32 v172, v135, v131, s41
    v_perm_b32 v173, v143, v139, s41
    v_mfma_f32_16x16x32_bf16 v[224:227], v[168:171], a[24:27], v[224:227]
    v_perm_b32 v174, v151, v147, s41
    v_perm_b32 v175, v159, v155, s41
    v_mfma_f32_16x16x32_bf16 v[228:231], v[168:171], a[28:31], v[228:231]
    buffer_load_dwordx4 v[120:123], v246, s[20:23], s44 offen
    v_mfma_f32_16x16x32_bf16 v[232:235], v[172:175], a[24:27], v[232:235]
    v_mfma_f32_16x16x32_bf16 v[236:239], v[172:175], a[28:31], v[236:239]
    buffer_load_dwordx4 v[124:127], v247, s[20:23], s44 offen
    s_waitcnt vmcnt(16)
    v_perm_b32 v160, v36, v32, s40
    v_perm_b32 v161, v44, v40, s40
    v_perm_b32 v162, v52, v48, s40
    v_perm_b32 v163, v60, v56, s40
    v_perm_b32 v164, v36, v32, s41
    v_perm_b32 v165, v44, v40, s41
    v_mfma_f32_16x16x32_bf16 v[176:179], v[160:163], a[32:35], v[176:179]
    v_perm_b32 v166, v52, v48, s41
    v_perm_b32 v167, v60, v56, s41
    v_mfma_f32_16x16x32_bf16 v[180:183], v[160:163], a[36:39], v[180:183]
    s_add_u32 s44, s39, 7
    s_and_b32 s44, s44, 15
    s_lshl_b32 s44, s44, 18
    buffer_load_dwordx4 v[128:131], v240, s[20:23], s44 offen
    v_perm_b32 v168, v37, v33, s40
    v_perm_b32 v169, v45, v41, s40
    v_mfma_f32_16x16x32_bf16 v[184:187], v[164:167], a[32:35], v[184:187]
    v_perm_b32 v170, v53, v49, s40
    v_perm_b32 v171, v61, v57, s40
    v_mfma_f32_16x16x32_bf16 v[188:191], v[164:167], a[36:39], v[188:191]
    buffer_load_dwordx4 v[132:135], v241, s[20:23], s44 offen
    v_perm_b32 v172, v37, v33, s41
    v_perm_b32 v173, v45, v41, s41
    v_mfma_f32_16x16x32_bf16 v[192:195], v[168:171], a[32:35], v[192:195]
    v_perm_b32 v174, v53, v49, s41
    v_perm_b32 v175, v61, v57, s41
    v_mfma_f32_16x16x32_bf16 v[196:199], v[168:171], a[36:39], v[196:199]
    buffer_load_dwordx4 v[136:139], v242, s[20:23], s44 offen
    v_perm_b32 v160, v38, v34, s40
    v_perm_b32 v161, v46, v42, s40
    v_mfma_f32_16x16x32_bf16 v[200:203], v[172:175], a[32:35], v[200:203]
    v_perm_b32 v162, v54, v50, s40
    v_perm_b32 v163, v62, v58, s40
    v_mfma_f32_16x16x32_bf16 v[204:207], v[172:175], a[36:39], v[204:207]
    buffer_load_dwordx4 v[140:143], v243, s[20:23], s44 offen
    v_perm_b32 v164, v38, v34, s41
    v_perm_b32 v165, v46, v42, s41
    v_mfma_f32_16x16x32_bf16 v[208:211], v[160:163], a[32:35], v[208:211]
    v_perm_b32 v166, v54, v50, s41
    v_perm_b32 v167, v62, v58, s41
    v_mfma_f32_16x16x32_bf16 v[212:215], v[160:163], a[36:39], v[212:215]
    buffer_load_dwordx4 v[144:147], v244, s[20:23], s44 offen
    v_perm_b32 v168, v39, v35, s40
    v_perm_b32 v169, v47, v43, s40
    v_mfma_f32_16x16x32_bf16 v[216:219], v[164:167], a[32:35], v[216:219]
    v_perm_b32 v170, v55, v51, s40
    v_perm_b32 v171, v63, v59, s40
    v_mfma_f32_16x16x32_bf16 v[220:223], v[164:167], a[36:39], v[220:223]
    buffer_load_dwordx4 v[148:151], v245, s[20:23], s44 offen
    v_perm_b32 v172, v39, v35, s41
    v_perm_b32 v173, v47, v43, s41
    v_mfma_f32_16x16x32_bf16 v[224:227], v[168:171], a[32:35], v[224:227]
    v_perm_b32 v174, v55, v51, s41
    v_perm_b32 v175, v63, v59, s41
    v_mfma_f32_16x16x32_bf16 v[228:231], v[168:171], a[36:39], v[228:231]
    buffer_load_dwordx4 v[152:155], v246, s[20:23], s44 offen
    v_mfma_f32_16x16x32_bf16 v[232:235], v[172:175], a[32:35], v[232:235]
    v_mfma_f32_16x16x32_bf16 v[236:239], v[172:175], a[36:39], v[236:239]
    buffer_load_dwordx4 v[156:159], v247, s[20:23], s44 offen
    s_waitcnt vmcnt(16)
    v_perm_b32 v160, v68, v64, s40
    v_perm_b32 v161, v76, v72, s40
    v_perm_b32 v162, v84, v80, s40
    v_perm_b32 v163, v92, v88, s40
    v_perm_b32 v164, v68, v64, s41
    v_perm_b32 v165, v76, v72, s41
    v_mfma_f32_16x16x32_bf16 v[176:179], v[160:163], a[40:43], v[176:179]
    v_perm_b32 v166, v84, v80, s41
    v_perm_b32 v167, v92, v88, s41
    v_mfma_f32_16x16x32_bf16 v[180:183], v[160:163], a[44:47], v[180:183]
    s_add_u32 s44, s39, 8
    s_and_b32 s44, s44, 15
    s_lshl_b32 s44, s44, 18
    buffer_load_dwordx4 v[32:35], v240, s[20:23], s44 offen
    v_perm_b32 v168, v69, v65, s40
    v_perm_b32 v169, v77, v73, s40
    v_mfma_f32_16x16x32_bf16 v[184:187], v[164:167], a[40:43], v[184:187]
    v_perm_b32 v170, v85, v81, s40
    v_perm_b32 v171, v93, v89, s40
    v_mfma_f32_16x16x32_bf16 v[188:191], v[164:167], a[44:47], v[188:191]
    buffer_load_dwordx4 v[36:39], v241, s[20:23], s44 offen
    v_perm_b32 v172, v69, v65, s41
    v_perm_b32 v173, v77, v73, s41
    v_mfma_f32_16x16x32_bf16 v[192:195], v[168:171], a[40:43], v[192:195]
    v_perm_b32 v174, v85, v81, s41
    v_perm_b32 v175, v93, v89, s41
    v_mfma_f32_16x16x32_bf16 v[196:199], v[168:171], a[44:47], v[196:199]
    buffer_load_dwordx4 v[40:43], v242, s[20:23], s44 offen
    v_perm_b32 v160, v70, v66, s40
    v_perm_b32 v161, v78, v74, s40
    v_mfma_f32_16x16x32_bf16 v[200:203], v[172:175], a[40:43], v[200:203]
    v_perm_b32 v162, v86, v82, s40
    v_perm_b32 v163, v94, v90, s40
    v_mfma_f32_16x16x32_bf16 v[204:207], v[172:175], a[44:47], v[204:207]
    buffer_load_dwordx4 v[44:47], v243, s[20:23], s44 offen
    v_perm_b32 v164, v70, v66, s41
    v_perm_b32 v165, v78, v74, s41
    v_mfma_f32_16x16x32_bf16 v[208:211], v[160:163], a[40:43], v[208:211]
    v_perm_b32 v166, v86, v82, s41
    v_perm_b32 v167, v94, v90, s41
    v_mfma_f32_16x16x32_bf16 v[212:215], v[160:163], a[44:47], v[212:215]
    buffer_load_dwordx4 v[48:51], v244, s[20:23], s44 offen
    v_perm_b32 v168, v71, v67, s40
    v_perm_b32 v169, v79, v75, s40
    v_mfma_f32_16x16x32_bf16 v[216:219], v[164:167], a[40:43], v[216:219]
    v_perm_b32 v170, v87, v83, s40
    v_perm_b32 v171, v95, v91, s40
    v_mfma_f32_16x16x32_bf16 v[220:223], v[164:167], a[44:47], v[220:223]
    buffer_load_dwordx4 v[52:55], v245, s[20:23], s44 offen
    v_perm_b32 v172, v71, v67, s41
    v_perm_b32 v173, v79, v75, s41
    v_mfma_f32_16x16x32_bf16 v[224:227], v[168:171], a[40:43], v[224:227]
    v_perm_b32 v174, v87, v83, s41
    v_perm_b32 v175, v95, v91, s41
    v_mfma_f32_16x16x32_bf16 v[228:231], v[168:171], a[44:47], v[228:231]
    buffer_load_dwordx4 v[56:59], v246, s[20:23], s44 offen
    v_mfma_f32_16x16x32_bf16 v[232:235], v[172:175], a[40:43], v[232:235]
    v_mfma_f32_16x16x32_bf16 v[236:239], v[172:175], a[44:47], v[236:239]
    buffer_load_dwordx4 v[60:63], v247, s[20:23], s44 offen
    s_waitcnt vmcnt(16)
    v_perm_b32 v160, v100, v96, s40
    v_perm_b32 v161, v108, v104, s40
    v_perm_b32 v162, v116, v112, s40
    v_perm_b32 v163, v124, v120, s40
    v_perm_b32 v164, v100, v96, s41
    v_perm_b32 v165, v108, v104, s41
    v_mfma_f32_16x16x32_bf16 v[176:179], v[160:163], a[48:51], v[176:179]
    v_perm_b32 v166, v116, v112, s41
    v_perm_b32 v167, v124, v120, s41
    v_mfma_f32_16x16x32_bf16 v[180:183], v[160:163], a[52:55], v[180:183]
    s_add_u32 s44, s39, 9
    s_and_b32 s44, s44, 15
    s_lshl_b32 s44, s44, 18
    buffer_load_dwordx4 v[64:67], v240, s[20:23], s44 offen
    v_perm_b32 v168, v101, v97, s40
    v_perm_b32 v169, v109, v105, s40
    v_mfma_f32_16x16x32_bf16 v[184:187], v[164:167], a[48:51], v[184:187]
    v_perm_b32 v170, v117, v113, s40
    v_perm_b32 v171, v125, v121, s40
    v_mfma_f32_16x16x32_bf16 v[188:191], v[164:167], a[52:55], v[188:191]
    buffer_load_dwordx4 v[68:71], v241, s[20:23], s44 offen
    v_perm_b32 v172, v101, v97, s41
    v_perm_b32 v173, v109, v105, s41
    v_mfma_f32_16x16x32_bf16 v[192:195], v[168:171], a[48:51], v[192:195]
    v_perm_b32 v174, v117, v113, s41
    v_perm_b32 v175, v125, v121, s41
    v_mfma_f32_16x16x32_bf16 v[196:199], v[168:171], a[52:55], v[196:199]
    buffer_load_dwordx4 v[72:75], v242, s[20:23], s44 offen
    v_perm_b32 v160, v102, v98, s40
    v_perm_b32 v161, v110, v106, s40
    v_mfma_f32_16x16x32_bf16 v[200:203], v[172:175], a[48:51], v[200:203]
    v_perm_b32 v162, v118, v114, s40
    v_perm_b32 v163, v126, v122, s40
    v_mfma_f32_16x16x32_bf16 v[204:207], v[172:175], a[52:55], v[204:207]
    buffer_load_dwordx4 v[76:79], v243, s[20:23], s44 offen
    v_perm_b32 v164, v102, v98, s41
    v_perm_b32 v165, v110, v106, s41
    v_mfma_f32_16x16x32_bf16 v[208:211], v[160:163], a[48:51], v[208:211]
    v_perm_b32 v166, v118, v114, s41
    v_perm_b32 v167, v126, v122, s41
    v_mfma_f32_16x16x32_bf16 v[212:215], v[160:163], a[52:55], v[212:215]
    buffer_load_dwordx4 v[80:83], v244, s[20:23], s44 offen
    v_perm_b32 v168, v103, v99, s40
    v_perm_b32 v169, v111, v107, s40
    v_mfma_f32_16x16x32_bf16 v[216:219], v[164:167], a[48:51], v[216:219]
    v_perm_b32 v170, v119, v115, s40
    v_perm_b32 v171, v127, v123, s40
    v_mfma_f32_16x16x32_bf16 v[220:223], v[164:167], a[52:55], v[220:223]
    buffer_load_dwordx4 v[84:87], v245, s[20:23], s44 offen
    v_perm_b32 v172, v103, v99, s41
    v_perm_b32 v173, v111, v107, s41
    v_mfma_f32_16x16x32_bf16 v[224:227], v[168:171], a[48:51], v[224:227]
    v_perm_b32 v174, v119, v115, s41
    v_perm_b32 v175, v127, v123, s41
    v_mfma_f32_16x16x32_bf16 v[228:231], v[168:171], a[52:55], v[228:231]
    buffer_load_dwordx4 v[88:91], v246, s[20:23], s44 offen
    v_mfma_f32_16x16x32_bf16 v[232:235], v[172:175], a[48:51], v[232:235]
    v_mfma_f32_16x16x32_bf16 v[236:239], v[172:175], a[52:55], v[236:239]
    buffer_load_dwordx4 v[92:95], v247, s[20:23], s44 offen
    s_waitcnt vmcnt(16)
    v_perm_b32 v160, v132, v128, s40
    v_perm_b32 v161, v140, v136, s40
    v_perm_b32 v162, v148, v144, s40
    v_perm_b32 v163, v156, v152, s40
    v_perm_b32 v164, v132, v128, s41
    v_perm_b32 v165, v140, v136, s41
    v_mfma_f32_16x16x32_bf16 v[176:179], v[160:163], a[56:59], v[176:179]
    v_perm_b32 v166, v148, v144, s41
    v_perm_b32 v167, v156, v152, s41
    v_mfma_f32_16x16x32_bf16 v[180:183], v[160:163], a[60:63], v[180:183]
    s_add_u32 s44, s39, 10
    s_and_b32 s44, s44, 15
    s_lshl_b32 s44, s44, 18
    buffer_load_dwordx4 v[96:99], v240, s[20:23], s44 offen
    v_perm_b32 v168, v133, v129, s40
    v_perm_b32 v169, v141, v137, s40
    v_mfma_f32_16x16x32_bf16 v[184:187], v[164:167], a[56:59], v[184:187]
    v_perm_b32 v170, v149, v145, s40
    v_perm_b32 v171, v157, v153, s40
    v_mfma_f32_16x16x32_bf16 v[188:191], v[164:167], a[60:63], v[188:191]
    buffer_load_dwordx4 v[100:103], v241, s[20:23], s44 offen
    v_perm_b32 v172, v133, v129, s41
    v_perm_b32 v173, v141, v137, s41
    v_mfma_f32_16x16x32_bf16 v[192:195], v[168:171], a[56:59], v[192:195]
    v_perm_b32 v174, v149, v145, s41
    v_perm_b32 v175, v157, v153, s41
    v_mfma_f32_16x16x32_bf16 v[196:199], v[168:171], a[60:63], v[196:199]
    buffer_load_dwordx4 v[104:107], v242, s[20:23], s44 offen
    v_perm_b32 v160, v134, v130, s40
    v_perm_b32 v161, v142, v138, s40
    v_mfma_f32_16x16x32_bf16 v[200:203], v[172:175], a[56:59], v[200:203]
    v_perm_b32 v162, v150, v146, s40
    v_perm_b32 v163, v158, v154, s40
    v_mfma_f32_16x16x32_bf16 v[204:207], v[172:175], a[60:63], v[204:207]
    buffer_load_dwordx4 v[108:111], v243, s[20:23], s44 offen
    v_perm_b32 v164, v134, v130, s41
    v_perm_b32 v165, v142, v138, s41
    v_mfma_f32_16x16x32_bf16 v[208:211], v[160:163], a[56:59], v[208:211]
    v_perm_b32 v166, v150, v146, s41
    v_perm_b32 v167, v158, v154, s41
    v_mfma_f32_16x16x32_bf16 v[212:215], v[160:163], a[60:63], v[212:215]
    buffer_load_dwordx4 v[112:115], v244, s[20:23], s44 offen
    v_perm_b32 v168, v135, v131, s40
    v_perm_b32 v169, v143, v139, s40
    v_mfma_f32_16x16x32_bf16 v[216:219], v[164:167], a[56:59], v[216:219]
    v_perm_b32 v170, v151, v147, s40
    v_perm_b32 v171, v159, v155, s40
    v_mfma_f32_16x16x32_bf16 v[220:223], v[164:167], a[60:63], v[220:223]
    buffer_load_dwordx4 v[116:119], v245, s[20:23], s44 offen
    v_perm_b32 v172, v135, v131, s41
    v_perm_b32 v173, v143, v139, s41
    v_mfma_f32_16x16x32_bf16 v[224:227], v[168:171], a[56:59], v[224:227]
    v_perm_b32 v174, v151, v147, s41
    v_perm_b32 v175, v159, v155, s41
    v_mfma_f32_16x16x32_bf16 v[228:231], v[168:171], a[60:63], v[228:231]
    buffer_load_dwordx4 v[120:123], v246, s[20:23], s44 offen
    v_mfma_f32_16x16x32_bf16 v[232:235], v[172:175], a[56:59], v[232:235]
    v_mfma_f32_16x16x32_bf16 v[236:239], v[172:175], a[60:63], v[236:239]
    buffer_load_dwordx4 v[124:127], v247, s[20:23], s44 offen
    s_waitcnt vmcnt(16)
    s_waitcnt lgkmcnt(14)
    v_perm_b32 v160, v36, v32, s40
    v_perm_b32 v161, v44, v40, s40
    v_perm_b32 v162, v52, v48, s40
    v_perm_b32 v163, v60, v56, s40
    v_perm_b32 v164, v36, v32, s41
    v_perm_b32 v165, v44, v40, s41
    v_mfma_f32_16x16x32_bf16 v[176:179], v[160:163], a[64:67], v[176:179]
    v_perm_b32 v166, v52, v48, s41
    v_perm_b32 v167, v60, v56, s41
    v_mfma_f32_16x16x32_bf16 v[180:183], v[160:163], a[68:71], v[180:183]
    s_add_u32 s44, s39, 11
    s_and_b32 s44, s44, 15
    s_lshl_b32 s44, s44, 18
    buffer_load_dwordx4 v[128:131], v240, s[20:23], s44 offen
    v_perm_b32 v168, v37, v33, s40
    v_perm_b32 v169, v45, v41, s40
    v_mfma_f32_16x16x32_bf16 v[184:187], v[164:167], a[64:67], v[184:187]
    v_perm_b32 v170, v53, v49, s40
    v_perm_b32 v171, v61, v57, s40
    v_mfma_f32_16x16x32_bf16 v[188:191], v[164:167], a[68:71], v[188:191]
    buffer_load_dwordx4 v[132:135], v241, s[20:23], s44 offen
    v_perm_b32 v172, v37, v33, s41
    v_perm_b32 v173, v45, v41, s41
    v_mfma_f32_16x16x32_bf16 v[192:195], v[168:171], a[64:67], v[192:195]
    v_perm_b32 v174, v53, v49, s41
    v_perm_b32 v175, v61, v57, s41
    v_mfma_f32_16x16x32_bf16 v[196:199], v[168:171], a[68:71], v[196:199]
    buffer_load_dwordx4 v[136:139], v242, s[20:23], s44 offen
    v_perm_b32 v160, v38, v34, s40
    v_perm_b32 v161, v46, v42, s40
    v_mfma_f32_16x16x32_bf16 v[200:203], v[172:175], a[64:67], v[200:203]
    v_perm_b32 v162, v54, v50, s40
    v_perm_b32 v163, v62, v58, s40
    v_mfma_f32_16x16x32_bf16 v[204:207], v[172:175], a[68:71], v[204:207]
    buffer_load_dwordx4 v[140:143], v243, s[20:23], s44 offen
    v_perm_b32 v164, v38, v34, s41
    v_perm_b32 v165, v46, v42, s41
    v_mfma_f32_16x16x32_bf16 v[208:211], v[160:163], a[64:67], v[208:211]
    v_perm_b32 v166, v54, v50, s41
    v_perm_b32 v167, v62, v58, s41
    v_mfma_f32_16x16x32_bf16 v[212:215], v[160:163], a[68:71], v[212:215]
    buffer_load_dwordx4 v[144:147], v244, s[20:23], s44 offen
    v_perm_b32 v168, v39, v35, s40
    v_perm_b32 v169, v47, v43, s40
    v_mfma_f32_16x16x32_bf16 v[216:219], v[164:167], a[64:67], v[216:219]
    v_perm_b32 v170, v55, v51, s40
    v_perm_b32 v171, v63, v59, s40
    v_mfma_f32_16x16x32_bf16 v[220:223], v[164:167], a[68:71], v[220:223]
    buffer_load_dwordx4 v[148:151], v245, s[20:23], s44 offen
    v_perm_b32 v172, v39, v35, s41
    v_perm_b32 v173, v47, v43, s41
    v_mfma_f32_16x16x32_bf16 v[224:227], v[168:171], a[64:67], v[224:227]
    v_perm_b32 v174, v55, v51, s41
    v_perm_b32 v175, v63, v59, s41
    v_mfma_f32_16x16x32_bf16 v[228:231], v[168:171], a[68:71], v[228:231]
    buffer_load_dwordx4 v[152:155], v246, s[20:23], s44 offen
    v_mfma_f32_16x16x32_bf16 v[232:235], v[172:175], a[64:67], v[232:235]
    v_mfma_f32_16x16x32_bf16 v[236:239], v[172:175], a[68:71], v[236:239]
    buffer_load_dwordx4 v[156:159], v247, s[20:23], s44 offen
    s_waitcnt vmcnt(16)
    s_waitcnt lgkmcnt(13)
    s_waitcnt lgkmcnt(12)
    v_perm_b32 v160, v68, v64, s40
    v_perm_b32 v161, v76, v72, s40
    v_perm_b32 v162, v84, v80, s40
    v_perm_b32 v163, v92, v88, s40
    v_perm_b32 v164, v68, v64, s41
    v_perm_b32 v165, v76, v72, s41
    v_mfma_f32_16x16x32_bf16 v[176:179], v[160:163], a[72:75], v[176:179]
    v_perm_b32 v166, v84, v80, s41
    v_perm_b32 v167, v92, v88, s41
    v_mfma_f32_16x16x32_bf16 v[180:183], v[160:163], a[76:79], v[180:183]
    s_add_u32 s44, s39, 12
    s_and_b32 s44, s44, 15
    s_lshl_b32 s44, s44, 18
    buffer_load_dwordx4 v[32:35], v240, s[20:23], s44 offen
    v_perm_b32 v168, v69, v65, s40
    v_perm_b32 v169, v77, v73, s40
    v_mfma_f32_16x16x32_bf16 v[184:187], v[164:167], a[72:75], v[184:187]
    v_perm_b32 v170, v85, v81, s40
    v_perm_b32 v171, v93, v89, s40
    v_mfma_f32_16x16x32_bf16 v[188:191], v[164:167], a[76:79], v[188:191]
    buffer_load_dwordx4 v[36:39], v241, s[20:23], s44 offen
    v_perm_b32 v172, v69, v65, s41
    v_perm_b32 v173, v77, v73, s41
    v_mfma_f32_16x16x32_bf16 v[192:195], v[168:171], a[72:75], v[192:195]
    v_perm_b32 v174, v85, v81, s41
    v_perm_b32 v175, v93, v89, s41
    v_mfma_f32_16x16x32_bf16 v[196:199], v[168:171], a[76:79], v[196:199]
    buffer_load_dwordx4 v[40:43], v242, s[20:23], s44 offen
    v_perm_b32 v160, v70, v66, s40
    v_perm_b32 v161, v78, v74, s40
    v_mfma_f32_16x16x32_bf16 v[200:203], v[172:175], a[72:75], v[200:203]
    v_perm_b32 v162, v86, v82, s40
    v_perm_b32 v163, v94, v90, s40
    v_mfma_f32_16x16x32_bf16 v[204:207], v[172:175], a[76:79], v[204:207]
    buffer_load_dwordx4 v[44:47], v243, s[20:23], s44 offen
    v_perm_b32 v164, v70, v66, s41
    v_perm_b32 v165, v78, v74, s41
    v_mfma_f32_16x16x32_bf16 v[208:211], v[160:163], a[72:75], v[208:211]
    v_perm_b32 v166, v86, v82, s41
    v_perm_b32 v167, v94, v90, s41
    v_mfma_f32_16x16x32_bf16 v[212:215], v[160:163], a[76:79], v[212:215]
    buffer_load_dwordx4 v[48:51], v244, s[20:23], s44 offen
    v_perm_b32 v168, v71, v67, s40
    v_perm_b32 v169, v79, v75, s40
    v_mfma_f32_16x16x32_bf16 v[216:219], v[164:167], a[72:75], v[216:219]
    v_perm_b32 v170, v87, v83, s40
    v_perm_b32 v171, v95, v91, s40
    v_mfma_f32_16x16x32_bf16 v[220:223], v[164:167], a[76:79], v[220:223]
    buffer_load_dwordx4 v[52:55], v245, s[20:23], s44 offen
    v_perm_b32 v172, v71, v67, s41
    v_perm_b32 v173, v79, v75, s41
    v_mfma_f32_16x16x32_bf16 v[224:227], v[168:171], a[72:75], v[224:227]
    v_perm_b32 v174, v87, v83, s41
    v_perm_b32 v175, v95, v91, s41
    v_mfma_f32_16x16x32_bf16 v[228:231], v[168:171], a[76:79], v[228:231]
    buffer_load_dwordx4 v[56:59], v246, s[20:23], s44 offen
    v_mfma_f32_16x16x32_bf16 v[232:235], v[172:175], a[72:75], v[232:235]
    v_mfma_f32_16x16x32_bf16 v[236:239], v[172:175], a[76:79], v[236:239]
    buffer_load_dwordx4 v[60:63], v247, s[20:23], s44 offen
    s_waitcnt vmcnt(16)
    s_waitcnt lgkmcnt(11)
    s_waitcnt lgkmcnt(10)
    v_perm_b32 v160, v100, v96, s40
    v_perm_b32 v161, v108, v104, s40
    v_perm_b32 v162, v116, v112, s40
    v_perm_b32 v163, v124, v120, s40
    v_perm_b32 v164, v100, v96, s41
    v_perm_b32 v165, v108, v104, s41
    v_mfma_f32_16x16x32_bf16 v[176:179], v[160:163], a[80:83], v[176:179]
    v_perm_b32 v166, v116, v112, s41
    v_perm_b32 v167, v124, v120, s41
    v_mfma_f32_16x16x32_bf16 v[180:183], v[160:163], a[84:87], v[180:183]
    s_add_u32 s44, s39, 13
    s_and_b32 s44, s44, 15
    s_lshl_b32 s44, s44, 18
    buffer_load_dwordx4 v[64:67], v240, s[20:23], s44 offen
    v_perm_b32 v168, v101, v97, s40
    v_perm_b32 v169, v109, v105, s40
    v_mfma_f32_16x16x32_bf16 v[184:187], v[164:167], a[80:83], v[184:187]
    v_perm_b32 v170, v117, v113, s40
    v_perm_b32 v171, v125, v121, s40
    v_mfma_f32_16x16x32_bf16 v[188:191], v[164:167], a[84:87], v[188:191]
    buffer_load_dwordx4 v[68:71], v241, s[20:23], s44 offen
    v_perm_b32 v172, v101, v97, s41
    v_perm_b32 v173, v109, v105, s41
    v_mfma_f32_16x16x32_bf16 v[192:195], v[168:171], a[80:83], v[192:195]
    v_perm_b32 v174, v117, v113, s41
    v_perm_b32 v175, v125, v121, s41
    v_mfma_f32_16x16x32_bf16 v[196:199], v[168:171], a[84:87], v[196:199]
    buffer_load_dwordx4 v[72:75], v242, s[20:23], s44 offen
    v_perm_b32 v160, v102, v98, s40
    v_perm_b32 v161, v110, v106, s40
    v_mfma_f32_16x16x32_bf16 v[200:203], v[172:175], a[80:83], v[200:203]
    v_perm_b32 v162, v118, v114, s40
    v_perm_b32 v163, v126, v122, s40
    v_mfma_f32_16x16x32_bf16 v[204:207], v[172:175], a[84:87], v[204:207]
    buffer_load_dwordx4 v[76:79], v243, s[20:23], s44 offen
    v_perm_b32 v164, v102, v98, s41
    v_perm_b32 v165, v110, v106, s41
    v_mfma_f32_16x16x32_bf16 v[208:211], v[160:163], a[80:83], v[208:211]
    v_perm_b32 v166, v118, v114, s41
    v_perm_b32 v167, v126, v122, s41
    v_mfma_f32_16x16x32_bf16 v[212:215], v[160:163], a[84:87], v[212:215]
    buffer_load_dwordx4 v[80:83], v244, s[20:23], s44 offen
    v_perm_b32 v168, v103, v99, s40
    v_perm_b32 v169, v111, v107, s40
    v_mfma_f32_16x16x32_bf16 v[216:219], v[164:167], a[80:83], v[216:219]
    v_perm_b32 v170, v119, v115, s40
    v_perm_b32 v171, v127, v123, s40
    v_mfma_f32_16x16x32_bf16 v[220:223], v[164:167], a[84:87], v[220:223]
    buffer_load_dwordx4 v[84:87], v245, s[20:23], s44 offen
    v_perm_b32 v172, v103, v99, s41
    v_perm_b32 v173, v111, v107, s41
    v_mfma_f32_16x16x32_bf16 v[224:227], v[168:171], a[80:83], v[224:227]
    v_perm_b32 v174, v119, v115, s41
    v_perm_b32 v175, v127, v123, s41
    v_mfma_f32_16x16x32_bf16 v[228:231], v[168:171], a[84:87], v[228:231]
    buffer_load_dwordx4 v[88:91], v246, s[20:23], s44 offen
    v_mfma_f32_16x16x32_bf16 v[232:235], v[172:175], a[80:83], v[232:235]
    v_mfma_f32_16x16x32_bf16 v[236:239], v[172:175], a[84:87], v[236:239]
    buffer_load_dwordx4 v[92:95], v247, s[20:23], s44 offen
    s_waitcnt vmcnt(16)
    s_waitcnt lgkmcnt(9)
    s_waitcnt lgkmcnt(8)
    v_perm_b32 v160, v132, v128, s40
    v_perm_b32 v161, v140, v136, s40
    v_perm_b32 v162, v148, v144, s40
    v_perm_b32 v163, v156, v152, s40
    v_perm_b32 v164, v132, v128, s41
    v_perm_b32 v165, v140, v136, s41
    v_mfma_f32_16x16x32_bf16 v[176:179], v[160:163], a[88:91], v[176:179]
    v_perm_b32 v166, v148, v144, s41
    v_perm_b32 v167, v156, v152, s41
    v_mfma_f32_16x16x32_bf16 v[180:183], v[160:163], a[92:95], v[180:183]
    s_add_u32 s44, s39, 14
    s_and_b32 s44, s44, 15
    s_lshl_b32 s44, s44, 18
    buffer_load_dwordx4 v[96:99], v240, s[20:23], s44 offen
    v_perm_b32 v168, v133, v129, s40
    v_perm_b32 v169, v141, v137, s40
    v_mfma_f32_16x16x32_bf16 v[184:187], v[164:167], a[88:91], v[184:187]
    v_perm_b32 v170, v149, v145, s40
    v_perm_b32 v171, v157, v153, s40
    v_mfma_f32_16x16x32_bf16 v[188:191], v[164:167], a[92:95], v[188:191]
    buffer_load_dwordx4 v[100:103], v241, s[20:23], s44 offen
    v_perm_b32 v172, v133, v129, s41
    v_perm_b32 v173, v141, v137, s41
    v_mfma_f32_16x16x32_bf16 v[192:195], v[168:171], a[88:91], v[192:195]
    v_perm_b32 v174, v149, v145, s41
    v_perm_b32 v175, v157, v153, s41
    v_mfma_f32_16x16x32_bf16 v[196:199], v[168:171], a[92:95], v[196:199]
    buffer_load_dwordx4 v[104:107], v242, s[20:23], s44 offen
    v_perm_b32 v160, v134, v130, s40
    v_perm_b32 v161, v142, v138, s40
    v_mfma_f32_16x16x32_bf16 v[200:203], v[172:175], a[88:91], v[200:203]
    v_perm_b32 v162, v150, v146, s40
    v_perm_b32 v163, v158, v154, s40
    v_mfma_f32_16x16x32_bf16 v[204:207], v[172:175], a[92:95], v[204:207]
    buffer_load_dwordx4 v[108:111], v243, s[20:23], s44 offen
    v_perm_b32 v164, v134, v130, s41
    v_perm_b32 v165, v142, v138, s41
    v_mfma_f32_16x16x32_bf16 v[208:211], v[160:163], a[88:91], v[208:211]
    v_perm_b32 v166, v150, v146, s41
    v_perm_b32 v167, v158, v154, s41
    v_mfma_f32_16x16x32_bf16 v[212:215], v[160:163], a[92:95], v[212:215]
    buffer_load_dwordx4 v[112:115], v244, s[20:23], s44 offen
    v_perm_b32 v168, v135, v131, s40
    v_perm_b32 v169, v143, v139, s40
    v_mfma_f32_16x16x32_bf16 v[216:219], v[164:167], a[88:91], v[216:219]
    v_perm_b32 v170, v151, v147, s40
    v_perm_b32 v171, v159, v155, s40
    v_mfma_f32_16x16x32_bf16 v[220:223], v[164:167], a[92:95], v[220:223]
    buffer_load_dwordx4 v[116:119], v245, s[20:23], s44 offen
    v_perm_b32 v172, v135, v131, s41
    v_perm_b32 v173, v143, v139, s41
    v_mfma_f32_16x16x32_bf16 v[224:227], v[168:171], a[88:91], v[224:227]
    v_perm_b32 v174, v151, v147, s41
    v_perm_b32 v175, v159, v155, s41
    v_mfma_f32_16x16x32_bf16 v[228:231], v[168:171], a[92:95], v[228:231]
    buffer_load_dwordx4 v[120:123], v246, s[20:23], s44 offen
    v_mfma_f32_16x16x32_bf16 v[232:235], v[172:175], a[88:91], v[232:235]
    v_mfma_f32_16x16x32_bf16 v[236:239], v[172:175], a[92:95], v[236:239]
    buffer_load_dwordx4 v[124:127], v247, s[20:23], s44 offen
    s_waitcnt vmcnt(16)
    s_waitcnt lgkmcnt(7)
    s_waitcnt lgkmcnt(6)
    v_perm_b32 v160, v36, v32, s40
    v_perm_b32 v161, v44, v40, s40
    v_perm_b32 v162, v52, v48, s40
    v_perm_b32 v163, v60, v56, s40
    v_perm_b32 v164, v36, v32, s41
    v_perm_b32 v165, v44, v40, s41
    v_mfma_f32_16x16x32_bf16 v[176:179], v[160:163], a[96:99], v[176:179]
    v_perm_b32 v166, v52, v48, s41
    v_perm_b32 v167, v60, v56, s41
    v_mfma_f32_16x16x32_bf16 v[180:183], v[160:163], a[100:103], v[180:183]
    s_add_u32 s44, s39, 15
    s_and_b32 s44, s44, 15
    s_lshl_b32 s44, s44, 18
    buffer_load_dwordx4 v[128:131], v240, s[20:23], s44 offen
    v_perm_b32 v168, v37, v33, s40
    v_perm_b32 v169, v45, v41, s40
    v_mfma_f32_16x16x32_bf16 v[184:187], v[164:167], a[96:99], v[184:187]
    v_perm_b32 v170, v53, v49, s40
    v_perm_b32 v171, v61, v57, s40
    v_mfma_f32_16x16x32_bf16 v[188:191], v[164:167], a[100:103], v[188:191]
    buffer_load_dwordx4 v[132:135], v241, s[20:23], s44 offen
    v_perm_b32 v172, v37, v33, s41
    v_perm_b32 v173, v45, v41, s41
    v_mfma_f32_16x16x32_bf16 v[192:195], v[168:171], a[96:99], v[192:195]
    v_perm_b32 v174, v53, v49, s41
    v_perm_b32 v175, v61, v57, s41
    v_mfma_f32_16x16x32_bf16 v[196:199], v[168:171], a[100:103], v[196:199]
    buffer_load_dwordx4 v[136:139], v242, s[20:23], s44 offen
    v_perm_b32 v160, v38, v34, s40
    v_perm_b32 v161, v46, v42, s40
    v_mfma_f32_16x16x32_bf16 v[200:203], v[172:175], a[96:99], v[200:203]
    v_perm_b32 v162, v54, v50, s40
    v_perm_b32 v163, v62, v58, s40
    v_mfma_f32_16x16x32_bf16 v[204:207], v[172:175], a[100:103], v[204:207]
    buffer_load_dwordx4 v[140:143], v243, s[20:23], s44 offen
    v_perm_b32 v164, v38, v34, s41
    v_perm_b32 v165, v46, v42, s41
    v_mfma_f32_16x16x32_bf16 v[208:211], v[160:163], a[96:99], v[208:211]
    v_perm_b32 v166, v54, v50, s41
    v_perm_b32 v167, v62, v58, s41
    v_mfma_f32_16x16x32_bf16 v[212:215], v[160:163], a[100:103], v[212:215]
    buffer_load_dwordx4 v[144:147], v244, s[20:23], s44 offen
    v_perm_b32 v168, v39, v35, s40
    v_perm_b32 v169, v47, v43, s40
    v_mfma_f32_16x16x32_bf16 v[216:219], v[164:167], a[96:99], v[216:219]
    v_perm_b32 v170, v55, v51, s40
    v_perm_b32 v171, v63, v59, s40
    v_mfma_f32_16x16x32_bf16 v[220:223], v[164:167], a[100:103], v[220:223]
    buffer_load_dwordx4 v[148:151], v245, s[20:23], s44 offen
    v_perm_b32 v172, v39, v35, s41
    v_perm_b32 v173, v47, v43, s41
    v_mfma_f32_16x16x32_bf16 v[224:227], v[168:171], a[96:99], v[224:227]
    v_perm_b32 v174, v55, v51, s41
    v_perm_b32 v175, v63, v59, s41
    v_mfma_f32_16x16x32_bf16 v[228:231], v[168:171], a[100:103], v[228:231]
    buffer_load_dwordx4 v[152:155], v246, s[20:23], s44 offen
    v_mfma_f32_16x16x32_bf16 v[232:235], v[172:175], a[96:99], v[232:235]
    v_mfma_f32_16x16x32_bf16 v[236:239], v[172:175], a[100:103], v[236:239]
    buffer_load_dwordx4 v[156:159], v247, s[20:23], s44 offen
    s_waitcnt vmcnt(16)
    s_waitcnt lgkmcnt(5)
    s_waitcnt lgkmcnt(4)
    v_perm_b32 v160, v68, v64, s40
    v_perm_b32 v161, v76, v72, s40
    v_perm_b32 v162, v84, v80, s40
    v_perm_b32 v163, v92, v88, s40
    v_perm_b32 v164, v68, v64, s41
    v_perm_b32 v165, v76, v72, s41
    v_mfma_f32_16x16x32_bf16 v[176:179], v[160:163], a[104:107], v[176:179]
    v_perm_b32 v166, v84, v80, s41
    v_perm_b32 v167, v92, v88, s41
    v_mfma_f32_16x16x32_bf16 v[180:183], v[160:163], a[108:111], v[180:183]
    v_perm_b32 v168, v69, v65, s40
    v_perm_b32 v169, v77, v73, s40
    v_mfma_f32_16x16x32_bf16 v[184:187], v[164:167], a[104:107], v[184:187]
    v_perm_b32 v170, v85, v81, s40
    v_perm_b32 v171, v93, v89, s40
    v_mfma_f32_16x16x32_bf16 v[188:191], v[164:167], a[108:111], v[188:191]
    v_perm_b32 v172, v69, v65, s41
    v_perm_b32 v173, v77, v73, s41
    v_mfma_f32_16x16x32_bf16 v[192:195], v[168:171], a[104:107], v[192:195]
    v_perm_b32 v174, v85, v81, s41
    v_perm_b32 v175, v93, v89, s41
    v_mfma_f32_16x16x32_bf16 v[196:199], v[168:171], a[108:111], v[196:199]
    v_perm_b32 v160, v70, v66, s40
    v_perm_b32 v161, v78, v74, s40
    v_mfma_f32_16x16x32_bf16 v[200:203], v[172:175], a[104:107], v[200:203]
    v_perm_b32 v162, v86, v82, s40
    v_perm_b32 v163, v94, v90, s40
    v_mfma_f32_16x16x32_bf16 v[204:207], v[172:175], a[108:111], v[204:207]
    v_perm_b32 v164, v70, v66, s41
    v_perm_b32 v165, v78, v74, s41
    v_mfma_f32_16x16x32_bf16 v[208:211], v[160:163], a[104:107], v[208:211]
    v_perm_b32 v166, v86, v82, s41
    v_perm_b32 v167, v94, v90, s41
    v_mfma_f32_16x16x32_bf16 v[212:215], v[160:163], a[108:111], v[212:215]
    v_perm_b32 v168, v71, v67, s40
    v_perm_b32 v169, v79, v75, s40
    v_mfma_f32_16x16x32_bf16 v[216:219], v[164:167], a[104:107], v[216:219]
    v_perm_b32 v170, v87, v83, s40
    v_perm_b32 v171, v95, v91, s40
    v_mfma_f32_16x16x32_bf16 v[220:223], v[164:167], a[108:111], v[220:223]
    v_perm_b32 v172, v71, v67, s41
    v_perm_b32 v173, v79, v75, s41
    v_mfma_f32_16x16x32_bf16 v[224:227], v[168:171], a[104:107], v[224:227]
    v_perm_b32 v174, v87, v83, s41
    v_perm_b32 v175, v95, v91, s41
    v_mfma_f32_16x16x32_bf16 v[228:231], v[168:171], a[108:111], v[228:231]
    s_nop 0
    v_mfma_f32_16x16x32_bf16 v[232:235], v[172:175], a[104:107], v[232:235]
    v_mfma_f32_16x16x32_bf16 v[236:239], v[172:175], a[108:111], v[236:239]
    s_waitcnt vmcnt(8)
    s_waitcnt lgkmcnt(3)
    s_waitcnt lgkmcnt(2)
    v_perm_b32 v160, v100, v96, s40
    v_perm_b32 v161, v108, v104, s40
    v_perm_b32 v162, v116, v112, s40
    v_perm_b32 v163, v124, v120, s40
    v_perm_b32 v164, v100, v96, s41
    v_perm_b32 v165, v108, v104, s41
    v_mfma_f32_16x16x32_bf16 v[176:179], v[160:163], a[112:115], v[176:179]
    v_perm_b32 v166, v116, v112, s41
    v_perm_b32 v167, v124, v120, s41
    v_mfma_f32_16x16x32_bf16 v[180:183], v[160:163], a[116:119], v[180:183]
    v_perm_b32 v168, v101, v97, s40
    v_perm_b32 v169, v109, v105, s40
    v_mfma_f32_16x16x32_bf16 v[184:187], v[164:167], a[112:115], v[184:187]
    v_perm_b32 v170, v117, v113, s40
    v_perm_b32 v171, v125, v121, s40
    v_mfma_f32_16x16x32_bf16 v[188:191], v[164:167], a[116:119], v[188:191]
    v_perm_b32 v172, v101, v97, s41
    v_perm_b32 v173, v109, v105, s41
    v_mfma_f32_16x16x32_bf16 v[192:195], v[168:171], a[112:115], v[192:195]
    v_perm_b32 v174, v117, v113, s41
    v_perm_b32 v175, v125, v121, s41
    v_mfma_f32_16x16x32_bf16 v[196:199], v[168:171], a[116:119], v[196:199]
    v_perm_b32 v160, v102, v98, s40
    v_perm_b32 v161, v110, v106, s40
    v_mfma_f32_16x16x32_bf16 v[200:203], v[172:175], a[112:115], v[200:203]
    v_perm_b32 v162, v118, v114, s40
    v_perm_b32 v163, v126, v122, s40
    v_mfma_f32_16x16x32_bf16 v[204:207], v[172:175], a[116:119], v[204:207]
    v_perm_b32 v164, v102, v98, s41
    v_perm_b32 v165, v110, v106, s41
    v_mfma_f32_16x16x32_bf16 v[208:211], v[160:163], a[112:115], v[208:211]
    v_perm_b32 v166, v118, v114, s41
    v_perm_b32 v167, v126, v122, s41
    v_mfma_f32_16x16x32_bf16 v[212:215], v[160:163], a[116:119], v[212:215]
    v_perm_b32 v168, v103, v99, s40
    v_perm_b32 v169, v111, v107, s40
    v_mfma_f32_16x16x32_bf16 v[216:219], v[164:167], a[112:115], v[216:219]
    v_perm_b32 v170, v119, v115, s40
    v_perm_b32 v171, v127, v123, s40
    v_mfma_f32_16x16x32_bf16 v[220:223], v[164:167], a[116:119], v[220:223]
    v_perm_b32 v172, v103, v99, s41
    v_perm_b32 v173, v111, v107, s41
    v_mfma_f32_16x16x32_bf16 v[224:227], v[168:171], a[112:115], v[224:227]
    v_perm_b32 v174, v119, v115, s41
    v_perm_b32 v175, v127, v123, s41
    v_mfma_f32_16x16x32_bf16 v[228:231], v[168:171], a[116:119], v[228:231]
    s_nop 0
    v_mfma_f32_16x16x32_bf16 v[232:235], v[172:175], a[112:115], v[232:235]
    v_mfma_f32_16x16x32_bf16 v[236:239], v[172:175], a[116:119], v[236:239]
    s_waitcnt vmcnt(0)
    s_waitcnt lgkmcnt(1)
    s_waitcnt lgkmcnt(0)
    v_perm_b32 v160, v132, v128, s40
    v_perm_b32 v161, v140, v136, s40
    v_perm_b32 v162, v148, v144, s40
    v_perm_b32 v163, v156, v152, s40
    v_perm_b32 v164, v132, v128, s41
    v_perm_b32 v165, v140, v136, s41
    v_mfma_f32_16x16x32_bf16 v[176:179], v[160:163], a[120:123], v[176:179]
    v_perm_b32 v166, v148, v144, s41
    v_perm_b32 v167, v156, v152, s41
    v_mfma_f32_16x16x32_bf16 v[180:183], v[160:163], a[124:127], v[180:183]
    v_perm_b32 v168, v133, v129, s40
    v_perm_b32 v169, v141, v137, s40
    v_mfma_f32_16x16x32_bf16 v[184:187], v[164:167], a[120:123], v[184:187]
    v_perm_b32 v170, v149, v145, s40
    v_perm_b32 v171, v157, v153, s40
    v_mfma_f32_16x16x32_bf16 v[188:191], v[164:167], a[124:127], v[188:191]
    v_perm_b32 v172, v133, v129, s41
    v_perm_b32 v173, v141, v137, s41
    v_mfma_f32_16x16x32_bf16 v[192:195], v[168:171], a[120:123], v[192:195]
    v_perm_b32 v174, v149, v145, s41
    v_perm_b32 v175, v157, v153, s41
    v_mfma_f32_16x16x32_bf16 v[196:199], v[168:171], a[124:127], v[196:199]
    v_perm_b32 v160, v134, v130, s40
    v_perm_b32 v161, v142, v138, s40
    v_mfma_f32_16x16x32_bf16 v[200:203], v[172:175], a[120:123], v[200:203]
    v_perm_b32 v162, v150, v146, s40
    v_perm_b32 v163, v158, v154, s40
    v_mfma_f32_16x16x32_bf16 v[204:207], v[172:175], a[124:127], v[204:207]
    v_perm_b32 v164, v134, v130, s41
    v_perm_b32 v165, v142, v138, s41
    v_mfma_f32_16x16x32_bf16 v[208:211], v[160:163], a[120:123], v[208:211]
    v_perm_b32 v166, v150, v146, s41
    v_perm_b32 v167, v158, v154, s41
    v_mfma_f32_16x16x32_bf16 v[212:215], v[160:163], a[124:127], v[212:215]
    v_perm_b32 v168, v135, v131, s40
    v_perm_b32 v169, v143, v139, s40
    v_mfma_f32_16x16x32_bf16 v[216:219], v[164:167], a[120:123], v[216:219]
    v_perm_b32 v170, v151, v147, s40
    v_perm_b32 v171, v159, v155, s40
    v_mfma_f32_16x16x32_bf16 v[220:223], v[164:167], a[124:127], v[220:223]
    v_perm_b32 v172, v135, v131, s41
    v_perm_b32 v173, v143, v139, s41
    v_mfma_f32_16x16x32_bf16 v[224:227], v[168:171], a[120:123], v[224:227]
    v_perm_b32 v174, v151, v147, s41
    v_perm_b32 v175, v159, v155, s41
    v_mfma_f32_16x16x32_bf16 v[228:231], v[168:171], a[124:127], v[228:231]
    s_nop 0
    v_mfma_f32_16x16x32_bf16 v[232:235], v[172:175], a[120:123], v[232:235]
    v_mfma_f32_16x16x32_bf16 v[236:239], v[172:175], a[124:127], v[236:239]
    v_mul_f32 v176, s42, v176
    v_mul_f32 v177, s42, v177
    v_mul_f32 v178, s42, v178
    v_mul_f32 v179, s42, v179
    v_mul_f32 v180, s42, v180
    v_mul_f32 v181, s42, v181
    v_mul_f32 v182, s42, v182
    v_mul_f32 v183, s42, v183
    v_mul_f32 v184, s42, v184
    v_mul_f32 v185, s42, v185
    v_mul_f32 v186, s42, v186
    v_mul_f32 v187, s42, v187
    v_mul_f32 v188, s42, v188
    v_mul_f32 v189, s42, v189
    v_mul_f32 v190, s42, v190
    v_mul_f32 v191, s42, v191
    v_mul_f32 v192, s42, v192
    v_mul_f32 v193, s42, v193
    v_mul_f32 v194, s42, v194
    v_mul_f32 v195, s42, v195
    v_mul_f32 v196, s42, v196
    v_mul_f32 v197, s42, v197
    v_mul_f32 v198, s42, v198
    v_mul_f32 v199, s42, v199
    v_mul_f32 v200, s42, v200
    v_mul_f32 v201, s42, v201
    v_mul_f32 v202, s42, v202
    v_mul_f32 v203, s42, v203
    v_mul_f32 v204, s42, v204
    v_mul_f32 v205, s42, v205
    v_mul_f32 v206, s42, v206
    v_mul_f32 v207, s42, v207
    v_mul_f32 v208, s42, v208
    v_mul_f32 v209, s42, v209
    v_mul_f32 v210, s42, v210
    v_mul_f32 v211, s42, v211
    v_mul_f32 v212, s42, v212
    v_mul_f32 v213, s42, v213
    v_mul_f32 v214, s42, v214
    v_mul_f32 v215, s42, v215
    v_mul_f32 v216, s42, v216
    v_mul_f32 v217, s42, v217
    v_mul_f32 v218, s42, v218
    v_mul_f32 v219, s42, v219
    v_mul_f32 v220, s42, v220
    v_mul_f32 v221, s42, v221
    v_mul_f32 v222, s42, v222
    v_mul_f32 v223, s42, v223
    v_mul_f32 v224, s42, v224
    v_mul_f32 v225, s42, v225
    v_mul_f32 v226, s42, v226
    v_mul_f32 v227, s42, v227
    v_mul_f32 v228, s42, v228
    v_mul_f32 v229, s42, v229
    v_mul_f32 v230, s42, v230
    v_mul_f32 v231, s42, v231
    v_mul_f32 v232, s42, v232
    v_mul_f32 v233, s42, v233
    v_mul_f32 v234, s42, v234
    v_mul_f32 v235, s42, v235
    v_mul_f32 v236, s42, v236
    v_mul_f32 v237, s42, v237
    v_mul_f32 v238, s42, v238
    v_mul_f32 v239, s42, v239
    v_cvt_pk_bf16_f32 v32, v176, v184
    v_cvt_pk_bf16_f32 v36, v180, v188
    v_cvt_pk_bf16_f32 v33, v192, v200
    v_cvt_pk_bf16_f32 v37, v196, v204
    v_cvt_pk_bf16_f32 v34, v208, v216
    v_cvt_pk_bf16_f32 v38, v212, v220
    v_cvt_pk_bf16_f32 v35, v224, v232
    v_cvt_pk_bf16_f32 v39, v228, v236
    v_cvt_pk_bf16_f32 v40, v177, v185
    v_cvt_pk_bf16_f32 v44, v181, v189
    v_cvt_pk_bf16_f32 v41, v193, v201
    v_cvt_pk_bf16_f32 v45, v197, v205
    v_cvt_pk_bf16_f32 v42, v209, v217
    v_cvt_pk_bf16_f32 v46, v213, v221
    v_cvt_pk_bf16_f32 v43, v225, v233
    v_cvt_pk_bf16_f32 v47, v229, v237
    v_cvt_pk_bf16_f32 v48, v178, v186
    v_cvt_pk_bf16_f32 v52, v182, v190
    v_cvt_pk_bf16_f32 v49, v194, v202
    v_cvt_pk_bf16_f32 v53, v198, v206
    v_cvt_pk_bf16_f32 v50, v210, v218
    v_cvt_pk_bf16_f32 v54, v214, v222
    v_cvt_pk_bf16_f32 v51, v226, v234
    v_cvt_pk_bf16_f32 v55, v230, v238
    v_cvt_pk_bf16_f32 v56, v179, v187
    v_cvt_pk_bf16_f32 v60, v183, v191
    v_cvt_pk_bf16_f32 v57, v195, v203
    v_cvt_pk_bf16_f32 v61, v199, v207
    v_cvt_pk_bf16_f32 v58, v211, v219
    v_cvt_pk_bf16_f32 v62, v215, v223
    v_cvt_pk_bf16_f32 v59, v227, v235
    v_cvt_pk_bf16_f32 v63, v231, v239
    v_permlane16_swap_b32 v32, v36
    v_permlane16_swap_b32 v33, v37
    v_permlane16_swap_b32 v34, v38
    v_permlane16_swap_b32 v35, v39
    v_permlane16_swap_b32 v40, v44
    v_permlane16_swap_b32 v41, v45
    v_permlane16_swap_b32 v42, v46
    v_permlane16_swap_b32 v43, v47
    v_permlane16_swap_b32 v48, v52
    v_permlane16_swap_b32 v49, v53
    v_permlane16_swap_b32 v50, v54
    v_permlane16_swap_b32 v51, v55
    v_permlane16_swap_b32 v56, v60
    v_permlane16_swap_b32 v57, v61
    v_permlane16_swap_b32 v58, v62
    v_permlane16_swap_b32 v59, v63
    v_accvgpr_write_b32 a128, v32
    v_accvgpr_write_b32 a144, v36
    v_accvgpr_write_b32 a129, v33
    v_accvgpr_write_b32 a145, v37
    v_accvgpr_write_b32 a130, v34
    v_accvgpr_write_b32 a146, v38
    v_accvgpr_write_b32 a131, v35
    v_accvgpr_write_b32 a147, v39
    v_accvgpr_write_b32 a132, v40
    v_accvgpr_write_b32 a148, v44
    v_accvgpr_write_b32 a133, v41
    v_accvgpr_write_b32 a149, v45
    v_accvgpr_write_b32 a134, v42
    v_accvgpr_write_b32 a150, v46
    v_accvgpr_write_b32 a135, v43
    v_accvgpr_write_b32 a151, v47
    v_accvgpr_write_b32 a136, v48
    v_accvgpr_write_b32 a152, v52
    v_accvgpr_write_b32 a137, v49
    v_accvgpr_write_b32 a153, v53
    v_accvgpr_write_b32 a138, v50
    v_accvgpr_write_b32 a154, v54
    v_accvgpr_write_b32 a139, v51
    v_accvgpr_write_b32 a155, v55
    v_accvgpr_write_b32 a140, v56
    v_accvgpr_write_b32 a156, v60
    v_accvgpr_write_b32 a141, v57
    v_accvgpr_write_b32 a157, v61
    v_accvgpr_write_b32 a142, v58
    v_accvgpr_write_b32 a158, v62
    v_accvgpr_write_b32 a143, v59
    v_accvgpr_write_b32 a159, v63
    s_branch L_qdone
L_q1:
    s_nop 15
    s_mov_b32 s20, s50
    s_and_b32 s21, s51, 0xffff
    s_mov_b32 s22, 4194304
    s_mov_b32 s23, 0x20000
    s_lshl_b32 s33, s36, 2
    s_add_u32 s33, s33, s38
    s_lshl_b32 s33, s33, 15
    s_lshl_b32 s32, s37, 10
    s_add_u32 s33, s33, s32
    buffer_load_dwordx4 a[128:131], v7, s[20:23], s33 offen
    s_add_u32 s33, s33, 8192
    buffer_load_dwordx4 a[132:135], v7, s[20:23], s33 offen
    s_add_u32 s33, s33, 8192
    buffer_load_dwordx4 a[136:139], v7, s[20:23], s33 offen
    s_add_u32 s33, s33, 8192
    buffer_load_dwordx4 a[140:143], v7, s[20:23], s33 offen
    s_lshl_b32 s33, s36, 15
    s_add_u32 s44, s44, s33
    s_addc_u32 s45, s45, 0
    s_mov_b32 s8, s44
    s_and_b32 s9, s45, 0xffff
    s_mov_b32 s10, 32768
    s_mov_b32 s11, 0x20000
    s_add_u32 m0, s34, 131072
    s_add_u32 s32, s34, 0
    buffer_load_dwordx4 v128, s[8:11], s32 offen lds
    buffer_load_dwordx4 v129, s[8:11], s32 offen offset:1024 lds
    buffer_load_dwordx4 v130, s[8:11], s32 offen offset:2048 lds
    buffer_load_dwordx4 v131, s[8:11], s32 offen offset:3072 lds
    s_add_u32 m0, s34, 135168
    s_add_u32 s32, s34, 4096
    buffer_load_dwordx4 v132, s[8:11], s32 offen lds
    buffer_load_dwordx4 v133, s[8:11], s32 offen offset:1024 lds
    buffer_load_dwordx4 v134, s[8:11], s32 offen offset:2048 lds
    buffer_load_dwordx4 v135, s[8:11], s32 offen offset:3072 lds
    s_add_u32 s44, s39, 0
    s_and_b32 s44, s44, 15
    s_lshl_b32 s44, s44, 18
    buffer_load_dwordx4 v[32:35], v240, s[20:23], s44 offen
    buffer_load_dwordx4 v[36:39], v241, s[20:23], s44 offen
    buffer_load_dwordx4 v[40:43], v242, s[20:23], s44 offen
    buffer_load_dwordx4 v[44:47], v243, s[20:23], s44 offen
    buffer_load_dwordx4 v[48:51], v244, s[20:23], s44 offen
    buffer_load_dwordx4 v[52:55], v245, s[20:23], s44 offen
    buffer_load_dwordx4 v[56:59], v246, s[20:23], s44 offen
    buffer_load_dwordx4 v[60:63], v247, s[20:23], s44 offen
    s_or_b32 s33, s37, s38
    s_or_b32 s98, s98, 1
    s_lshl_b32 s32, s36, 3
    v_mov_b32 v30, s32
    v_mov_b32 v31, s98
    s_cmp_lg_u32 s33, 0
    s_cbranch_scc1 L_nolead2
    s_mov_b64 exec, 1
    global_store_dword v30, v31, s[56:57] sc1
    s_mov_b64 exec, -1
L_nolead2:
    s_lshl_b32 s33, s37, 19
    s_add_u32 s52, s52, s33
    s_addc_u32 s53, s53, 0
    s_mov_b32 s24, s52
    s_and_b32 s25, s53, 0xffff
    s_mov_b32 s26, 524288
    s_mov_b32 s27, 0x20000
    s_lshl_b32 s33, s2, 16
    s_add_u32 s50, s58, s33
    s_addc_u32 s51, s59, 0
    s_mov_b32 s28, s50
    s_and_b32 s29, s51, 0xffff
    s_mov_b32 s30, 65536
    s_mov_b32 s31, 0x20000
    s_mov_b32 s92, s56
    s_mov_b32 s93, s57
    s_mov_b32 s94, s58
    s_mov_b32 s95, s59
    s_mov_b32 s96, s54
    s_mov_b32 s97, s55
    s_getpc_b64 s[32:33]
L_pc2:
    s_sub_u32 s32, s32, L_pc2-standalone__sliding_block_cached__sampling_kernel
    s_subb_u32 s33, s33, 0
    s_and_b32 s50, s36, 7
    s_lshl_b32 s50, s50, 13
    v_lshlrev_b32 v30, 7, v1
    v_add_u32 v30, s50, v30
    v_min_u32 v30, L_code_end-standalone__sliding_block_cached__sampling_kernel-4, v30
    global_load_dword a148, v30, s[32:33]
    s_mov_b32 s40, 0x05040100
    s_mov_b32 s41, 0x07060302
    s_mov_b32 s42, 0x3e0293ee
    s_lshl_b32 s48, s38, 13
    v_lshlrev_b32 v22, 10, v28
    v_lshrrev_b32 v30, 2, v28
    v_lshl_add_u32 v22, v30, 6, v22
    v_and_b32 v30, 3, v28
    v_xor_b32 v30, v30, v29
    v_lshl_add_u32 v22, v30, 4, v22
    v_add_u32 v22, 131072, v22
    v_and_b32 v30, 31, v1
    v_lshrrev_b32 v31, 5, v1
    v_lshlrev_b32 v8, 3, v31
    v_xor_b32 v8, v8, v28
    v_lshlrev_b32 v8, 4, v8
    v_lshl_add_u32 v8, v30, 8, v8
    v_xor_b32 v9, 16, v8
    v_xor_b32 v10, 32, v8
    v_xor_b32 v11, 48, v8
    v_xor_b32 v12, 64, v8
    v_xor_b32 v13, 80, v8
    v_xor_b32 v14, 96, v8
    v_xor_b32 v15, 112, v8
    v_lshrrev_b32 v30, 2, v28
    v_lshl_add_u32 v16, v31, 2, v30
    v_lshlrev_b32 v16, 8, v16
    v_lshl_add_u32 v16, v30, 6, v16
    v_and_b32 v30, 1, v29
    v_lshl_add_u32 v16, v30, 5, v16
    v_and_b32 v30, 2, v28
    v_lshl_add_u32 v16, v30, 3, v16
    v_and_b32 v30, 1, v28
    v_lshl_add_u32 v16, v30, 3, v16
    v_xor_b32 v17, 64, v16
    v_xor_b32 v18, 128, v16
    v_xor_b32 v19, 192, v16
    s_waitcnt vmcnt(9)
    s_barrier
    s_add_u32 s44, s39, 0
    s_and_b32 s44, s44, 15
    s_lshl_b32 s44, s44, 6
    v_xor_b32 v23, s44, v22
    ds_read_b128 a[0:3], v23
    ds_read_b128 a[4:7], v23 offset:16384
    s_add_u32 s44, s39, 1
    s_and_b32 s44, s44, 15
    s_lshl_b32 s44, s44, 6
    v_xor_b32 v23, s44, v22
    ds_read_b128 a[8:11], v23
    ds_read_b128 a[12:15], v23 offset:16384
    s_add_u32 s44, s39, 2
    s_and_b32 s44, s44, 15
    s_lshl_b32 s44, s44, 6
    v_xor_b32 v23, s44, v22
    ds_read_b128 a[16:19], v23
    ds_read_b128 a[20:23], v23 offset:16384
    s_add_u32 s44, s39, 3
    s_and_b32 s44, s44, 15
    s_lshl_b32 s44, s44, 6
    v_xor_b32 v23, s44, v22
    ds_read_b128 a[24:27], v23
    ds_read_b128 a[28:31], v23 offset:16384
    s_add_u32 s44, s39, 1
    s_and_b32 s44, s44, 15
    s_lshl_b32 s44, s44, 18
    buffer_load_dwordx4 v[64:67], v240, s[20:23], s44 offen
    buffer_load_dwordx4 v[68:71], v241, s[20:23], s44 offen
    buffer_load_dwordx4 v[72:75], v242, s[20:23], s44 offen
    buffer_load_dwordx4 v[76:79], v243, s[20:23], s44 offen
    buffer_load_dwordx4 v[80:83], v244, s[20:23], s44 offen
    buffer_load_dwordx4 v[84:87], v245, s[20:23], s44 offen
    buffer_load_dwordx4 v[88:91], v246, s[20:23], s44 offen
    buffer_load_dwordx4 v[92:95], v247, s[20:23], s44 offen
    s_add_u32 s44, s39, 4
    s_and_b32 s44, s44, 15
    s_lshl_b32 s44, s44, 6
    v_xor_b32 v23, s44, v22
    ds_read_b128 a[32:35], v23
    ds_read_b128 a[36:39], v23 offset:16384
    s_add_u32 s44, s39, 5
    s_and_b32 s44, s44, 15
    s_lshl_b32 s44, s44, 6
    v_xor_b32 v23, s44, v22
    ds_read_b128 a[40:43], v23
    ds_read_b128 a[44:47], v23 offset:16384
    s_add_u32 s44, s39, 6
    s_and_b32 s44, s44, 15
    s_lshl_b32 s44, s44, 6
    v_xor_b32 v23, s44, v22
    ds_read_b128 a[48:51], v23
    ds_read_b128 a[52:55], v23 offset:16384
    s_add_u32 s44, s39, 7
    s_and_b32 s44, s44, 15
    s_lshl_b32 s44, s44, 6
    v_xor_b32 v23, s44, v22
    ds_read_b128 a[56:59], v23
    ds_read_b128 a[60:63], v23 offset:16384
    s_add_u32 s44, s39, 8
    s_and_b32 s44, s44, 15
    s_lshl_b32 s44, s44, 6
    v_xor_b32 v23, s44, v22
    ds_read_b128 a[64:67], v23
    ds_read_b128 a[68:71], v23 offset:16384
    s_add_u32 s44, s39, 9
    s_and_b32 s44, s44, 15
    s_lshl_b32 s44, s44, 6
    v_xor_b32 v23, s44, v22
    ds_read_b128 a[72:75], v23
    ds_read_b128 a[76:79], v23 offset:16384
    s_add_u32 s44, s39, 2
    s_and_b32 s44, s44, 15
    s_lshl_b32 s44, s44, 18
    buffer_load_dwordx4 v[96:99], v240, s[20:23], s44 offen
    buffer_load_dwordx4 v[100:103], v241, s[20:23], s44 offen
    buffer_load_dwordx4 v[104:107], v242, s[20:23], s44 offen
    buffer_load_dwordx4 v[108:111], v243, s[20:23], s44 offen
    buffer_load_dwordx4 v[112:115], v244, s[20:23], s44 offen
    buffer_load_dwordx4 v[116:119], v245, s[20:23], s44 offen
    buffer_load_dwordx4 v[120:123], v246, s[20:23], s44 offen
    buffer_load_dwordx4 v[124:127], v247, s[20:23], s44 offen
    s_add_u32 s44, s39, 10
    s_and_b32 s44, s44, 15
    s_lshl_b32 s44, s44, 6
    v_xor_b32 v23, s44, v22
    ds_read_b128 a[80:83], v23
    ds_read_b128 a[84:87], v23 offset:16384
    s_add_u32 s44, s39, 11
    s_and_b32 s44, s44, 15
    s_lshl_b32 s44, s44, 6
    v_xor_b32 v23, s44, v22
    ds_read_b128 a[88:91], v23
    ds_read_b128 a[92:95], v23 offset:16384
    s_add_u32 s44, s39, 12
    s_and_b32 s44, s44, 15
    s_lshl_b32 s44, s44, 6
    v_xor_b32 v23, s44, v22
    ds_read_b128 a[96:99], v23
    ds_read_b128 a[100:103], v23 offset:16384
    s_add_u32 s44, s39, 13
    s_and_b32 s44, s44, 15
    s_lshl_b32 s44, s44, 6
    v_xor_b32 v23, s44, v22
    ds_read_b128 a[104:107], v23
    ds_read_b128 a[108:111], v23 offset:16384
    s_add_u32 s44, s39, 14
    s_and_b32 s44, s44, 15
    s_lshl_b32 s44, s44, 6
    v_xor_b32 v23, s44, v22
    ds_read_b128 a[112:115], v23
    ds_read_b128 a[116:119], v23 offset:16384
    s_add_u32 s44, s39, 15
    s_and_b32 s44, s44, 15
    s_lshl_b32 s44, s44, 6
    v_xor_b32 v23, s44, v22
    ds_read_b128 a[120:123], v23
    ds_read_b128 a[124:127], v23 offset:16384
    v_lshlrev_b32 v30, 2, v29
    v_xor_b32 v30, v28, v30
    v_lshlrev_b32 v30, 4, v30
    v_lshl_add_u32 v30, v29, 10, v30
    s_lshl_b32 s45, s38, 8
    v_add_u32 v20, s45, v30
    v_add_u32 v21, 3072, v20
    v_add_u32 v22, 6144, v20
    v_add_u32 v23, 9216, v20
    s_waitcnt vmcnt(17)
    s_waitcnt lgkmcnt(15)
    v_perm_b32 v160, v36, v32, s40
    v_perm_b32 v161, v44, v40, s40
    v_perm_b32 v162, v52, v48, s40
    v_perm_b32 v163, v60, v56, s40
    v_perm_b32 v164, v36, v32, s41
    v_perm_b32 v165, v44, v40, s41
    v_mfma_f32_16x16x32_bf16 v[176:179], v[160:163], a[0:3], 0
    v_perm_b32 v166, v52, v48, s41
    v_perm_b32 v167, v60, v56, s41
    v_mfma_f32_16x16x32_bf16 v[180:183], v[160:163], a[4:7], 0
    s_add_u32 s44, s39, 3
    s_and_b32 s44, s44, 15
    s_lshl_b32 s44, s44, 18
    buffer_load_dwordx4 v[128:131], v240, s[20:23], s44 offen
    v_perm_b32 v168, v37, v33, s40
    v_perm_b32 v169, v45, v41, s40
    v_mfma_f32_16x16x32_bf16 v[184:187], v[164:167], a[0:3], 0
    v_perm_b32 v170, v53, v49, s40
    v_perm_b32 v171, v61, v57, s40
    v_mfma_f32_16x16x32_bf16 v[188:191], v[164:167], a[4:7], 0
    buffer_load_dwordx4 v[132:135], v241, s[20:23], s44 offen
    v_perm_b32 v172, v37, v33, s41
    v_perm_b32 v173, v45, v41, s41
    v_mfma_f32_16x16x32_bf16 v[192:195], v[168:171], a[0:3], 0
    v_perm_b32 v174, v53, v49, s41
    v_perm_b32 v175, v61, v57, s41
    v_mfma_f32_16x16x32_bf16 v[196:199], v[168:171], a[4:7], 0
    buffer_load_dwordx4 v[136:139], v242, s[20:23], s44 offen
    v_perm_b32 v160, v38, v34, s40
    v_perm_b32 v161, v46, v42, s40
    v_mfma_f32_16x16x32_bf16 v[200:203], v[172:175], a[0:3], 0
    v_perm_b32 v162, v54, v50, s40
    v_perm_b32 v163, v62, v58, s40
    v_mfma_f32_16x16x32_bf16 v[204:207], v[172:175], a[4:7], 0
    buffer_load_dwordx4 v[140:143], v243, s[20:23], s44 offen
    v_perm_b32 v164, v38, v34, s41
    v_perm_b32 v165, v46, v42, s41
    v_mfma_f32_16x16x32_bf16 v[208:211], v[160:163], a[0:3], 0
    v_perm_b32 v166, v54, v50, s41
    v_perm_b32 v167, v62, v58, s41
    v_mfma_f32_16x16x32_bf16 v[212:215], v[160:163], a[4:7], 0
    buffer_load_dwordx4 v[144:147], v244, s[20:23], s44 offen
    v_perm_b32 v168, v39, v35, s40
    v_perm_b32 v169, v47, v43, s40
    v_mfma_f32_16x16x32_bf16 v[216:219], v[164:167], a[0:3], 0
    v_perm_b32 v170, v55, v51, s40
    v_perm_b32 v171, v63, v59, s40
    v_mfma_f32_16x16x32_bf16 v[220:223], v[164:167], a[4:7], 0
    buffer_load_dwordx4 v[148:151], v245, s[20:23], s44 offen
    v_perm_b32 v172, v39, v35, s41
    v_perm_b32 v173, v47, v43, s41
    v_mfma_f32_16x16x32_bf16 v[224:227], v[168:171], a[0:3], 0
    v_perm_b32 v174, v55, v51, s41
    v_perm_b32 v175, v63, v59, s41
    v_mfma_f32_16x16x32_bf16 v[228:231], v[168:171], a[4:7], 0
    buffer_load_dwordx4 v[152:155], v246, s[20:23], s44 offen
    v_mfma_f32_16x16x32_bf16 v[232:235], v[172:175], a[0:3], 0
    v_mfma_f32_16x16x32_bf16 v[236:239], v[172:175], a[4:7], 0
    buffer_load_dwordx4 v[156:159], v247, s[20:23], s44 offen
    s_waitcnt vmcnt(16)
    v_perm_b32 v160, v68, v64, s40
    v_perm_b32 v161, v76, v72, s40
    v_perm_b32 v162, v84, v80, s40
    v_perm_b32 v163, v92, v88, s40
    v_perm_b32 v164, v68, v64, s41
    v_perm_b32 v165, v76, v72, s41
    v_mfma_f32_16x16x32_bf16 v[176:179], v[160:163], a[8:11], v[176:179]
    v_perm_b32 v166, v84, v80, s41
    v_perm_b32 v167, v92, v88, s41
    v_mfma_f32_16x16x32_bf16 v[180:183], v[160:163], a[12:15], v[180:183]
    s_add_u32 s44, s39, 4
    s_and_b32 s44, s44, 15
    s_lshl_b32 s44, s44, 18
    buffer_load_dwordx4 v[32:35], v240, s[20:23], s44 offen
    v_perm_b32 v168, v69, v65, s40
    v_perm_b32 v169, v77, v73, s40
    v_mfma_f32_16x16x32_bf16 v[184:187], v[164:167], a[8:11], v[184:187]
    v_perm_b32 v170, v85, v81, s40
    v_perm_b32 v171, v93, v89, s40
    v_mfma_f32_16x16x32_bf16 v[188:191], v[164:167], a[12:15], v[188:191]
    buffer_load_dwordx4 v[36:39], v241, s[20:23], s44 offen
    v_perm_b32 v172, v69, v65, s41
    v_perm_b32 v173, v77, v73, s41
    v_mfma_f32_16x16x32_bf16 v[192:195], v[168:171], a[8:11], v[192:195]
    v_perm_b32 v174, v85, v81, s41
    v_perm_b32 v175, v93, v89, s41
    v_mfma_f32_16x16x32_bf16 v[196:199], v[168:171], a[12:15], v[196:199]
    buffer_load_dwordx4 v[40:43], v242, s[20:23], s44 offen
    v_perm_b32 v160, v70, v66, s40
    v_perm_b32 v161, v78, v74, s40
    v_mfma_f32_16x16x32_bf16 v[200:203], v[172:175], a[8:11], v[200:203]
    v_perm_b32 v162, v86, v82, s40
    v_perm_b32 v163, v94, v90, s40
    v_mfma_f32_16x16x32_bf16 v[204:207], v[172:175], a[12:15], v[204:207]
    buffer_load_dwordx4 v[44:47], v243, s[20:23], s44 offen
    v_perm_b32 v164, v70, v66, s41
    v_perm_b32 v165, v78, v74, s41
    v_mfma_f32_16x16x32_bf16 v[208:211], v[160:163], a[8:11], v[208:211]
    v_perm_b32 v166, v86, v82, s41
    v_perm_b32 v167, v94, v90, s41
    v_mfma_f32_16x16x32_bf16 v[212:215], v[160:163], a[12:15], v[212:215]
    buffer_load_dwordx4 v[48:51], v244, s[20:23], s44 offen
    v_perm_b32 v168, v71, v67, s40
    v_perm_b32 v169, v79, v75, s40
    v_mfma_f32_16x16x32_bf16 v[216:219], v[164:167], a[8:11], v[216:219]
    v_perm_b32 v170, v87, v83, s40
    v_perm_b32 v171, v95, v91, s40
    v_mfma_f32_16x16x32_bf16 v[220:223], v[164:167], a[12:15], v[220:223]
    buffer_load_dwordx4 v[52:55], v245, s[20:23], s44 offen
    v_perm_b32 v172, v71, v67, s41
    v_perm_b32 v173, v79, v75, s41
    v_mfma_f32_16x16x32_bf16 v[224:227], v[168:171], a[8:11], v[224:227]
    v_perm_b32 v174, v87, v83, s41
    v_perm_b32 v175, v95, v91, s41
    v_mfma_f32_16x16x32_bf16 v[228:231], v[168:171], a[12:15], v[228:231]
    buffer_load_dwordx4 v[56:59], v246, s[20:23], s44 offen
    v_mfma_f32_16x16x32_bf16 v[232:235], v[172:175], a[8:11], v[232:235]
    v_mfma_f32_16x16x32_bf16 v[236:239], v[172:175], a[12:15], v[236:239]
    buffer_load_dwordx4 v[60:63], v247, s[20:23], s44 offen
    s_waitcnt vmcnt(16)
    v_perm_b32 v160, v100, v96, s40
    v_perm_b32 v161, v108, v104, s40
    v_perm_b32 v162, v116, v112, s40
    v_perm_b32 v163, v124, v120, s40
    v_perm_b32 v164, v100, v96, s41
    v_perm_b32 v165, v108, v104, s41
    v_mfma_f32_16x16x32_bf16 v[176:179], v[160:163], a[16:19], v[176:179]
    v_perm_b32 v166, v116, v112, s41
    v_perm_b32 v167, v124, v120, s41
    v_mfma_f32_16x16x32_bf16 v[180:183], v[160:163], a[20:23], v[180:183]
    s_add_u32 s44, s39, 5
    s_and_b32 s44, s44, 15
    s_lshl_b32 s44, s44, 18
    buffer_load_dwordx4 v[64:67], v240, s[20:23], s44 offen
    v_perm_b32 v168, v101, v97, s40
    v_perm_b32 v169, v109, v105, s40
    v_mfma_f32_16x16x32_bf16 v[184:187], v[164:167], a[16:19], v[184:187]
    v_perm_b32 v170, v117, v113, s40
    v_perm_b32 v171, v125, v121, s40
    v_mfma_f32_16x16x32_bf16 v[188:191], v[164:167], a[20:23], v[188:191]
    buffer_load_dwordx4 v[68:71], v241, s[20:23], s44 offen
    v_perm_b32 v172, v101, v97, s41
    v_perm_b32 v173, v109, v105, s41
    v_mfma_f32_16x16x32_bf16 v[192:195], v[168:171], a[16:19], v[192:195]
    v_perm_b32 v174, v117, v113, s41
    v_perm_b32 v175, v125, v121, s41
    v_mfma_f32_16x16x32_bf16 v[196:199], v[168:171], a[20:23], v[196:199]
    buffer_load_dwordx4 v[72:75], v242, s[20:23], s44 offen
    v_perm_b32 v160, v102, v98, s40
    v_perm_b32 v161, v110, v106, s40
    v_mfma_f32_16x16x32_bf16 v[200:203], v[172:175], a[16:19], v[200:203]
    v_perm_b32 v162, v118, v114, s40
    v_perm_b32 v163, v126, v122, s40
    v_mfma_f32_16x16x32_bf16 v[204:207], v[172:175], a[20:23], v[204:207]
    buffer_load_dwordx4 v[76:79], v243, s[20:23], s44 offen
    v_perm_b32 v164, v102, v98, s41
    v_perm_b32 v165, v110, v106, s41
    v_mfma_f32_16x16x32_bf16 v[208:211], v[160:163], a[16:19], v[208:211]
    v_perm_b32 v166, v118, v114, s41
    v_perm_b32 v167, v126, v122, s41
    v_mfma_f32_16x16x32_bf16 v[212:215], v[160:163], a[20:23], v[212:215]
    buffer_load_dwordx4 v[80:83], v244, s[20:23], s44 offen
    v_perm_b32 v168, v103, v99, s40
    v_perm_b32 v169, v111, v107, s40
    v_mfma_f32_16x16x32_bf16 v[216:219], v[164:167], a[16:19], v[216:219]
    v_perm_b32 v170, v119, v115, s40
    v_perm_b32 v171, v127, v123, s40
    v_mfma_f32_16x16x32_bf16 v[220:223], v[164:167], a[20:23], v[220:223]
    buffer_load_dwordx4 v[84:87], v245, s[20:23], s44 offen
    v_perm_b32 v172, v103, v99, s41
    v_perm_b32 v173, v111, v107, s41
    v_mfma_f32_16x16x32_bf16 v[224:227], v[168:171], a[16:19], v[224:227]
    v_perm_b32 v174, v119, v115, s41
    v_perm_b32 v175, v127, v123, s41
    v_mfma_f32_16x16x32_bf16 v[228:231], v[168:171], a[20:23], v[228:231]
    buffer_load_dwordx4 v[88:91], v246, s[20:23], s44 offen
    v_mfma_f32_16x16x32_bf16 v[232:235], v[172:175], a[16:19], v[232:235]
    v_mfma_f32_16x16x32_bf16 v[236:239], v[172:175], a[20:23], v[236:239]
    buffer_load_dwordx4 v[92:95], v247, s[20:23], s44 offen
    s_waitcnt vmcnt(16)
    v_perm_b32 v160, v132, v128, s40
    v_perm_b32 v161, v140, v136, s40
    v_perm_b32 v162, v148, v144, s40
    v_perm_b32 v163, v156, v152, s40
    v_perm_b32 v164, v132, v128, s41
    v_perm_b32 v165, v140, v136, s41
    v_mfma_f32_16x16x32_bf16 v[176:179], v[160:163], a[24:27], v[176:179]
    v_perm_b32 v166, v148, v144, s41
    v_perm_b32 v167, v156, v152, s41
    v_mfma_f32_16x16x32_bf16 v[180:183], v[160:163], a[28:31], v[180:183]
    s_add_u32 s44, s39, 6
    s_and_b32 s44, s44, 15
    s_lshl_b32 s44, s44, 18
    buffer_load_dwordx4 v[96:99], v240, s[20:23], s44 offen
    v_perm_b32 v168, v133, v129, s40
    v_perm_b32 v169, v141, v137, s40
    v_mfma_f32_16x16x32_bf16 v[184:187], v[164:167], a[24:27], v[184:187]
    v_perm_b32 v170, v149, v145, s40
    v_perm_b32 v171, v157, v153, s40
    v_mfma_f32_16x16x32_bf16 v[188:191], v[164:167], a[28:31], v[188:191]
    buffer_load_dwordx4 v[100:103], v241, s[20:23], s44 offen
    v_perm_b32 v172, v133, v129, s41
    v_perm_b32 v173, v141, v137, s41
    v_mfma_f32_16x16x32_bf16 v[192:195], v[168:171], a[24:27], v[192:195]
    v_perm_b32 v174, v149, v145, s41
    v_perm_b32 v175, v157, v153, s41
    v_mfma_f32_16x16x32_bf16 v[196:199], v[168:171], a[28:31], v[196:199]
    buffer_load_dwordx4 v[104:107], v242, s[20:23], s44 offen
    v_perm_b32 v160, v134, v130, s40
    v_perm_b32 v161, v142, v138, s40
    v_mfma_f32_16x16x32_bf16 v[200:203], v[172:175], a[24:27], v[200:203]
    v_perm_b32 v162, v150, v146, s40
    v_perm_b32 v163, v158, v154, s40
    v_mfma_f32_16x16x32_bf16 v[204:207], v[172:175], a[28:31], v[204:207]
    buffer_load_dwordx4 v[108:111], v243, s[20:23], s44 offen
    v_perm_b32 v164, v134, v130, s41
    v_perm_b32 v165, v142, v138, s41
    v_mfma_f32_16x16x32_bf16 v[208:211], v[160:163], a[24:27], v[208:211]
    v_perm_b32 v166, v150, v146, s41
    v_perm_b32 v167, v158, v154, s41
    v_mfma_f32_16x16x32_bf16 v[212:215], v[160:163], a[28:31], v[212:215]
    buffer_load_dwordx4 v[112:115], v244, s[20:23], s44 offen
    v_perm_b32 v168, v135, v131, s40
    v_perm_b32 v169, v143, v139, s40
    v_mfma_f32_16x16x32_bf16 v[216:219], v[164:167], a[24:27], v[216:219]
    v_perm_b32 v170, v151, v147, s40
    v_perm_b32 v171, v159, v155, s40
    v_mfma_f32_16x16x32_bf16 v[220:223], v[164:167], a[28:31], v[220:223]
    buffer_load_dwordx4 v[116:119], v245, s[20:23], s44 offen
    v_perm_b32 v172, v135, v131, s41
    v_perm_b32 v173, v143, v139, s41
    v_mfma_f32_16x16x32_bf16 v[224:227], v[168:171], a[24:27], v[224:227]
    v_perm_b32 v174, v151, v147, s41
    v_perm_b32 v175, v159, v155, s41
    v_mfma_f32_16x16x32_bf16 v[228:231], v[168:171], a[28:31], v[228:231]
    buffer_load_dwordx4 v[120:123], v246, s[20:23], s44 offen
    v_mfma_f32_16x16x32_bf16 v[232:235], v[172:175], a[24:27], v[232:235]
    v_mfma_f32_16x16x32_bf16 v[236:239], v[172:175], a[28:31], v[236:239]
    buffer_load_dwordx4 v[124:127], v247, s[20:23], s44 offen
    s_waitcnt vmcnt(16)
    v_perm_b32 v160, v36, v32, s40
    v_perm_b32 v161, v44, v40, s40
    v_perm_b32 v162, v52, v48, s40
    v_perm_b32 v163, v60, v56, s40
    v_perm_b32 v164, v36, v32, s41
    v_perm_b32 v165, v44, v40, s41
    v_mfma_f32_16x16x32_bf16 v[176:179], v[160:163], a[32:35], v[176:179]
    v_perm_b32 v166, v52, v48, s41
    v_perm_b32 v167, v60, v56, s41
    v_mfma_f32_16x16x32_bf16 v[180:183], v[160:163], a[36:39], v[180:183]
    s_add_u32 s44, s39, 7
    s_and_b32 s44, s44, 15
    s_lshl_b32 s44, s44, 18
    buffer_load_dwordx4 v[128:131], v240, s[20:23], s44 offen
    v_perm_b32 v168, v37, v33, s40
    v_perm_b32 v169, v45, v41, s40
    v_mfma_f32_16x16x32_bf16 v[184:187], v[164:167], a[32:35], v[184:187]
    v_perm_b32 v170, v53, v49, s40
    v_perm_b32 v171, v61, v57, s40
    v_mfma_f32_16x16x32_bf16 v[188:191], v[164:167], a[36:39], v[188:191]
    buffer_load_dwordx4 v[132:135], v241, s[20:23], s44 offen
    v_perm_b32 v172, v37, v33, s41
    v_perm_b32 v173, v45, v41, s41
    v_mfma_f32_16x16x32_bf16 v[192:195], v[168:171], a[32:35], v[192:195]
    v_perm_b32 v174, v53, v49, s41
    v_perm_b32 v175, v61, v57, s41
    v_mfma_f32_16x16x32_bf16 v[196:199], v[168:171], a[36:39], v[196:199]
    buffer_load_dwordx4 v[136:139], v242, s[20:23], s44 offen
    v_perm_b32 v160, v38, v34, s40
    v_perm_b32 v161, v46, v42, s40
    v_mfma_f32_16x16x32_bf16 v[200:203], v[172:175], a[32:35], v[200:203]
    v_perm_b32 v162, v54, v50, s40
    v_perm_b32 v163, v62, v58, s40
    v_mfma_f32_16x16x32_bf16 v[204:207], v[172:175], a[36:39], v[204:207]
    buffer_load_dwordx4 v[140:143], v243, s[20:23], s44 offen
    v_perm_b32 v164, v38, v34, s41
    v_perm_b32 v165, v46, v42, s41
    v_mfma_f32_16x16x32_bf16 v[208:211], v[160:163], a[32:35], v[208:211]
    v_perm_b32 v166, v54, v50, s41
    v_perm_b32 v167, v62, v58, s41
    v_mfma_f32_16x16x32_bf16 v[212:215], v[160:163], a[36:39], v[212:215]
    buffer_load_dwordx4 v[144:147], v244, s[20:23], s44 offen
    v_perm_b32 v168, v39, v35, s40
    v_perm_b32 v169, v47, v43, s40
    v_mfma_f32_16x16x32_bf16 v[216:219], v[164:167], a[32:35], v[216:219]
    v_perm_b32 v170, v55, v51, s40
    v_perm_b32 v171, v63, v59, s40
    v_mfma_f32_16x16x32_bf16 v[220:223], v[164:167], a[36:39], v[220:223]
    buffer_load_dwordx4 v[148:151], v245, s[20:23], s44 offen
    v_perm_b32 v172, v39, v35, s41
    v_perm_b32 v173, v47, v43, s41
    v_mfma_f32_16x16x32_bf16 v[224:227], v[168:171], a[32:35], v[224:227]
    v_perm_b32 v174, v55, v51, s41
    v_perm_b32 v175, v63, v59, s41
    v_mfma_f32_16x16x32_bf16 v[228:231], v[168:171], a[36:39], v[228:231]
    buffer_load_dwordx4 v[152:155], v246, s[20:23], s44 offen
    v_mfma_f32_16x16x32_bf16 v[232:235], v[172:175], a[32:35], v[232:235]
    v_mfma_f32_16x16x32_bf16 v[236:239], v[172:175], a[36:39], v[236:239]
    buffer_load_dwordx4 v[156:159], v247, s[20:23], s44 offen
    s_waitcnt vmcnt(16)
    v_perm_b32 v160, v68, v64, s40
    v_perm_b32 v161, v76, v72, s40
    v_perm_b32 v162, v84, v80, s40
    v_perm_b32 v163, v92, v88, s40
    v_perm_b32 v164, v68, v64, s41
    v_perm_b32 v165, v76, v72, s41
    v_mfma_f32_16x16x32_bf16 v[176:179], v[160:163], a[40:43], v[176:179]
    v_perm_b32 v166, v84, v80, s41
    v_perm_b32 v167, v92, v88, s41
    v_mfma_f32_16x16x32_bf16 v[180:183], v[160:163], a[44:47], v[180:183]
    s_add_u32 s44, s39, 8
    s_and_b32 s44, s44, 15
    s_lshl_b32 s44, s44, 18
    buffer_load_dwordx4 v[32:35], v240, s[20:23], s44 offen
    v_perm_b32 v168, v69, v65, s40
    v_perm_b32 v169, v77, v73, s40
    v_mfma_f32_16x16x32_bf16 v[184:187], v[164:167], a[40:43], v[184:187]
    v_perm_b32 v170, v85, v81, s40
    v_perm_b32 v171, v93, v89, s40
    v_mfma_f32_16x16x32_bf16 v[188:191], v[164:167], a[44:47], v[188:191]
    buffer_load_dwordx4 v[36:39], v241, s[20:23], s44 offen
    v_perm_b32 v172, v69, v65, s41
    v_perm_b32 v173, v77, v73, s41
    v_mfma_f32_16x16x32_bf16 v[192:195], v[168:171], a[40:43], v[192:195]
    v_perm_b32 v174, v85, v81, s41
    v_perm_b32 v175, v93, v89, s41
    v_mfma_f32_16x16x32_bf16 v[196:199], v[168:171], a[44:47], v[196:199]
    buffer_load_dwordx4 v[40:43], v242, s[20:23], s44 offen
    v_perm_b32 v160, v70, v66, s40
    v_perm_b32 v161, v78, v74, s40
    v_mfma_f32_16x16x32_bf16 v[200:203], v[172:175], a[40:43], v[200:203]
    v_perm_b32 v162, v86, v82, s40
    v_perm_b32 v163, v94, v90, s40
    v_mfma_f32_16x16x32_bf16 v[204:207], v[172:175], a[44:47], v[204:207]
    buffer_load_dwordx4 v[44:47], v243, s[20:23], s44 offen
    v_perm_b32 v164, v70, v66, s41
    v_perm_b32 v165, v78, v74, s41
    v_mfma_f32_16x16x32_bf16 v[208:211], v[160:163], a[40:43], v[208:211]
    v_perm_b32 v166, v86, v82, s41
    v_perm_b32 v167, v94, v90, s41
    v_mfma_f32_16x16x32_bf16 v[212:215], v[160:163], a[44:47], v[212:215]
    buffer_load_dwordx4 v[48:51], v244, s[20:23], s44 offen
    v_perm_b32 v168, v71, v67, s40
    v_perm_b32 v169, v79, v75, s40
    v_mfma_f32_16x16x32_bf16 v[216:219], v[164:167], a[40:43], v[216:219]
    v_perm_b32 v170, v87, v83, s40
    v_perm_b32 v171, v95, v91, s40
    v_mfma_f32_16x16x32_bf16 v[220:223], v[164:167], a[44:47], v[220:223]
    buffer_load_dwordx4 v[52:55], v245, s[20:23], s44 offen
    v_perm_b32 v172, v71, v67, s41
    v_perm_b32 v173, v79, v75, s41
    v_mfma_f32_16x16x32_bf16 v[224:227], v[168:171], a[40:43], v[224:227]
    v_perm_b32 v174, v87, v83, s41
    v_perm_b32 v175, v95, v91, s41
    v_mfma_f32_16x16x32_bf16 v[228:231], v[168:171], a[44:47], v[228:231]
    buffer_load_dwordx4 v[56:59], v246, s[20:23], s44 offen
    v_mfma_f32_16x16x32_bf16 v[232:235], v[172:175], a[40:43], v[232:235]
    v_mfma_f32_16x16x32_bf16 v[236:239], v[172:175], a[44:47], v[236:239]
    buffer_load_dwordx4 v[60:63], v247, s[20:23], s44 offen
    s_waitcnt vmcnt(16)
    v_perm_b32 v160, v100, v96, s40
    v_perm_b32 v161, v108, v104, s40
    v_perm_b32 v162, v116, v112, s40
    v_perm_b32 v163, v124, v120, s40
    v_perm_b32 v164, v100, v96, s41
    v_perm_b32 v165, v108, v104, s41
    v_mfma_f32_16x16x32_bf16 v[176:179], v[160:163], a[48:51], v[176:179]
    v_perm_b32 v166, v116, v112, s41
    v_perm_b32 v167, v124, v120, s41
    v_mfma_f32_16x16x32_bf16 v[180:183], v[160:163], a[52:55], v[180:183]
    s_add_u32 s44, s39, 9
    s_and_b32 s44, s44, 15
    s_lshl_b32 s44, s44, 18
    buffer_load_dwordx4 v[64:67], v240, s[20:23], s44 offen
    v_perm_b32 v168, v101, v97, s40
    v_perm_b32 v169, v109, v105, s40
    v_mfma_f32_16x16x32_bf16 v[184:187], v[164:167], a[48:51], v[184:187]
    v_perm_b32 v170, v117, v113, s40
    v_perm_b32 v171, v125, v121, s40
    v_mfma_f32_16x16x32_bf16 v[188:191], v[164:167], a[52:55], v[188:191]
    buffer_load_dwordx4 v[68:71], v241, s[20:23], s44 offen
    v_perm_b32 v172, v101, v97, s41
    v_perm_b32 v173, v109, v105, s41
    v_mfma_f32_16x16x32_bf16 v[192:195], v[168:171], a[48:51], v[192:195]
    v_perm_b32 v174, v117, v113, s41
    v_perm_b32 v175, v125, v121, s41
    v_mfma_f32_16x16x32_bf16 v[196:199], v[168:171], a[52:55], v[196:199]
    buffer_load_dwordx4 v[72:75], v242, s[20:23], s44 offen
    v_perm_b32 v160, v102, v98, s40
    v_perm_b32 v161, v110, v106, s40
    v_mfma_f32_16x16x32_bf16 v[200:203], v[172:175], a[48:51], v[200:203]
    v_perm_b32 v162, v118, v114, s40
    v_perm_b32 v163, v126, v122, s40
    v_mfma_f32_16x16x32_bf16 v[204:207], v[172:175], a[52:55], v[204:207]
    buffer_load_dwordx4 v[76:79], v243, s[20:23], s44 offen
    v_perm_b32 v164, v102, v98, s41
    v_perm_b32 v165, v110, v106, s41
    v_mfma_f32_16x16x32_bf16 v[208:211], v[160:163], a[48:51], v[208:211]
    v_perm_b32 v166, v118, v114, s41
    v_perm_b32 v167, v126, v122, s41
    v_mfma_f32_16x16x32_bf16 v[212:215], v[160:163], a[52:55], v[212:215]
    buffer_load_dwordx4 v[80:83], v244, s[20:23], s44 offen
    v_perm_b32 v168, v103, v99, s40
    v_perm_b32 v169, v111, v107, s40
    v_mfma_f32_16x16x32_bf16 v[216:219], v[164:167], a[48:51], v[216:219]
    v_perm_b32 v170, v119, v115, s40
    v_perm_b32 v171, v127, v123, s40
    v_mfma_f32_16x16x32_bf16 v[220:223], v[164:167], a[52:55], v[220:223]
    buffer_load_dwordx4 v[84:87], v245, s[20:23], s44 offen
    v_perm_b32 v172, v103, v99, s41
    v_perm_b32 v173, v111, v107, s41
    v_mfma_f32_16x16x32_bf16 v[224:227], v[168:171], a[48:51], v[224:227]
    v_perm_b32 v174, v119, v115, s41
    v_perm_b32 v175, v127, v123, s41
    v_mfma_f32_16x16x32_bf16 v[228:231], v[168:171], a[52:55], v[228:231]
    buffer_load_dwordx4 v[88:91], v246, s[20:23], s44 offen
    v_mfma_f32_16x16x32_bf16 v[232:235], v[172:175], a[48:51], v[232:235]
    v_mfma_f32_16x16x32_bf16 v[236:239], v[172:175], a[52:55], v[236:239]
    buffer_load_dwordx4 v[92:95], v247, s[20:23], s44 offen
    s_waitcnt vmcnt(16)
    v_perm_b32 v160, v132, v128, s40
    v_perm_b32 v161, v140, v136, s40
    v_perm_b32 v162, v148, v144, s40
    v_perm_b32 v163, v156, v152, s40
    v_perm_b32 v164, v132, v128, s41
    v_perm_b32 v165, v140, v136, s41
    v_mfma_f32_16x16x32_bf16 v[176:179], v[160:163], a[56:59], v[176:179]
    v_perm_b32 v166, v148, v144, s41
    v_perm_b32 v167, v156, v152, s41
    v_mfma_f32_16x16x32_bf16 v[180:183], v[160:163], a[60:63], v[180:183]
    s_add_u32 s44, s39, 10
    s_and_b32 s44, s44, 15
    s_lshl_b32 s44, s44, 18
    buffer_load_dwordx4 v[96:99], v240, s[20:23], s44 offen
    v_perm_b32 v168, v133, v129, s40
    v_perm_b32 v169, v141, v137, s40
    v_mfma_f32_16x16x32_bf16 v[184:187], v[164:167], a[56:59], v[184:187]
    v_perm_b32 v170, v149, v145, s40
    v_perm_b32 v171, v157, v153, s40
    v_mfma_f32_16x16x32_bf16 v[188:191], v[164:167], a[60:63], v[188:191]
    buffer_load_dwordx4 v[100:103], v241, s[20:23], s44 offen
    v_perm_b32 v172, v133, v129, s41
    v_perm_b32 v173, v141, v137, s41
    v_mfma_f32_16x16x32_bf16 v[192:195], v[168:171], a[56:59], v[192:195]
    v_perm_b32 v174, v149, v145, s41
    v_perm_b32 v175, v157, v153, s41
    v_mfma_f32_16x16x32_bf16 v[196:199], v[168:171], a[60:63], v[196:199]
    buffer_load_dwordx4 v[104:107], v242, s[20:23], s44 offen
    v_perm_b32 v160, v134, v130, s40
    v_perm_b32 v161, v142, v138, s40
    v_mfma_f32_16x16x32_bf16 v[200:203], v[172:175], a[56:59], v[200:203]
    v_perm_b32 v162, v150, v146, s40
    v_perm_b32 v163, v158, v154, s40
    v_mfma_f32_16x16x32_bf16 v[204:207], v[172:175], a[60:63], v[204:207]
    buffer_load_dwordx4 v[108:111], v243, s[20:23], s44 offen
    v_perm_b32 v164, v134, v130, s41
    v_perm_b32 v165, v142, v138, s41
    v_mfma_f32_16x16x32_bf16 v[208:211], v[160:163], a[56:59], v[208:211]
    v_perm_b32 v166, v150, v146, s41
    v_perm_b32 v167, v158, v154, s41
    v_mfma_f32_16x16x32_bf16 v[212:215], v[160:163], a[60:63], v[212:215]
    buffer_load_dwordx4 v[112:115], v244, s[20:23], s44 offen
    v_perm_b32 v168, v135, v131, s40
    v_perm_b32 v169, v143, v139, s40
    v_mfma_f32_16x16x32_bf16 v[216:219], v[164:167], a[56:59], v[216:219]
    v_perm_b32 v170, v151, v147, s40
    v_perm_b32 v171, v159, v155, s40
    v_mfma_f32_16x16x32_bf16 v[220:223], v[164:167], a[60:63], v[220:223]
    buffer_load_dwordx4 v[116:119], v245, s[20:23], s44 offen
    v_perm_b32 v172, v135, v131, s41
    v_perm_b32 v173, v143, v139, s41
    v_mfma_f32_16x16x32_bf16 v[224:227], v[168:171], a[56:59], v[224:227]
    v_perm_b32 v174, v151, v147, s41
    v_perm_b32 v175, v159, v155, s41
    v_mfma_f32_16x16x32_bf16 v[228:231], v[168:171], a[60:63], v[228:231]
    buffer_load_dwordx4 v[120:123], v246, s[20:23], s44 offen
    v_mfma_f32_16x16x32_bf16 v[232:235], v[172:175], a[56:59], v[232:235]
    v_mfma_f32_16x16x32_bf16 v[236:239], v[172:175], a[60:63], v[236:239]
    buffer_load_dwordx4 v[124:127], v247, s[20:23], s44 offen
    s_waitcnt vmcnt(16)
    s_waitcnt lgkmcnt(14)
    v_perm_b32 v160, v36, v32, s40
    v_perm_b32 v161, v44, v40, s40
    v_perm_b32 v162, v52, v48, s40
    v_perm_b32 v163, v60, v56, s40
    v_perm_b32 v164, v36, v32, s41
    v_perm_b32 v165, v44, v40, s41
    v_mfma_f32_16x16x32_bf16 v[176:179], v[160:163], a[64:67], v[176:179]
    v_perm_b32 v166, v52, v48, s41
    v_perm_b32 v167, v60, v56, s41
    v_mfma_f32_16x16x32_bf16 v[180:183], v[160:163], a[68:71], v[180:183]
    s_add_u32 s44, s39, 11
    s_and_b32 s44, s44, 15
    s_lshl_b32 s44, s44, 18
    buffer_load_dwordx4 v[128:131], v240, s[20:23], s44 offen
    v_perm_b32 v168, v37, v33, s40
    v_perm_b32 v169, v45, v41, s40
    v_mfma_f32_16x16x32_bf16 v[184:187], v[164:167], a[64:67], v[184:187]
    v_perm_b32 v170, v53, v49, s40
    v_perm_b32 v171, v61, v57, s40
    v_mfma_f32_16x16x32_bf16 v[188:191], v[164:167], a[68:71], v[188:191]
    buffer_load_dwordx4 v[132:135], v241, s[20:23], s44 offen
    v_perm_b32 v172, v37, v33, s41
    v_perm_b32 v173, v45, v41, s41
    v_mfma_f32_16x16x32_bf16 v[192:195], v[168:171], a[64:67], v[192:195]
    v_perm_b32 v174, v53, v49, s41
    v_perm_b32 v175, v61, v57, s41
    v_mfma_f32_16x16x32_bf16 v[196:199], v[168:171], a[68:71], v[196:199]
    buffer_load_dwordx4 v[136:139], v242, s[20:23], s44 offen
    v_perm_b32 v160, v38, v34, s40
    v_perm_b32 v161, v46, v42, s40
    v_mfma_f32_16x16x32_bf16 v[200:203], v[172:175], a[64:67], v[200:203]
    v_perm_b32 v162, v54, v50, s40
    v_perm_b32 v163, v62, v58, s40
    v_mfma_f32_16x16x32_bf16 v[204:207], v[172:175], a[68:71], v[204:207]
    buffer_load_dwordx4 v[140:143], v243, s[20:23], s44 offen
    v_perm_b32 v164, v38, v34, s41
    v_perm_b32 v165, v46, v42, s41
    v_mfma_f32_16x16x32_bf16 v[208:211], v[160:163], a[64:67], v[208:211]
    v_perm_b32 v166, v54, v50, s41
    v_perm_b32 v167, v62, v58, s41
    v_mfma_f32_16x16x32_bf16 v[212:215], v[160:163], a[68:71], v[212:215]
    buffer_load_dwordx4 v[144:147], v244, s[20:23], s44 offen
    v_perm_b32 v168, v39, v35, s40
    v_perm_b32 v169, v47, v43, s40
    v_mfma_f32_16x16x32_bf16 v[216:219], v[164:167], a[64:67], v[216:219]
    v_perm_b32 v170, v55, v51, s40
    v_perm_b32 v171, v63, v59, s40
    v_mfma_f32_16x16x32_bf16 v[220:223], v[164:167], a[68:71], v[220:223]
    buffer_load_dwordx4 v[148:151], v245, s[20:23], s44 offen
    v_perm_b32 v172, v39, v35, s41
    v_perm_b32 v173, v47, v43, s41
    v_mfma_f32_16x16x32_bf16 v[224:227], v[168:171], a[64:67], v[224:227]
    v_perm_b32 v174, v55, v51, s41
    v_perm_b32 v175, v63, v59, s41
    v_mfma_f32_16x16x32_bf16 v[228:231], v[168:171], a[68:71], v[228:231]
    buffer_load_dwordx4 v[152:155], v246, s[20:23], s44 offen
    v_mfma_f32_16x16x32_bf16 v[232:235], v[172:175], a[64:67], v[232:235]
    v_mfma_f32_16x16x32_bf16 v[236:239], v[172:175], a[68:71], v[236:239]
    buffer_load_dwordx4 v[156:159], v247, s[20:23], s44 offen
    s_waitcnt vmcnt(16)
    s_waitcnt lgkmcnt(13)
    s_waitcnt lgkmcnt(12)
    v_perm_b32 v160, v68, v64, s40
    v_perm_b32 v161, v76, v72, s40
    v_perm_b32 v162, v84, v80, s40
    v_perm_b32 v163, v92, v88, s40
    v_perm_b32 v164, v68, v64, s41
    v_perm_b32 v165, v76, v72, s41
    v_mfma_f32_16x16x32_bf16 v[176:179], v[160:163], a[72:75], v[176:179]
    v_perm_b32 v166, v84, v80, s41
    v_perm_b32 v167, v92, v88, s41
    v_mfma_f32_16x16x32_bf16 v[180:183], v[160:163], a[76:79], v[180:183]
    s_add_u32 s44, s39, 12
    s_and_b32 s44, s44, 15
    s_lshl_b32 s44, s44, 18
    buffer_load_dwordx4 v[32:35], v240, s[20:23], s44 offen
    v_perm_b32 v168, v69, v65, s40
    v_perm_b32 v169, v77, v73, s40
    v_mfma_f32_16x16x32_bf16 v[184:187], v[164:167], a[72:75], v[184:187]
    v_perm_b32 v170, v85, v81, s40
    v_perm_b32 v171, v93, v89, s40
    v_mfma_f32_16x16x32_bf16 v[188:191], v[164:167], a[76:79], v[188:191]
    buffer_load_dwordx4 v[36:39], v241, s[20:23], s44 offen
    v_perm_b32 v172, v69, v65, s41
    v_perm_b32 v173, v77, v73, s41
    v_mfma_f32_16x16x32_bf16 v[192:195], v[168:171], a[72:75], v[192:195]
    v_perm_b32 v174, v85, v81, s41
    v_perm_b32 v175, v93, v89, s41
    v_mfma_f32_16x16x32_bf16 v[196:199], v[168:171], a[76:79], v[196:199]
    buffer_load_dwordx4 v[40:43], v242, s[20:23], s44 offen
    v_perm_b32 v160, v70, v66, s40
    v_perm_b32 v161, v78, v74, s40
    v_mfma_f32_16x16x32_bf16 v[200:203], v[172:175], a[72:75], v[200:203]
    v_perm_b32 v162, v86, v82, s40
    v_perm_b32 v163, v94, v90, s40
    v_mfma_f32_16x16x32_bf16 v[204:207], v[172:175], a[76:79], v[204:207]
    buffer_load_dwordx4 v[44:47], v243, s[20:23], s44 offen
    v_perm_b32 v164, v70, v66, s41
    v_perm_b32 v165, v78, v74, s41
    v_mfma_f32_16x16x32_bf16 v[208:211], v[160:163], a[72:75], v[208:211]
    v_perm_b32 v166, v86, v82, s41
    v_perm_b32 v167, v94, v90, s41
    v_mfma_f32_16x16x32_bf16 v[212:215], v[160:163], a[76:79], v[212:215]
    buffer_load_dwordx4 v[48:51], v244, s[20:23], s44 offen
    v_perm_b32 v168, v71, v67, s40
    v_perm_b32 v169, v79, v75, s40
    v_mfma_f32_16x16x32_bf16 v[216:219], v[164:167], a[72:75], v[216:219]
    v_perm_b32 v170, v87, v83, s40
    v_perm_b32 v171, v95, v91, s40
    v_mfma_f32_16x16x32_bf16 v[220:223], v[164:167], a[76:79], v[220:223]
    buffer_load_dwordx4 v[52:55], v245, s[20:23], s44 offen
    v_perm_b32 v172, v71, v67, s41
    v_perm_b32 v173, v79, v75, s41
    v_mfma_f32_16x16x32_bf16 v[224:227], v[168:171], a[72:75], v[224:227]
    v_perm_b32 v174, v87, v83, s41
    v_perm_b32 v175, v95, v91, s41
    v_mfma_f32_16x16x32_bf16 v[228:231], v[168:171], a[76:79], v[228:231]
    buffer_load_dwordx4 v[56:59], v246, s[20:23], s44 offen
    v_mfma_f32_16x16x32_bf16 v[232:235], v[172:175], a[72:75], v[232:235]
    v_mfma_f32_16x16x32_bf16 v[236:239], v[172:175], a[76:79], v[236:239]
    buffer_load_dwordx4 v[60:63], v247, s[20:23], s44 offen
    s_waitcnt vmcnt(16)
    s_waitcnt lgkmcnt(11)
    s_waitcnt lgkmcnt(10)
    v_perm_b32 v160, v100, v96, s40
    v_perm_b32 v161, v108, v104, s40
    v_perm_b32 v162, v116, v112, s40
    v_perm_b32 v163, v124, v120, s40
    v_perm_b32 v164, v100, v96, s41
    v_perm_b32 v165, v108, v104, s41
    v_mfma_f32_16x16x32_bf16 v[176:179], v[160:163], a[80:83], v[176:179]
    v_perm_b32 v166, v116, v112, s41
    v_perm_b32 v167, v124, v120, s41
    v_mfma_f32_16x16x32_bf16 v[180:183], v[160:163], a[84:87], v[180:183]
    s_add_u32 s44, s39, 13
    s_and_b32 s44, s44, 15
    s_lshl_b32 s44, s44, 18
    buffer_load_dwordx4 v[64:67], v240, s[20:23], s44 offen
    v_perm_b32 v168, v101, v97, s40
    v_perm_b32 v169, v109, v105, s40
    v_mfma_f32_16x16x32_bf16 v[184:187], v[164:167], a[80:83], v[184:187]
    v_perm_b32 v170, v117, v113, s40
    v_perm_b32 v171, v125, v121, s40
    v_mfma_f32_16x16x32_bf16 v[188:191], v[164:167], a[84:87], v[188:191]
    buffer_load_dwordx4 v[68:71], v241, s[20:23], s44 offen
    v_perm_b32 v172, v101, v97, s41
    v_perm_b32 v173, v109, v105, s41
    v_mfma_f32_16x16x32_bf16 v[192:195], v[168:171], a[80:83], v[192:195]
    v_perm_b32 v174, v117, v113, s41
    v_perm_b32 v175, v125, v121, s41
    v_mfma_f32_16x16x32_bf16 v[196:199], v[168:171], a[84:87], v[196:199]
    buffer_load_dwordx4 v[72:75], v242, s[20:23], s44 offen
    v_perm_b32 v160, v102, v98, s40
    v_perm_b32 v161, v110, v106, s40
    v_mfma_f32_16x16x32_bf16 v[200:203], v[172:175], a[80:83], v[200:203]
    v_perm_b32 v162, v118, v114, s40
    v_perm_b32 v163, v126, v122, s40
    v_mfma_f32_16x16x32_bf16 v[204:207], v[172:175], a[84:87], v[204:207]
    buffer_load_dwordx4 v[76:79], v243, s[20:23], s44 offen
    v_perm_b32 v164, v102, v98, s41
    v_perm_b32 v165, v110, v106, s41
    v_mfma_f32_16x16x32_bf16 v[208:211], v[160:163], a[80:83], v[208:211]
    v_perm_b32 v166, v118, v114, s41
    v_perm_b32 v167, v126, v122, s41
    v_mfma_f32_16x16x32_bf16 v[212:215], v[160:163], a[84:87], v[212:215]
    buffer_load_dwordx4 v[80:83], v244, s[20:23], s44 offen
    v_perm_b32 v168, v103, v99, s40
    v_perm_b32 v169, v111, v107, s40
    v_mfma_f32_16x16x32_bf16 v[216:219], v[164:167], a[80:83], v[216:219]
    v_perm_b32 v170, v119, v115, s40
    v_perm_b32 v171, v127, v123, s40
    v_mfma_f32_16x16x32_bf16 v[220:223], v[164:167], a[84:87], v[220:223]
    buffer_load_dwordx4 v[84:87], v245, s[20:23], s44 offen
    v_perm_b32 v172, v103, v99, s41
    v_perm_b32 v173, v111, v107, s41
    v_mfma_f32_16x16x32_bf16 v[224:227], v[168:171], a[80:83], v[224:227]
    v_perm_b32 v174, v119, v115, s41
    v_perm_b32 v175, v127, v123, s41
    v_mfma_f32_16x16x32_bf16 v[228:231], v[168:171], a[84:87], v[228:231]
    buffer_load_dwordx4 v[88:91], v246, s[20:23], s44 offen
    v_mfma_f32_16x16x32_bf16 v[232:235], v[172:175], a[80:83], v[232:235]
    v_mfma_f32_16x16x32_bf16 v[236:239], v[172:175], a[84:87], v[236:239]
    buffer_load_dwordx4 v[92:95], v247, s[20:23], s44 offen
    s_waitcnt vmcnt(16)
    s_waitcnt lgkmcnt(9)
    s_waitcnt lgkmcnt(8)
    v_perm_b32 v160, v132, v128, s40
    v_perm_b32 v161, v140, v136, s40
    v_perm_b32 v162, v148, v144, s40
    v_perm_b32 v163, v156, v152, s40
    v_perm_b32 v164, v132, v128, s41
    v_perm_b32 v165, v140, v136, s41
    v_mfma_f32_16x16x32_bf16 v[176:179], v[160:163], a[88:91], v[176:179]
    v_perm_b32 v166, v148, v144, s41
    v_perm_b32 v167, v156, v152, s41
    v_mfma_f32_16x16x32_bf16 v[180:183], v[160:163], a[92:95], v[180:183]
    s_add_u32 s44, s39, 14
    s_and_b32 s44, s44, 15
    s_lshl_b32 s44, s44, 18
    buffer_load_dwordx4 v[96:99], v240, s[20:23], s44 offen
    v_perm_b32 v168, v133, v129, s40
    v_perm_b32 v169, v141, v137, s40
    v_mfma_f32_16x16x32_bf16 v[184:187], v[164:167], a[88:91], v[184:187]
    v_perm_b32 v170, v149, v145, s40
    v_perm_b32 v171, v157, v153, s40
    v_mfma_f32_16x16x32_bf16 v[188:191], v[164:167], a[92:95], v[188:191]
    buffer_load_dwordx4 v[100:103], v241, s[20:23], s44 offen
    v_perm_b32 v172, v133, v129, s41
    v_perm_b32 v173, v141, v137, s41
    v_mfma_f32_16x16x32_bf16 v[192:195], v[168:171], a[88:91], v[192:195]
    v_perm_b32 v174, v149, v145, s41
    v_perm_b32 v175, v157, v153, s41
    v_mfma_f32_16x16x32_bf16 v[196:199], v[168:171], a[92:95], v[196:199]
    buffer_load_dwordx4 v[104:107], v242, s[20:23], s44 offen
    v_perm_b32 v160, v134, v130, s40
    v_perm_b32 v161, v142, v138, s40
    v_mfma_f32_16x16x32_bf16 v[200:203], v[172:175], a[88:91], v[200:203]
    v_perm_b32 v162, v150, v146, s40
    v_perm_b32 v163, v158, v154, s40
    v_mfma_f32_16x16x32_bf16 v[204:207], v[172:175], a[92:95], v[204:207]
    buffer_load_dwordx4 v[108:111], v243, s[20:23], s44 offen
    v_perm_b32 v164, v134, v130, s41
    v_perm_b32 v165, v142, v138, s41
    v_mfma_f32_16x16x32_bf16 v[208:211], v[160:163], a[88:91], v[208:211]
    v_perm_b32 v166, v150, v146, s41
    v_perm_b32 v167, v158, v154, s41
    v_mfma_f32_16x16x32_bf16 v[212:215], v[160:163], a[92:95], v[212:215]
    buffer_load_dwordx4 v[112:115], v244, s[20:23], s44 offen
    v_perm_b32 v168, v135, v131, s40
    v_perm_b32 v169, v143, v139, s40
    v_mfma_f32_16x16x32_bf16 v[216:219], v[164:167], a[88:91], v[216:219]
    v_perm_b32 v170, v151, v147, s40
    v_perm_b32 v171, v159, v155, s40
    v_mfma_f32_16x16x32_bf16 v[220:223], v[164:167], a[92:95], v[220:223]
    buffer_load_dwordx4 v[116:119], v245, s[20:23], s44 offen
    v_perm_b32 v172, v135, v131, s41
    v_perm_b32 v173, v143, v139, s41
    v_mfma_f32_16x16x32_bf16 v[224:227], v[168:171], a[88:91], v[224:227]
    v_perm_b32 v174, v151, v147, s41
    v_perm_b32 v175, v159, v155, s41
    v_mfma_f32_16x16x32_bf16 v[228:231], v[168:171], a[92:95], v[228:231]
    buffer_load_dwordx4 v[120:123], v246, s[20:23], s44 offen
    v_mfma_f32_16x16x32_bf16 v[232:235], v[172:175], a[88:91], v[232:235]
    v_mfma_f32_16x16x32_bf16 v[236:239], v[172:175], a[92:95], v[236:239]
    buffer_load_dwordx4 v[124:127], v247, s[20:23], s44 offen
    s_waitcnt vmcnt(16)
    s_waitcnt lgkmcnt(7)
    s_waitcnt lgkmcnt(6)
    v_perm_b32 v160, v36, v32, s40
    v_perm_b32 v161, v44, v40, s40
    v_perm_b32 v162, v52, v48, s40
    v_perm_b32 v163, v60, v56, s40
    v_perm_b32 v164, v36, v32, s41
    v_perm_b32 v165, v44, v40, s41
    v_mfma_f32_16x16x32_bf16 v[176:179], v[160:163], a[96:99], v[176:179]
    v_perm_b32 v166, v52, v48, s41
    v_perm_b32 v167, v60, v56, s41
    v_mfma_f32_16x16x32_bf16 v[180:183], v[160:163], a[100:103], v[180:183]
    s_add_u32 s44, s39, 15
    s_and_b32 s44, s44, 15
    s_lshl_b32 s44, s44, 18
    buffer_load_dwordx4 v[128:131], v240, s[20:23], s44 offen
    v_perm_b32 v168, v37, v33, s40
    v_perm_b32 v169, v45, v41, s40
    v_mfma_f32_16x16x32_bf16 v[184:187], v[164:167], a[96:99], v[184:187]
    v_perm_b32 v170, v53, v49, s40
    v_perm_b32 v171, v61, v57, s40
    v_mfma_f32_16x16x32_bf16 v[188:191], v[164:167], a[100:103], v[188:191]
    buffer_load_dwordx4 v[132:135], v241, s[20:23], s44 offen
    v_perm_b32 v172, v37, v33, s41
    v_perm_b32 v173, v45, v41, s41
    v_mfma_f32_16x16x32_bf16 v[192:195], v[168:171], a[96:99], v[192:195]
    v_perm_b32 v174, v53, v49, s41
    v_perm_b32 v175, v61, v57, s41
    v_mfma_f32_16x16x32_bf16 v[196:199], v[168:171], a[100:103], v[196:199]
    buffer_load_dwordx4 v[136:139], v242, s[20:23], s44 offen
    v_perm_b32 v160, v38, v34, s40
    v_perm_b32 v161, v46, v42, s40
    v_mfma_f32_16x16x32_bf16 v[200:203], v[172:175], a[96:99], v[200:203]
    v_perm_b32 v162, v54, v50, s40
    v_perm_b32 v163, v62, v58, s40
    v_mfma_f32_16x16x32_bf16 v[204:207], v[172:175], a[100:103], v[204:207]
    buffer_load_dwordx4 v[140:143], v243, s[20:23], s44 offen
    v_perm_b32 v164, v38, v34, s41
    v_perm_b32 v165, v46, v42, s41
    v_mfma_f32_16x16x32_bf16 v[208:211], v[160:163], a[96:99], v[208:211]
    v_perm_b32 v166, v54, v50, s41
    v_perm_b32 v167, v62, v58, s41
    v_mfma_f32_16x16x32_bf16 v[212:215], v[160:163], a[100:103], v[212:215]
    buffer_load_dwordx4 v[144:147], v244, s[20:23], s44 offen
    v_perm_b32 v168, v39, v35, s40
    v_perm_b32 v169, v47, v43, s40
    v_mfma_f32_16x16x32_bf16 v[216:219], v[164:167], a[96:99], v[216:219]
    v_perm_b32 v170, v55, v51, s40
    v_perm_b32 v171, v63, v59, s40
    v_mfma_f32_16x16x32_bf16 v[220:223], v[164:167], a[100:103], v[220:223]
    buffer_load_dwordx4 v[148:151], v245, s[20:23], s44 offen
    v_perm_b32 v172, v39, v35, s41
    v_perm_b32 v173, v47, v43, s41
    v_mfma_f32_16x16x32_bf16 v[224:227], v[168:171], a[96:99], v[224:227]
    v_perm_b32 v174, v55, v51, s41
    v_perm_b32 v175, v63, v59, s41
    v_mfma_f32_16x16x32_bf16 v[228:231], v[168:171], a[100:103], v[228:231]
    buffer_load_dwordx4 v[152:155], v246, s[20:23], s44 offen
    v_mfma_f32_16x16x32_bf16 v[232:235], v[172:175], a[96:99], v[232:235]
    v_mfma_f32_16x16x32_bf16 v[236:239], v[172:175], a[100:103], v[236:239]
    buffer_load_dwordx4 v[156:159], v247, s[20:23], s44 offen
    s_waitcnt vmcnt(16)
    s_waitcnt lgkmcnt(5)
    s_waitcnt lgkmcnt(4)
    v_perm_b32 v160, v68, v64, s40
    v_perm_b32 v161, v76, v72, s40
    v_perm_b32 v162, v84, v80, s40
    v_perm_b32 v163, v92, v88, s40
    v_perm_b32 v164, v68, v64, s41
    v_perm_b32 v165, v76, v72, s41
    v_mfma_f32_16x16x32_bf16 v[176:179], v[160:163], a[104:107], v[176:179]
    v_perm_b32 v166, v84, v80, s41
    v_perm_b32 v167, v92, v88, s41
    v_mfma_f32_16x16x32_bf16 v[180:183], v[160:163], a[108:111], v[180:183]
    v_perm_b32 v168, v69, v65, s40
    v_perm_b32 v169, v77, v73, s40
    v_mfma_f32_16x16x32_bf16 v[184:187], v[164:167], a[104:107], v[184:187]
    v_perm_b32 v170, v85, v81, s40
    v_perm_b32 v171, v93, v89, s40
    v_mfma_f32_16x16x32_bf16 v[188:191], v[164:167], a[108:111], v[188:191]
    s_add_u32 m0, s43, 0
    s_add_u32 s47, s43, 0
    buffer_load_dwordx4 v2, s[12:15], s47 offen nt lds
    v_perm_b32 v172, v69, v65, s41
    v_perm_b32 v173, v77, v73, s41
    v_mfma_f32_16x16x32_bf16 v[192:195], v[168:171], a[104:107], v[192:195]
    v_perm_b32 v174, v85, v81, s41
    v_perm_b32 v175, v93, v89, s41
    v_mfma_f32_16x16x32_bf16 v[196:199], v[168:171], a[108:111], v[196:199]
    v_perm_b32 v160, v70, v66, s40
    v_perm_b32 v161, v78, v74, s40
    v_mfma_f32_16x16x32_bf16 v[200:203], v[172:175], a[104:107], v[200:203]
    v_perm_b32 v162, v86, v82, s40
    v_perm_b32 v163, v94, v90, s40
    v_mfma_f32_16x16x32_bf16 v[204:207], v[172:175], a[108:111], v[204:207]
    buffer_load_dwordx4 v3, s[12:15], s47 offen offset:1024 nt lds
    v_perm_b32 v164, v70, v66, s41
    v_perm_b32 v165, v78, v74, s41
    v_mfma_f32_16x16x32_bf16 v[208:211], v[160:163], a[104:107], v[208:211]
    v_perm_b32 v166, v86, v82, s41
    v_perm_b32 v167, v94, v90, s41
    v_mfma_f32_16x16x32_bf16 v[212:215], v[160:163], a[108:111], v[212:215]
    v_perm_b32 v168, v71, v67, s40
    v_perm_b32 v169, v79, v75, s40
    v_mfma_f32_16x16x32_bf16 v[216:219], v[164:167], a[104:107], v[216:219]
    v_perm_b32 v170, v87, v83, s40
    v_perm_b32 v171, v95, v91, s40
    v_mfma_f32_16x16x32_bf16 v[220:223], v[164:167], a[108:111], v[220:223]
    buffer_load_dwordx4 v4, s[12:15], s47 offen offset:2048 nt lds
    v_perm_b32 v172, v71, v67, s41
    v_perm_b32 v173, v79, v75, s41
    v_mfma_f32_16x16x32_bf16 v[224:227], v[168:171], a[104:107], v[224:227]
    v_perm_b32 v174, v87, v83, s41
    v_perm_b32 v175, v95, v91, s41
    v_mfma_f32_16x16x32_bf16 v[228:231], v[168:171], a[108:111], v[228:231]
    s_nop 0
    v_mfma_f32_16x16x32_bf16 v[232:235], v[172:175], a[104:107], v[232:235]
    v_mfma_f32_16x16x32_bf16 v[236:239], v[172:175], a[108:111], v[236:239]
    buffer_load_dwordx4 v5, s[12:15], s47 offen offset:3072 nt lds
    s_waitcnt vmcnt(12)
    s_waitcnt lgkmcnt(3)
    s_waitcnt lgkmcnt(2)
    v_perm_b32 v160, v100, v96, s40
    v_perm_b32 v161, v108, v104, s40
    v_perm_b32 v162, v116, v112, s40
    v_perm_b32 v163, v124, v120, s40
    v_perm_b32 v164, v100, v96, s41
    v_perm_b32 v165, v108, v104, s41
    v_mfma_f32_16x16x32_bf16 v[176:179], v[160:163], a[112:115], v[176:179]
    v_perm_b32 v166, v116, v112, s41
    v_perm_b32 v167, v124, v120, s41
    v_mfma_f32_16x16x32_bf16 v[180:183], v[160:163], a[116:119], v[180:183]
    v_perm_b32 v168, v101, v97, s40
    v_perm_b32 v169, v109, v105, s40
    v_mfma_f32_16x16x32_bf16 v[184:187], v[164:167], a[112:115], v[184:187]
    v_perm_b32 v170, v117, v113, s40
    v_perm_b32 v171, v125, v121, s40
    v_mfma_f32_16x16x32_bf16 v[188:191], v[164:167], a[116:119], v[188:191]
    s_add_u32 m0, s43, 16384
    s_add_u32 s47, s43, 16384
    buffer_load_dwordx4 v2, s[12:15], s47 offen nt lds
    v_perm_b32 v172, v101, v97, s41
    v_perm_b32 v173, v109, v105, s41
    v_mfma_f32_16x16x32_bf16 v[192:195], v[168:171], a[112:115], v[192:195]
    v_perm_b32 v174, v117, v113, s41
    v_perm_b32 v175, v125, v121, s41
    v_mfma_f32_16x16x32_bf16 v[196:199], v[168:171], a[116:119], v[196:199]
    v_perm_b32 v160, v102, v98, s40
    v_perm_b32 v161, v110, v106, s40
    v_mfma_f32_16x16x32_bf16 v[200:203], v[172:175], a[112:115], v[200:203]
    v_perm_b32 v162, v118, v114, s40
    v_perm_b32 v163, v126, v122, s40
    v_mfma_f32_16x16x32_bf16 v[204:207], v[172:175], a[116:119], v[204:207]
    buffer_load_dwordx4 v3, s[12:15], s47 offen offset:1024 nt lds
    v_perm_b32 v164, v102, v98, s41
    v_perm_b32 v165, v110, v106, s41
    v_mfma_f32_16x16x32_bf16 v[208:211], v[160:163], a[112:115], v[208:211]
    v_perm_b32 v166, v118, v114, s41
    v_perm_b32 v167, v126, v122, s41
    v_mfma_f32_16x16x32_bf16 v[212:215], v[160:163], a[116:119], v[212:215]
    v_perm_b32 v168, v103, v99, s40
    v_perm_b32 v169, v111, v107, s40
    v_mfma_f32_16x16x32_bf16 v[216:219], v[164:167], a[112:115], v[216:219]
    v_perm_b32 v170, v119, v115, s40
    v_perm_b32 v171, v127, v123, s40
    v_mfma_f32_16x16x32_bf16 v[220:223], v[164:167], a[116:119], v[220:223]
    buffer_load_dwordx4 v4, s[12:15], s47 offen offset:2048 nt lds
    v_perm_b32 v172, v103, v99, s41
    v_perm_b32 v173, v111, v107, s41
    v_mfma_f32_16x16x32_bf16 v[224:227], v[168:171], a[112:115], v[224:227]
    v_perm_b32 v174, v119, v115, s41
    v_perm_b32 v175, v127, v123, s41
    v_mfma_f32_16x16x32_bf16 v[228:231], v[168:171], a[116:119], v[228:231]
    s_nop 0
    v_mfma_f32_16x16x32_bf16 v[232:235], v[172:175], a[112:115], v[232:235]
    v_mfma_f32_16x16x32_bf16 v[236:239], v[172:175], a[116:119], v[236:239]
    buffer_load_dwordx4 v5, s[12:15], s47 offen offset:3072 nt lds
    s_waitcnt vmcnt(8)
    s_waitcnt lgkmcnt(1)
    s_waitcnt lgkmcnt(0)
    v_perm_b32 v160, v132, v128, s40
    v_perm_b32 v161, v140, v136, s40
    v_perm_b32 v162, v148, v144, s40
    v_perm_b32 v163, v156, v152, s40
    v_perm_b32 v164, v132, v128, s41
    v_perm_b32 v165, v140, v136, s41
    v_mfma_f32_16x16x32_bf16 v[176:179], v[160:163], a[120:123], v[176:179]
    v_perm_b32 v166, v148, v144, s41
    v_perm_b32 v167, v156, v152, s41
    v_mfma_f32_16x16x32_bf16 v[180:183], v[160:163], a[124:127], v[180:183]
    v_perm_b32 v168, v133, v129, s40
    v_perm_b32 v169, v141, v137, s40
    v_mfma_f32_16x16x32_bf16 v[184:187], v[164:167], a[120:123], v[184:187]
    v_perm_b32 v170, v149, v145, s40
    v_perm_b32 v171, v157, v153, s40
    v_mfma_f32_16x16x32_bf16 v[188:191], v[164:167], a[124:127], v[188:191]
    s_add_u32 m0, s43, 49152
    s_add_u32 s47, s43, 0
    buffer_load_dwordx4 v6, s[16:19], s47 offen nt lds
    v_perm_b32 v172, v133, v129, s41
    v_perm_b32 v173, v141, v137, s41
    v_mfma_f32_16x16x32_bf16 v[192:195], v[168:171], a[120:123], v[192:195]
    v_perm_b32 v174, v149, v145, s41
    v_perm_b32 v175, v157, v153, s41
    v_mfma_f32_16x16x32_bf16 v[196:199], v[168:171], a[124:127], v[196:199]
    v_perm_b32 v160, v134, v130, s40
    v_perm_b32 v161, v142, v138, s40
    v_mfma_f32_16x16x32_bf16 v[200:203], v[172:175], a[120:123], v[200:203]
    v_perm_b32 v162, v150, v146, s40
    v_perm_b32 v163, v158, v154, s40
    v_mfma_f32_16x16x32_bf16 v[204:207], v[172:175], a[124:127], v[204:207]
    buffer_load_dwordx4 v6, s[16:19], s47 offen offset:1024 nt lds
    v_perm_b32 v164, v134, v130, s41
    v_perm_b32 v165, v142, v138, s41
    v_mfma_f32_16x16x32_bf16 v[208:211], v[160:163], a[120:123], v[208:211]
    v_perm_b32 v166, v150, v146, s41
    v_perm_b32 v167, v158, v154, s41
    v_mfma_f32_16x16x32_bf16 v[212:215], v[160:163], a[124:127], v[212:215]
    v_perm_b32 v168, v135, v131, s40
    v_perm_b32 v169, v143, v139, s40
    v_mfma_f32_16x16x32_bf16 v[216:219], v[164:167], a[120:123], v[216:219]
    v_perm_b32 v170, v151, v147, s40
    v_perm_b32 v171, v159, v155, s40
    v_mfma_f32_16x16x32_bf16 v[220:223], v[164:167], a[124:127], v[220:223]
    buffer_load_dwordx4 v6, s[16:19], s47 offen offset:2048 nt lds
    v_perm_b32 v172, v135, v131, s41
    v_perm_b32 v173, v143, v139, s41
    v_mfma_f32_16x16x32_bf16 v[224:227], v[168:171], a[120:123], v[224:227]
    v_perm_b32 v174, v151, v147, s41
    v_perm_b32 v175, v159, v155, s41
    v_mfma_f32_16x16x32_bf16 v[228:231], v[168:171], a[124:127], v[228:231]
    s_nop 0
    v_mfma_f32_16x16x32_bf16 v[232:235], v[172:175], a[120:123], v[232:235]
    v_mfma_f32_16x16x32_bf16 v[236:239], v[172:175], a[124:127], v[236:239]
    buffer_load_dwordx4 v6, s[16:19], s47 offen offset:3072 nt lds
    v_mul_f32 v176, s42, v176
    v_mul_f32 v177, s42, v177
    v_mul_f32 v178, s42, v178
    v_mul_f32 v179, s42, v179
    v_mul_f32 v180, s42, v180
    v_mul_f32 v181, s42, v181
    v_mul_f32 v182, s42, v182
    v_mul_f32 v183, s42, v183
    v_mul_f32 v184, s42, v184
    v_mul_f32 v185, s42, v185
    v_mul_f32 v186, s42, v186
    v_mul_f32 v187, s42, v187
    v_mul_f32 v188, s42, v188
    v_mul_f32 v189, s42, v189
    v_mul_f32 v190, s42, v190
    v_mul_f32 v191, s42, v191
    s_add_u32 m0, s43, 32768
    s_add_u32 s47, s43, 32768
    buffer_load_dwordx4 v2, s[12:15], s47 offen nt lds
    v_mul_f32 v192, s42, v192
    v_mul_f32 v193, s42, v193
    v_mul_f32 v194, s42, v194
    v_mul_f32 v195, s42, v195
    v_mul_f32 v196, s42, v196
    v_mul_f32 v197, s42, v197
    v_mul_f32 v198, s42, v198
    v_mul_f32 v199, s42, v199
    v_mul_f32 v200, s42, v200
    v_mul_f32 v201, s42, v201
    v_mul_f32 v202, s42, v202
    v_mul_f32 v203, s42, v203
    v_mul_f32 v204, s42, v204
    v_mul_f32 v205, s42, v205
    v_mul_f32 v206, s42, v206
    v_mul_f32 v207, s42, v207
    buffer_load_dwordx4 v3, s[12:15], s47 offen offset:1024 nt lds
    v_mul_f32 v208, s42, v208
    v_mul_f32 v209, s42, v209
    v_mul_f32 v210, s42, v210
    v_mul_f32 v211, s42, v211
    v_mul_f32 v212, s42, v212
    v_mul_f32 v213, s42, v213
    v_mul_f32 v214, s42, v214
    v_mul_f32 v215, s42, v215
    v_mul_f32 v216, s42, v216
    v_mul_f32 v217, s42, v217
    v_mul_f32 v218, s42, v218
    v_mul_f32 v219, s42, v219
    v_mul_f32 v220, s42, v220
    v_mul_f32 v221, s42, v221
    v_mul_f32 v222, s42, v222
    v_mul_f32 v223, s42, v223
    buffer_load_dwordx4 v4, s[12:15], s47 offen offset:2048 nt lds
    v_mul_f32 v224, s42, v224
    v_mul_f32 v225, s42, v225
    v_mul_f32 v226, s42, v226
    v_mul_f32 v227, s42, v227
    v_mul_f32 v228, s42, v228
    v_mul_f32 v229, s42, v229
    v_mul_f32 v230, s42, v230
    v_mul_f32 v231, s42, v231
    v_mul_f32 v232, s42, v232
    v_mul_f32 v233, s42, v233
    v_mul_f32 v234, s42, v234
    v_mul_f32 v235, s42, v235
    v_mul_f32 v236, s42, v236
    v_mul_f32 v237, s42, v237
    v_mul_f32 v238, s42, v238
    v_mul_f32 v239, s42, v239
    buffer_load_dwordx4 v5, s[12:15], s47 offen offset:3072 nt lds
    v_cvt_pk_bf16_f32 v32, v176, v184
    v_cvt_pk_bf16_f32 v36, v180, v188
    v_cvt_pk_bf16_f32 v33, v192, v200
    v_cvt_pk_bf16_f32 v37, v196, v204
    v_cvt_pk_bf16_f32 v34, v208, v216
    v_cvt_pk_bf16_f32 v38, v212, v220
    v_cvt_pk_bf16_f32 v35, v224, v232
    v_cvt_pk_bf16_f32 v39, v228, v236
    v_cvt_pk_bf16_f32 v40, v177, v185
    v_cvt_pk_bf16_f32 v44, v181, v189
    v_cvt_pk_bf16_f32 v41, v193, v201
    v_cvt_pk_bf16_f32 v45, v197, v205
    v_cvt_pk_bf16_f32 v42, v209, v217
    v_cvt_pk_bf16_f32 v46, v213, v221
    v_cvt_pk_bf16_f32 v43, v225, v233
    v_cvt_pk_bf16_f32 v47, v229, v237
    v_cvt_pk_bf16_f32 v48, v178, v186
    v_cvt_pk_bf16_f32 v52, v182, v190
    v_cvt_pk_bf16_f32 v49, v194, v202
    v_cvt_pk_bf16_f32 v53, v198, v206
    v_cvt_pk_bf16_f32 v50, v210, v218
    v_cvt_pk_bf16_f32 v54, v214, v222
    v_cvt_pk_bf16_f32 v51, v226, v234
    v_cvt_pk_bf16_f32 v55, v230, v238
    v_cvt_pk_bf16_f32 v56, v179, v187
    v_cvt_pk_bf16_f32 v60, v183, v191
    v_cvt_pk_bf16_f32 v57, v195, v203
    v_cvt_pk_bf16_f32 v61, v199, v207
    v_cvt_pk_bf16_f32 v58, v211, v219
    v_cvt_pk_bf16_f32 v62, v215, v223
    v_cvt_pk_bf16_f32 v59, v227, v235
    v_cvt_pk_bf16_f32 v63, v231, v239
    v_permlane16_swap_b32 v32, v36
    v_permlane16_swap_b32 v33, v37
    v_permlane16_swap_b32 v34, v38
    v_permlane16_swap_b32 v35, v39
    v_permlane16_swap_b32 v40, v44
    v_permlane16_swap_b32 v41, v45
    v_permlane16_swap_b32 v42, v46
    v_permlane16_swap_b32 v43, v47
    v_permlane16_swap_b32 v48, v52
    v_permlane16_swap_b32 v49, v53
    v_permlane16_swap_b32 v50, v54
    v_permlane16_swap_b32 v51, v55
    v_permlane16_swap_b32 v56, v60
    v_permlane16_swap_b32 v57, v61
    v_permlane16_swap_b32 v58, v62
    v_permlane16_swap_b32 v59, v63
    v_accvgpr_write_b32 a128, v32
    v_accvgpr_write_b32 a144, v36
    v_accvgpr_write_b32 a129, v33
    v_accvgpr_write_b32 a145, v37
    v_accvgpr_write_b32 a130, v34
    v_accvgpr_write_b32 a146, v38
    v_accvgpr_write_b32 a131, v35
    v_accvgpr_write_b32 a147, v39
    v_accvgpr_write_b32 a132, v40
    v_accvgpr_write_b32 a148, v44
    v_accvgpr_write_b32 a133, v41
    v_accvgpr_write_b32 a149, v45
    v_accvgpr_write_b32 a134, v42
    v_accvgpr_write_b32 a150, v46
    v_accvgpr_write_b32 a135, v43
    v_accvgpr_write_b32 a151, v47
    v_accvgpr_write_b32 a136, v48
    v_accvgpr_write_b32 a152, v52
    v_accvgpr_write_b32 a137, v49
    v_accvgpr_write_b32 a153, v53
    v_accvgpr_write_b32 a138, v50
    v_accvgpr_write_b32 a154, v54
    v_accvgpr_write_b32 a139, v51
    v_accvgpr_write_b32 a155, v55
    v_accvgpr_write_b32 a140, v56
    v_accvgpr_write_b32 a156, v60
    v_accvgpr_write_b32 a141, v57
    v_accvgpr_write_b32 a157, v61
    v_accvgpr_write_b32 a142, v58
    v_accvgpr_write_b32 a158, v62
    v_accvgpr_write_b32 a143, v59
    v_accvgpr_write_b32 a159, v63
L_qdone:
    s_nop 15
    v_add_u32 v216, 65536, v16
    v_add_u32 v220, 131072, v16
    v_add_u32 v217, 65536, v17
    v_add_u32 v221, 131072, v17
    v_add_u32 v218, 65536, v18
    v_add_u32 v222, 131072, v18
    v_add_u32 v219, 65536, v19
    v_add_u32 v223, 131072, v19
    s_waitcnt vmcnt(8)
    s_barrier
    ds_read_b128 a[0:3], v8 offset:0
    ds_read_b128 a[4:7], v9 offset:0
    ds_read_b128 a[8:11], v10 offset:0
    ds_read_b128 a[12:15], v11 offset:0
    ds_read_b128 a[16:19], v12 offset:0
    ds_read_b128 a[20:23], v13 offset:0
    ds_read_b128 a[24:27], v14 offset:0
    ds_read_b128 a[28:31], v15 offset:0
    s_waitcnt lgkmcnt(4)
    v_mfma_f32_32x32x16_bf16 v[32:47], a[0:3], a[128:131], 0
    ds_read_b128 a[32:35], v8 offset:8192
    s_cmp_eq_u32 s35, 0
    s_cbranch_scc1 L_cd1
    s_add_u32 m0, s43, 81920
    s_add_u32 s47, s43, 16384
    buffer_load_dwordx4 v6, s[16:19], s47 offen nt lds
    buffer_load_dwordx4 v6, s[16:19], s47 offen offset:1024 nt lds
    buffer_load_dwordx4 v6, s[16:19], s47 offen offset:2048 nt lds
    buffer_load_dwordx4 v6, s[16:19], s47 offen offset:3072 nt lds
L_cd1:
    v_mfma_f32_32x32x16_bf16 v[32:47], a[4:7], a[132:135], v[32:47]
    ds_read_b128 a[36:39], v9 offset:8192
    v_mfma_f32_32x32x16_bf16 v[32:47], a[8:11], a[136:139], v[32:47]
    ds_read_b128 a[40:43], v10 offset:8192
    v_mfma_f32_32x32x16_bf16 v[32:47], a[12:15], a[140:143], v[32:47]
    ds_read_b128 a[44:47], v11 offset:8192
    s_waitcnt lgkmcnt(4)
    v_mfma_f32_32x32x16_bf16 v[32:47], a[16:19], a[144:147], v[32:47]
    ds_read_b128 a[0:3], v12 offset:8192
    v_mfma_f32_32x32x16_bf16 v[32:47], a[20:23], a[148:151], v[32:47]
    ds_read_b128 a[4:7], v13 offset:8192
    v_mfma_f32_32x32x16_bf16 v[32:47], a[24:27], a[152:155], v[32:47]
    ds_read_b128 a[8:11], v14 offset:8192
    v_mfma_f32_32x32x16_bf16 v[32:47], a[28:31], a[156:159], v[32:47]
    ds_read_b128 a[12:15], v15 offset:8192
    s_waitcnt lgkmcnt(4)
    v_mfma_f32_32x32x16_bf16 v[48:63], a[32:35], a[128:131], 0
    ds_read_b128 a[16:19], v8 offset:16384
    s_cmp_eq_u32 s35, 0
    s_cbranch_scc1 L_cd2
    s_add_u32 m0, s43, 65536
    s_add_u32 s47, s43, 49152
    buffer_load_dwordx4 v2, s[12:15], s47 offen nt lds
    buffer_load_dwordx4 v3, s[12:15], s47 offen offset:1024 nt lds
    buffer_load_dwordx4 v4, s[12:15], s47 offen offset:2048 nt lds
    buffer_load_dwordx4 v5, s[12:15], s47 offen offset:3072 nt lds
L_cd2:
    s_nop 5
    v_max_f32 v26, v32, v33
    v_max3_f32 v26, v26, v34, v35
    v_max3_f32 v26, v26, v36, v37
    v_max3_f32 v26, v26, v38, v39
    v_mfma_f32_32x32x16_bf16 v[48:63], a[36:39], a[132:135], v[48:63]
    ds_read_b128 a[20:23], v9 offset:16384
    v_max3_f32 v26, v26, v40, v41
    v_mfma_f32_32x32x16_bf16 v[48:63], a[40:43], a[136:139], v[48:63]
    ds_read_b128 a[24:27], v10 offset:16384
    v_mfma_f32_32x32x16_bf16 v[48:63], a[44:47], a[140:143], v[48:63]
    ds_read_b128 a[28:31], v11 offset:16384
    v_max3_f32 v26, v26, v42, v43
    s_waitcnt lgkmcnt(4)
    v_mfma_f32_32x32x16_bf16 v[48:63], a[0:3], a[144:147], v[48:63]
    ds_read_b128 a[32:35], v12 offset:16384
    v_mfma_f32_32x32x16_bf16 v[48:63], a[4:7], a[148:151], v[48:63]
    ds_read_b128 a[36:39], v13 offset:16384
    v_max3_f32 v26, v26, v44, v45
    v_mfma_f32_32x32x16_bf16 v[48:63], a[8:11], a[152:155], v[48:63]
    ds_read_b128 a[40:43], v14 offset:16384
    v_mfma_f32_32x32x16_bf16 v[48:63], a[12:15], a[156:159], v[48:63]
    ds_read_b128 a[44:47], v15 offset:16384
    v_max3_f32 v26, v26, v46, v47
    s_waitcnt lgkmcnt(4)
    v_mfma_f32_32x32x16_bf16 v[64:79], a[16:19], a[128:131], 0
    ds_read_b128 a[0:3], v8 offset:24576
    s_cmp_eq_u32 s35, 0
    s_cbranch_scc1 L_cd3
    s_add_u32 m0, s43, 114688
    s_add_u32 s47, s43, 32768
    buffer_load_dwordx4 v6, s[16:19], s47 offen nt lds
    buffer_load_dwordx4 v6, s[16:19], s47 offen offset:1024 nt lds
    buffer_load_dwordx4 v6, s[16:19], s47 offen offset:2048 nt lds
    buffer_load_dwordx4 v6, s[16:19], s47 offen offset:3072 nt lds
L_cd3:
    s_nop 4
    v_max3_f32 v26, v26, v48, v49
    v_max3_f32 v26, v26, v50, v51
    v_max3_f32 v26, v26, v52, v53
    v_max3_f32 v26, v26, v54, v55
    v_max3_f32 v26, v26, v56, v57
    v_max3_f32 v26, v26, v58, v59
    v_max3_f32 v26, v26, v60, v61
    v_max3_f32 v26, v26, v62, v63
    v_mov_b32 v27, v26
    s_nop 1
    v_permlane32_swap_b32 v26, v27
    v_max_f32 v26, v26, v27
    v_sub_f32 v192, 0, v26
    v_mfma_f32_32x32x16_bf16 v[64:79], a[20:23], a[132:135], v[64:79]
    ds_read_b128 a[4:7], v9 offset:24576
    v_sub_f32 v193, 0, v26
    v_sub_f32 v194, 0, v26
    v_sub_f32 v195, 0, v26
    v_sub_f32 v196, 0, v26
    v_sub_f32 v197, 0, v26
    v_sub_f32 v198, 0, v26
    v_sub_f32 v199, 0, v26
    v_sub_f32 v200, 0, v26
    v_sub_f32 v201, 0, v26
    v_sub_f32 v202, 0, v26
    v_sub_f32 v203, 0, v26
    v_sub_f32 v204, 0, v26
    v_mfma_f32_32x32x16_bf16 v[64:79], a[24:27], a[136:139], v[64:79]
    ds_read_b128 a[8:11], v10 offset:24576
    v_sub_f32 v205, 0, v26
    v_sub_f32 v206, 0, v26
    v_sub_f32 v207, 0, v26
    v_mov_b32 v24, 0
    v_add_f32 v210, v192, v32
    v_add_f32 v211, v192, v33
    v_exp_f32 v210, v210
    v_exp_f32 v211, v211
    s_nop 0
    v_add_f32 v208, v210, v211
    v_cvt_pk_bf16_f32 v96, v210, v211
    v_add_f32 v212, v192, v34
    v_mfma_f32_32x32x16_bf16 v[64:79], a[28:31], a[140:143], v[64:79]
    ds_read_b128 a[12:15], v11 offset:24576
    v_add_f32 v213, v192, v35
    v_exp_f32 v212, v212
    v_exp_f32 v213, v213
    v_add_f32 v208, v208, v212
    v_add_f32 v208, v208, v213
    v_cvt_pk_bf16_f32 v97, v212, v213
    v_add_f32 v210, v192, v36
    v_add_f32 v211, v192, v37
    v_exp_f32 v210, v210
    s_waitcnt lgkmcnt(4)
    v_mfma_f32_32x32x16_bf16 v[64:79], a[32:35], a[144:147], v[64:79]
    ds_read_b128 a[16:19], v12 offset:24576
    v_exp_f32 v211, v211
    v_add_f32 v208, v208, v210
    v_add_f32 v208, v208, v211
    v_cvt_pk_bf16_f32 v98, v210, v211
    v_add_f32 v212, v192, v38
    v_add_f32 v213, v192, v39
    v_exp_f32 v212, v212
    v_exp_f32 v213, v213
    v_add_f32 v208, v208, v212
    v_add_f32 v208, v208, v213
    v_cvt_pk_bf16_f32 v99, v212, v213
    v_mfma_f32_32x32x16_bf16 v[64:79], a[36:39], a[148:151], v[64:79]
    ds_read_b128 a[20:23], v13 offset:24576
    v_add_f32 v210, v192, v40
    v_add_f32 v211, v192, v41
    v_exp_f32 v210, v210
    v_exp_f32 v211, v211
    v_add_f32 v208, v208, v210
    v_add_f32 v208, v208, v211
    v_cvt_pk_bf16_f32 v100, v210, v211
    v_add_f32 v212, v192, v42
    v_add_f32 v213, v192, v43
    v_exp_f32 v212, v212
    v_mfma_f32_32x32x16_bf16 v[64:79], a[40:43], a[152:155], v[64:79]
    ds_read_b128 a[24:27], v14 offset:24576
    v_exp_f32 v213, v213
    v_add_f32 v208, v208, v212
    v_add_f32 v208, v208, v213
    v_cvt_pk_bf16_f32 v101, v212, v213
    v_add_f32 v210, v192, v44
    v_add_f32 v211, v192, v45
    v_exp_f32 v210, v210
    v_exp_f32 v211, v211
    v_add_f32 v208, v208, v210
    v_mfma_f32_32x32x16_bf16 v[64:79], a[44:47], a[156:159], v[64:79]
    ds_read_b128 a[28:31], v15 offset:24576
    v_add_f32 v208, v208, v211
    v_cvt_pk_bf16_f32 v102, v210, v211
    v_add_f32 v212, v192, v46
    v_add_f32 v213, v192, v47
    v_exp_f32 v212, v212
    v_exp_f32 v213, v213
    v_add_f32 v208, v208, v212
    v_add_f32 v208, v208, v213
    v_cvt_pk_bf16_f32 v103, v212, v213
    v_add_f32 v210, v192, v48
    s_waitcnt vmcnt(16)
    s_waitcnt vmcnt(12)
    s_barrier
    s_waitcnt lgkmcnt(4)
    v_mfma_f32_32x32x16_bf16 v[80:95], a[0:3], a[128:131], v[192:207]
    ds_read_b64_tr_b16 a[32:33], v16 offset:49152
    ds_read_b64_tr_b16 a[34:35], v16 offset:51200
    s_cmp_eq_u32 s35, 0
    s_cbranch_scc1 L_cd4
    s_add_u32 m0, s43, 98304
    s_add_u32 s47, s43, 65536
    buffer_load_dwordx4 v2, s[12:15], s47 offen nt lds
    buffer_load_dwordx4 v3, s[12:15], s47 offen offset:1024 nt lds
    buffer_load_dwordx4 v4, s[12:15], s47 offen offset:2048 nt lds
    buffer_load_dwordx4 v5, s[12:15], s47 offen offset:3072 nt lds
L_cd4:
    v_add_f32 v211, v192, v49
    v_exp_f32 v210, v210
    v_exp_f32 v211, v211
    v_add_f32 v208, v208, v210
    v_add_f32 v208, v208, v211
    v_cvt_pk_bf16_f32 v104, v210, v211
    v_add_f32 v212, v192, v50
    v_add_f32 v213, v192, v51
    v_mfma_f32_32x32x16_bf16 v[80:95], a[4:7], a[132:135], v[80:95]
    ds_read_b64_tr_b16 a[36:37], v16 offset:53248
    ds_read_b64_tr_b16 a[38:39], v16 offset:55296
    v_exp_f32 v212, v212
    v_exp_f32 v213, v213
    v_add_f32 v208, v208, v212
    v_add_f32 v208, v208, v213
    v_cvt_pk_bf16_f32 v105, v212, v213
    v_add_f32 v210, v192, v52
    v_add_f32 v211, v192, v53
    v_exp_f32 v210, v210
    v_mfma_f32_32x32x16_bf16 v[80:95], a[8:11], a[136:139], v[80:95]
    ds_read_b64_tr_b16 a[40:41], v16 offset:57344
    ds_read_b64_tr_b16 a[42:43], v16 offset:59392
    v_exp_f32 v211, v211
    v_add_f32 v208, v208, v210
    v_add_f32 v208, v208, v211
    v_cvt_pk_bf16_f32 v106, v210, v211
    v_add_f32 v212, v192, v54
    v_add_f32 v213, v192, v55
    v_exp_f32 v212, v212
    v_exp_f32 v213, v213
    v_add_f32 v208, v208, v212
    v_mfma_f32_32x32x16_bf16 v[80:95], a[12:15], a[140:143], v[80:95]
    ds_read_b64_tr_b16 a[44:45], v16 offset:61440
    ds_read_b64_tr_b16 a[46:47], v16 offset:63488
    v_add_f32 v208, v208, v213
    v_cvt_pk_bf16_f32 v107, v212, v213
    v_add_f32 v210, v192, v56
    v_add_f32 v211, v192, v57
    v_exp_f32 v210, v210
    v_exp_f32 v211, v211
    v_add_f32 v208, v208, v210
    v_add_f32 v208, v208, v211
    v_cvt_pk_bf16_f32 v108, v210, v211
    s_waitcnt lgkmcnt(8)
    v_mfma_f32_32x32x16_bf16 v[80:95], a[16:19], a[144:147], v[80:95]
    ds_read_b64_tr_b16 a[0:1], v17 offset:49152
    ds_read_b64_tr_b16 a[2:3], v17 offset:51200
    v_add_f32 v212, v192, v58
    v_add_f32 v213, v192, v59
    v_exp_f32 v212, v212
    v_exp_f32 v213, v213
    v_add_f32 v208, v208, v212
    v_add_f32 v208, v208, v213
    v_cvt_pk_bf16_f32 v109, v212, v213
    v_add_f32 v210, v192, v60
    v_add_f32 v211, v192, v61
    v_mfma_f32_32x32x16_bf16 v[80:95], a[20:23], a[148:151], v[80:95]
    ds_read_b64_tr_b16 a[4:5], v17 offset:53248
    ds_read_b64_tr_b16 a[6:7], v17 offset:55296
    v_exp_f32 v210, v210
    v_exp_f32 v211, v211
    v_add_f32 v208, v208, v210
    v_add_f32 v208, v208, v211
    v_cvt_pk_bf16_f32 v110, v210, v211
    v_add_f32 v212, v192, v62
    v_add_f32 v213, v192, v63
    v_exp_f32 v212, v212
    v_mfma_f32_32x32x16_bf16 v[80:95], a[24:27], a[152:155], v[80:95]
    ds_read_b64_tr_b16 a[8:9], v17 offset:57344
    ds_read_b64_tr_b16 a[10:11], v17 offset:59392
    v_exp_f32 v213, v213
    v_add_f32 v208, v208, v212
    v_add_f32 v208, v208, v213
    v_cvt_pk_bf16_f32 v111, v212, v213
    v_mov_b32 v24, v208
    v_add_f32 v64, v192, v64
    v_add_f32 v65, v192, v65
    v_add_f32 v66, v192, v66
    v_add_f32 v67, v192, v67
    v_add_f32 v68, v192, v68
    v_mfma_f32_32x32x16_bf16 v[80:95], a[28:31], a[156:159], v[80:95]
    ds_read_b64_tr_b16 a[12:13], v17 offset:61440
    ds_read_b64_tr_b16 a[14:15], v17 offset:63488
    v_add_f32 v69, v192, v69
    v_add_f32 v70, v192, v70
    v_add_f32 v71, v192, v71
    v_add_f32 v72, v192, v72
    v_add_f32 v73, v192, v73
    v_add_f32 v74, v192, v74
    v_add_f32 v75, v192, v75
    v_add_f32 v76, v192, v76
    v_add_f32 v77, v192, v77
    v_add_f32 v78, v192, v78
    v_add_f32 v79, v192, v79
    s_waitcnt lgkmcnt(8)
    v_mfma_f32_32x32x16_bf16 v[128:143], a[32:35], v[96:99], 0
    ds_read_b64_tr_b16 a[16:17], v18 offset:49152
    ds_read_b64_tr_b16 a[18:19], v18 offset:51200
    s_add_u32 m0, s43, 147456
    s_add_u32 s47, s43, 49152
    buffer_load_dwordx4 v6, s[16:19], s47 offen nt lds
    v_exp_f32 v210, v64
    v_mfma_f32_32x32x16_bf16 v[128:143], a[36:39], v[100:103], v[128:143]
    ds_read_b64_tr_b16 a[20:21], v18 offset:53248
    ds_read_b64_tr_b16 a[22:23], v18 offset:55296
    v_exp_f32 v211, v65
    s_nop 0
    v_add_f32 v208, v210, v211
    v_cvt_pk_bf16_f32 v112, v210, v211
    v_mfma_f32_32x32x16_bf16 v[128:143], a[40:43], v[104:107], v[128:143]
    ds_read_b64_tr_b16 a[24:25], v18 offset:57344
    ds_read_b64_tr_b16 a[26:27], v18 offset:59392
    buffer_load_dwordx4 v6, s[16:19], s47 offen offset:1024 nt lds
    v_exp_f32 v212, v66
    v_exp_f32 v213, v67
    v_mfma_f32_32x32x16_bf16 v[128:143], a[44:47], v[108:111], v[128:143]
    ds_read_b64_tr_b16 a[28:29], v18 offset:61440
    ds_read_b64_tr_b16 a[30:31], v18 offset:63488
    v_add_f32 v208, v208, v212
    v_add_f32 v208, v208, v213
    v_cvt_pk_bf16_f32 v113, v212, v213
    s_waitcnt lgkmcnt(8)
    v_mfma_f32_32x32x16_bf16 v[144:159], a[0:3], v[96:99], 0
    ds_read_b64_tr_b16 a[32:33], v19 offset:49152
    ds_read_b64_tr_b16 a[34:35], v19 offset:51200
    buffer_load_dwordx4 v6, s[16:19], s47 offen offset:2048 nt lds
    v_exp_f32 v210, v68
    v_exp_f32 v211, v69
    v_mfma_f32_32x32x16_bf16 v[144:159], a[4:7], v[100:103], v[144:159]
    ds_read_b64_tr_b16 a[36:37], v19 offset:53248
    ds_read_b64_tr_b16 a[38:39], v19 offset:55296
    v_add_f32 v208, v208, v210
    v_add_f32 v208, v208, v211
    v_cvt_pk_bf16_f32 v114, v210, v211
    v_mfma_f32_32x32x16_bf16 v[144:159], a[8:11], v[104:107], v[144:159]
    ds_read_b64_tr_b16 a[40:41], v19 offset:57344
    ds_read_b64_tr_b16 a[42:43], v19 offset:59392
    buffer_load_dwordx4 v6, s[16:19], s47 offen offset:3072 nt lds
    v_exp_f32 v212, v70
    v_exp_f32 v213, v71
    v_mfma_f32_32x32x16_bf16 v[144:159], a[12:15], v[108:111], v[144:159]
    ds_read_b64_tr_b16 a[44:45], v19 offset:61440
    ds_read_b64_tr_b16 a[46:47], v19 offset:63488
    v_add_f32 v208, v208, v212
    v_add_f32 v208, v208, v213
    v_cvt_pk_bf16_f32 v115, v212, v213
    s_waitcnt lgkmcnt(8)
    v_mfma_f32_32x32x16_bf16 v[160:175], a[16:19], v[96:99], 0
    ds_read_b128 a[0:3], v8 offset:32768
    s_add_u32 m0, s43, 131072
    s_add_u32 s47, s43, 81920
    buffer_load_dwordx4 v2, s[12:15], s47 offen nt lds
    v_exp_f32 v210, v72
    v_exp_f32 v211, v73
    v_mfma_f32_32x32x16_bf16 v[160:175], a[20:23], v[100:103], v[160:175]
    ds_read_b128 a[4:7], v9 offset:32768
    v_add_f32 v208, v208, v210
    v_add_f32 v208, v208, v211
    v_cvt_pk_bf16_f32 v116, v210, v211
    v_exp_f32 v212, v74
    v_mfma_f32_32x32x16_bf16 v[160:175], a[24:27], v[104:107], v[160:175]
    ds_read_b128 a[8:11], v10 offset:32768
    buffer_load_dwordx4 v3, s[12:15], s47 offen offset:1024 nt lds
    v_exp_f32 v213, v75
    v_add_f32 v208, v208, v212
    v_mfma_f32_32x32x16_bf16 v[160:175], a[28:31], v[108:111], v[160:175]
    ds_read_b128 a[12:15], v11 offset:32768
    v_add_f32 v208, v208, v213
    v_cvt_pk_bf16_f32 v117, v212, v213
    v_exp_f32 v210, v76
    v_exp_f32 v211, v77
    s_waitcnt lgkmcnt(4)
    v_mfma_f32_32x32x16_bf16 v[176:191], a[32:35], v[96:99], 0
    ds_read_b128 a[16:19], v12 offset:32768
    buffer_load_dwordx4 v4, s[12:15], s47 offen offset:2048 nt lds
    v_add_f32 v208, v208, v210
    v_add_f32 v208, v208, v211
    v_cvt_pk_bf16_f32 v118, v210, v211
    v_mfma_f32_32x32x16_bf16 v[176:191], a[36:39], v[100:103], v[176:191]
    ds_read_b128 a[20:23], v13 offset:32768
    v_exp_f32 v212, v78
    v_exp_f32 v213, v79
    v_add_f32 v208, v208, v212
    v_mfma_f32_32x32x16_bf16 v[176:191], a[40:43], v[104:107], v[176:191]
    ds_read_b128 a[24:27], v14 offset:32768
    buffer_load_dwordx4 v5, s[12:15], s47 offen offset:3072 nt lds
    v_add_f32 v208, v208, v213
    v_cvt_pk_bf16_f32 v119, v212, v213
    v_exp_f32 v210, v80
    v_mfma_f32_32x32x16_bf16 v[176:191], a[44:47], v[108:111], v[176:191]
    ds_read_b128 a[28:31], v15 offset:32768
    v_exp_f32 v211, v81
    v_add_f32 v208, v208, v210
    v_add_f32 v208, v208, v211
    s_waitcnt lgkmcnt(4)
    v_mfma_f32_32x32x16_bf16 v[32:47], a[0:3], a[128:131], v[192:207]
    ds_read_b128 a[32:35], v8 offset:40960
    v_cvt_pk_bf16_f32 v120, v210, v211
    v_exp_f32 v212, v82
    v_mfma_f32_32x32x16_bf16 v[32:47], a[4:7], a[132:135], v[32:47]
    ds_read_b128 a[36:39], v9 offset:40960
    v_exp_f32 v213, v83
    v_add_f32 v208, v208, v212
    v_add_f32 v208, v208, v213
    v_cvt_pk_bf16_f32 v121, v212, v213
    v_mfma_f32_32x32x16_bf16 v[32:47], a[8:11], a[136:139], v[32:47]
    ds_read_b128 a[40:43], v10 offset:40960
    v_exp_f32 v210, v84
    v_exp_f32 v211, v85
    v_add_f32 v208, v208, v210
    v_mfma_f32_32x32x16_bf16 v[32:47], a[12:15], a[140:143], v[32:47]
    ds_read_b128 a[44:47], v11 offset:40960
    v_add_f32 v208, v208, v211
    v_cvt_pk_bf16_f32 v122, v210, v211
    v_exp_f32 v212, v86
    s_waitcnt lgkmcnt(4)
    v_mfma_f32_32x32x16_bf16 v[32:47], a[16:19], a[144:147], v[32:47]
    ds_read_b128 a[0:3], v12 offset:40960
    v_exp_f32 v213, v87
    v_add_f32 v208, v208, v212
    v_add_f32 v208, v208, v213
    v_cvt_pk_bf16_f32 v123, v212, v213
    v_mfma_f32_32x32x16_bf16 v[32:47], a[20:23], a[148:151], v[32:47]
    ds_read_b128 a[4:7], v13 offset:40960
    v_exp_f32 v210, v88
    v_exp_f32 v211, v89
    v_mfma_f32_32x32x16_bf16 v[32:47], a[24:27], a[152:155], v[32:47]
    ds_read_b128 a[8:11], v14 offset:40960
    v_add_f32 v208, v208, v210
    v_add_f32 v208, v208, v211
    v_cvt_pk_bf16_f32 v124, v210, v211
    v_exp_f32 v212, v90
    v_mfma_f32_32x32x16_bf16 v[32:47], a[28:31], a[156:159], v[32:47]
    ds_read_b128 a[12:15], v15 offset:40960
    v_exp_f32 v213, v91
    v_add_f32 v208, v208, v212
    v_add_f32 v208, v208, v213
    s_waitcnt vmcnt(20)
    s_waitcnt vmcnt(16)
    s_barrier
    s_waitcnt lgkmcnt(4)
    v_mfma_f32_32x32x16_bf16 v[48:63], a[32:35], a[128:131], v[192:207]
    ds_read_b64_tr_b16 a[16:17], v216 offset:16384
    ds_read_b64_tr_b16 a[18:19], v216 offset:18432
    s_add_u32 s46, s39, 0
    s_and_b32 s46, s46, 15
    s_lshl_b32 s46, s46, 15
    s_add_u32 m0, s48, 0
    s_nop 0
    buffer_load_dwordx4 v20, s[24:27], s46 offen lds
    v_cvt_pk_bf16_f32 v125, v212, v213
    v_exp_f32 v210, v92
    v_mfma_f32_32x32x16_bf16 v[48:63], a[36:39], a[132:135], v[48:63]
    ds_read_b64_tr_b16 a[20:21], v216 offset:20480
    ds_read_b64_tr_b16 a[22:23], v216 offset:22528
    v_exp_f32 v211, v93
    v_mfma_f32_32x32x16_bf16 v[48:63], a[40:43], a[136:139], v[48:63]
    ds_read_b64_tr_b16 a[24:25], v216 offset:24576
    ds_read_b64_tr_b16 a[26:27], v216 offset:26624
    buffer_load_dwordx4 v21, s[24:27], s46 offen offset:1024 lds
    v_add_f32 v208, v208, v210
    v_add_f32 v208, v208, v211
    v_cvt_pk_bf16_f32 v126, v210, v211
    v_mfma_f32_32x32x16_bf16 v[48:63], a[44:47], a[140:143], v[48:63]
    ds_read_b64_tr_b16 a[28:29], v216 offset:28672
    ds_read_b64_tr_b16 a[30:31], v216 offset:30720
    v_exp_f32 v212, v94
    s_waitcnt lgkmcnt(8)
    v_mfma_f32_32x32x16_bf16 v[48:63], a[0:3], a[144:147], v[48:63]
    ds_read_b64_tr_b16 a[32:33], v217 offset:16384
    ds_read_b64_tr_b16 a[34:35], v217 offset:18432
    buffer_load_dwordx4 v22, s[24:27], s46 offen offset:2048 lds
    v_exp_f32 v213, v95
    v_add_f32 v208, v208, v212
    v_add_f32 v208, v208, v213
    v_mfma_f32_32x32x16_bf16 v[48:63], a[4:7], a[148:151], v[48:63]
    ds_read_b64_tr_b16 a[36:37], v217 offset:20480
    ds_read_b64_tr_b16 a[38:39], v217 offset:22528
    v_cvt_pk_bf16_f32 v127, v212, v213
    v_mfma_f32_32x32x16_bf16 v[48:63], a[8:11], a[152:155], v[48:63]
    ds_read_b64_tr_b16 a[40:41], v217 offset:24576
    ds_read_b64_tr_b16 a[42:43], v217 offset:26624
    buffer_load_dwordx4 v23, s[24:27], s46 offen offset:3072 lds
    v_mfma_f32_32x32x16_bf16 v[48:63], a[12:15], a[156:159], v[48:63]
    ds_read_b64_tr_b16 a[44:45], v217 offset:28672
    ds_read_b64_tr_b16 a[46:47], v217 offset:30720
    v_cmp_lt_f32 vcc, 0x44800000, v208
    s_nop 3
    s_nop 2
    s_cmp_lg_u64 vcc, 0
    s_cbranch_scc1 L_rg1
L_rg1_back:
    v_add_f32 v24, v24, v208
    s_waitcnt lgkmcnt(8)
    v_mfma_f32_32x32x16_bf16 v[128:143], a[16:19], v[112:115], v[128:143]
    ds_read_b64_tr_b16 a[0:1], v218 offset:16384
    ds_read_b64_tr_b16 a[2:3], v218 offset:18432
    s_add_u32 m0, s48, 4096
    s_add_u32 s46, s46, 16384
    buffer_load_dwordx4 v20, s[24:27], s46 offen lds
    v_exp_f32 v210, v32
    v_mfma_f32_32x32x16_bf16 v[128:143], a[20:23], v[116:119], v[128:143]
    ds_read_b64_tr_b16 a[4:5], v218 offset:20480
    ds_read_b64_tr_b16 a[6:7], v218 offset:22528
    v_exp_f32 v211, v33
    s_nop 0
    v_add_f32 v208, v210, v211
    v_cvt_pk_bf16_f32 v96, v210, v211
    v_mfma_f32_32x32x16_bf16 v[128:143], a[24:27], v[120:123], v[128:143]
    ds_read_b64_tr_b16 a[8:9], v218 offset:24576
    ds_read_b64_tr_b16 a[10:11], v218 offset:26624
    buffer_load_dwordx4 v21, s[24:27], s46 offen offset:1024 lds
    v_exp_f32 v212, v34
    v_exp_f32 v213, v35
    v_mfma_f32_32x32x16_bf16 v[128:143], a[28:31], v[124:127], v[128:143]
    ds_read_b64_tr_b16 a[12:13], v218 offset:28672
    ds_read_b64_tr_b16 a[14:15], v218 offset:30720
    v_add_f32 v208, v208, v212
    v_add_f32 v208, v208, v213
    v_cvt_pk_bf16_f32 v97, v212, v213
    s_waitcnt lgkmcnt(8)
    v_mfma_f32_32x32x16_bf16 v[144:159], a[32:35], v[112:115], v[144:159]
    ds_read_b64_tr_b16 a[16:17], v219 offset:16384
    ds_read_b64_tr_b16 a[18:19], v219 offset:18432
    buffer_load_dwordx4 v22, s[24:27], s46 offen offset:2048 lds
    v_exp_f32 v210, v36
    v_exp_f32 v211, v37
    v_mfma_f32_32x32x16_bf16 v[144:159], a[36:39], v[116:119], v[144:159]
    ds_read_b64_tr_b16 a[20:21], v219 offset:20480
    ds_read_b64_tr_b16 a[22:23], v219 offset:22528
    v_add_f32 v208, v208, v210
    v_add_f32 v208, v208, v211
    v_cvt_pk_bf16_f32 v98, v210, v211
    v_mfma_f32_32x32x16_bf16 v[144:159], a[40:43], v[120:123], v[144:159]
    ds_read_b64_tr_b16 a[24:25], v219 offset:24576
    ds_read_b64_tr_b16 a[26:27], v219 offset:26624
    buffer_load_dwordx4 v23, s[24:27], s46 offen offset:3072 lds
    v_exp_f32 v212, v38
    v_mfma_f32_32x32x16_bf16 v[144:159], a[44:47], v[124:127], v[144:159]
    ds_read_b64_tr_b16 a[28:29], v219 offset:28672
    ds_read_b64_tr_b16 a[30:31], v219 offset:30720
    v_exp_f32 v213, v39
    v_add_f32 v208, v208, v212
    v_add_f32 v208, v208, v213
    s_waitcnt lgkmcnt(8)
    v_add_u32 v8, 0x10000, v8
    v_add_u32 v9, 0x10000, v9
    v_add_u32 v10, 0x10000, v10
    v_add_u32 v11, 0x10000, v11
    v_add_u32 v12, 0x10000, v12
    v_add_u32 v13, 0x10000, v13
    v_add_u32 v14, 0x10000, v14
    v_add_u32 v15, 0x10000, v15
    v_mfma_f32_32x32x16_bf16 v[160:175], a[0:3], v[112:115], v[160:175]
    ds_read_b128 a[32:35], v8 offset:0
    v_cvt_pk_bf16_f32 v99, v212, v213
    v_exp_f32 v210, v40
    v_exp_f32 v211, v41
    v_mfma_f32_32x32x16_bf16 v[160:175], a[4:7], v[116:119], v[160:175]
    ds_read_b128 a[36:39], v9 offset:0
    v_add_f32 v208, v208, v210
    v_add_f32 v208, v208, v211
    v_cvt_pk_bf16_f32 v100, v210, v211
    v_mfma_f32_32x32x16_bf16 v[160:175], a[8:11], v[120:123], v[160:175]
    ds_read_b128 a[40:43], v10 offset:0
    v_exp_f32 v212, v42
    v_exp_f32 v213, v43
    v_add_f32 v208, v208, v212
    v_mfma_f32_32x32x16_bf16 v[160:175], a[12:15], v[124:127], v[160:175]
    ds_read_b128 a[44:47], v11 offset:0
    v_add_f32 v208, v208, v213
    v_cvt_pk_bf16_f32 v101, v212, v213
    v_exp_f32 v210, v44
    s_waitcnt lgkmcnt(4)
    v_mfma_f32_32x32x16_bf16 v[176:191], a[16:19], v[112:115], v[176:191]
    ds_read_b128 a[0:3], v12 offset:0
    v_exp_f32 v211, v45
    v_add_f32 v208, v208, v210
    v_add_f32 v208, v208, v211
    v_cvt_pk_bf16_f32 v102, v210, v211
    v_mfma_f32_32x32x16_bf16 v[176:191], a[20:23], v[116:119], v[176:191]
    ds_read_b128 a[4:7], v13 offset:0
    v_exp_f32 v212, v46
    v_exp_f32 v213, v47
    v_mfma_f32_32x32x16_bf16 v[176:191], a[24:27], v[120:123], v[176:191]
    ds_read_b128 a[8:11], v14 offset:0
    v_add_f32 v208, v208, v212
    v_add_f32 v208, v208, v213
    v_cvt_pk_bf16_f32 v103, v212, v213
    v_exp_f32 v210, v48
    v_mfma_f32_32x32x16_bf16 v[176:191], a[28:31], v[124:127], v[176:191]
    ds_read_b128 a[12:15], v15 offset:0
    v_exp_f32 v211, v49
    v_add_f32 v208, v208, v210
    v_add_f32 v208, v208, v211
    s_waitcnt lgkmcnt(4)
    v_mfma_f32_32x32x16_bf16 v[64:79], a[32:35], a[128:131], v[192:207]
    ds_read_b128 a[16:19], v8 offset:8192
    v_cvt_pk_bf16_f32 v104, v210, v211
    v_exp_f32 v212, v50
    v_exp_f32 v213, v51
    v_mfma_f32_32x32x16_bf16 v[64:79], a[36:39], a[132:135], v[64:79]
    ds_read_b128 a[20:23], v9 offset:8192
    v_add_f32 v208, v208, v212
    v_add_f32 v208, v208, v213
    v_cvt_pk_bf16_f32 v105, v212, v213
    v_mfma_f32_32x32x16_bf16 v[64:79], a[40:43], a[136:139], v[64:79]
    ds_read_b128 a[24:27], v10 offset:8192
    v_exp_f32 v210, v52
    v_exp_f32 v211, v53
    v_add_f32 v208, v208, v210
    v_mfma_f32_32x32x16_bf16 v[64:79], a[44:47], a[140:143], v[64:79]
    ds_read_b128 a[28:31], v11 offset:8192
    v_add_f32 v208, v208, v211
    v_cvt_pk_bf16_f32 v106, v210, v211
    v_exp_f32 v212, v54
    s_waitcnt lgkmcnt(4)
    v_mfma_f32_32x32x16_bf16 v[64:79], a[0:3], a[144:147], v[64:79]
    ds_read_b128 a[32:35], v12 offset:8192
    v_exp_f32 v213, v55
    v_add_f32 v208, v208, v212
    v_add_f32 v208, v208, v213
    v_cvt_pk_bf16_f32 v107, v212, v213
    v_mfma_f32_32x32x16_bf16 v[64:79], a[4:7], a[148:151], v[64:79]
    ds_read_b128 a[36:39], v13 offset:8192
    v_exp_f32 v210, v56
    v_exp_f32 v211, v57
    v_mfma_f32_32x32x16_bf16 v[64:79], a[8:11], a[152:155], v[64:79]
    ds_read_b128 a[40:43], v14 offset:8192
    v_add_f32 v208, v208, v210
    v_add_f32 v208, v208, v211
    v_cvt_pk_bf16_f32 v108, v210, v211
    v_exp_f32 v212, v58
    v_mfma_f32_32x32x16_bf16 v[64:79], a[12:15], a[156:159], v[64:79]
    ds_read_b128 a[44:47], v15 offset:8192
    v_exp_f32 v213, v59
    v_add_f32 v208, v208, v212
    v_add_f32 v208, v208, v213
    s_waitcnt vmcnt(20)
    s_waitcnt vmcnt(16)
    s_barrier
    s_waitcnt lgkmcnt(4)
    v_mfma_f32_32x32x16_bf16 v[80:95], a[16:19], a[128:131], v[192:207]
    ds_read_b64_tr_b16 a[0:1], v216 offset:49152
    ds_read_b64_tr_b16 a[2:3], v216 offset:51200
    s_add_u32 m0, s43, 49152
    s_add_u32 s47, s43, 65536
    buffer_load_dwordx4 v6, s[16:19], s47 offen nt lds
    v_cvt_pk_bf16_f32 v109, v212, v213
    v_exp_f32 v210, v60
    v_mfma_f32_32x32x16_bf16 v[80:95], a[20:23], a[132:135], v[80:95]
    ds_read_b64_tr_b16 a[4:5], v216 offset:53248
    ds_read_b64_tr_b16 a[6:7], v216 offset:55296
    v_exp_f32 v211, v61
    v_add_f32 v208, v208, v210
    v_mfma_f32_32x32x16_bf16 v[80:95], a[24:27], a[136:139], v[80:95]
    ds_read_b64_tr_b16 a[8:9], v216 offset:57344
    ds_read_b64_tr_b16 a[10:11], v216 offset:59392
    buffer_load_dwordx4 v6, s[16:19], s47 offen offset:1024 nt lds
    v_add_f32 v208, v208, v211
    v_cvt_pk_bf16_f32 v110, v210, v211
    v_mfma_f32_32x32x16_bf16 v[80:95], a[28:31], a[140:143], v[80:95]
    ds_read_b64_tr_b16 a[12:13], v216 offset:61440
    ds_read_b64_tr_b16 a[14:15], v216 offset:63488
    v_exp_f32 v212, v62
    v_exp_f32 v213, v63
    s_waitcnt lgkmcnt(8)
    v_mfma_f32_32x32x16_bf16 v[80:95], a[32:35], a[144:147], v[80:95]
    ds_read_b64_tr_b16 a[16:17], v217 offset:49152
    ds_read_b64_tr_b16 a[18:19], v217 offset:51200
    buffer_load_dwordx4 v6, s[16:19], s47 offen offset:2048 nt lds
    v_add_f32 v208, v208, v212
    v_mfma_f32_32x32x16_bf16 v[80:95], a[36:39], a[148:151], v[80:95]
    ds_read_b64_tr_b16 a[20:21], v217 offset:53248
    ds_read_b64_tr_b16 a[22:23], v217 offset:55296
    v_add_f32 v208, v208, v213
    v_cvt_pk_bf16_f32 v111, v212, v213
    v_mfma_f32_32x32x16_bf16 v[80:95], a[40:43], a[152:155], v[80:95]
    ds_read_b64_tr_b16 a[24:25], v217 offset:57344
    ds_read_b64_tr_b16 a[26:27], v217 offset:59392
    buffer_load_dwordx4 v6, s[16:19], s47 offen offset:3072 nt lds
    v_mfma_f32_32x32x16_bf16 v[80:95], a[44:47], a[156:159], v[80:95]
    ds_read_b64_tr_b16 a[28:29], v217 offset:61440
    ds_read_b64_tr_b16 a[30:31], v217 offset:63488
    v_cmp_lt_f32 vcc, 0x44800000, v208
    s_nop 3
    s_nop 2
    s_cmp_lg_u64 vcc, 0
    s_cbranch_scc1 L_rg2
L_rg2_back:
    v_add_f32 v24, v24, v208
    s_waitcnt lgkmcnt(8)
    v_mfma_f32_32x32x16_bf16 v[128:143], a[0:3], v[96:99], v[128:143]
    ds_read_b64_tr_b16 a[32:33], v218 offset:49152
    ds_read_b64_tr_b16 a[34:35], v218 offset:51200
    s_add_u32 m0, s43, 32768
    s_add_u32 s47, s43, 98304
    buffer_load_dwordx4 v2, s[12:15], s47 offen nt lds
    v_exp_f32 v210, v64
    v_mfma_f32_32x32x16_bf16 v[128:143], a[4:7], v[100:103], v[128:143]
    ds_read_b64_tr_b16 a[36:37], v218 offset:53248
    ds_read_b64_tr_b16 a[38:39], v218 offset:55296
    v_exp_f32 v211, v65
    s_nop 0
    v_add_f32 v208, v210, v211
    v_cvt_pk_bf16_f32 v112, v210, v211
    v_mfma_f32_32x32x16_bf16 v[128:143], a[8:11], v[104:107], v[128:143]
    ds_read_b64_tr_b16 a[40:41], v218 offset:57344
    ds_read_b64_tr_b16 a[42:43], v218 offset:59392
    buffer_load_dwordx4 v3, s[12:15], s47 offen offset:1024 nt lds
    v_exp_f32 v212, v66
    v_exp_f32 v213, v67
    v_mfma_f32_32x32x16_bf16 v[128:143], a[12:15], v[108:111], v[128:143]
    ds_read_b64_tr_b16 a[44:45], v218 offset:61440
    ds_read_b64_tr_b16 a[46:47], v218 offset:63488
    v_add_f32 v208, v208, v212
    v_add_f32 v208, v208, v213
    v_cvt_pk_bf16_f32 v113, v212, v213
    s_waitcnt lgkmcnt(8)
    v_mfma_f32_32x32x16_bf16 v[144:159], a[16:19], v[96:99], v[144:159]
    ds_read_b64_tr_b16 a[0:1], v219 offset:49152
    ds_read_b64_tr_b16 a[2:3], v219 offset:51200
    buffer_load_dwordx4 v4, s[12:15], s47 offen offset:2048 nt lds
    v_exp_f32 v210, v68
    v_exp_f32 v211, v69
    v_mfma_f32_32x32x16_bf16 v[144:159], a[20:23], v[100:103], v[144:159]
    ds_read_b64_tr_b16 a[4:5], v219 offset:53248
    ds_read_b64_tr_b16 a[6:7], v219 offset:55296
    v_add_f32 v208, v208, v210
    v_add_f32 v208, v208, v211
    v_cvt_pk_bf16_f32 v114, v210, v211
    v_mfma_f32_32x32x16_bf16 v[144:159], a[24:27], v[104:107], v[144:159]
    ds_read_b64_tr_b16 a[8:9], v219 offset:57344
    ds_read_b64_tr_b16 a[10:11], v219 offset:59392
    buffer_load_dwordx4 v5, s[12:15], s47 offen offset:3072 nt lds
    v_exp_f32 v212, v70
    v_exp_f32 v213, v71
    v_mfma_f32_32x32x16_bf16 v[144:159], a[28:31], v[108:111], v[144:159]
    ds_read_b64_tr_b16 a[12:13], v219 offset:61440
    ds_read_b64_tr_b16 a[14:15], v219 offset:63488
    v_add_f32 v208, v208, v212
    v_add_f32 v208, v208, v213
    v_cvt_pk_bf16_f32 v115, v212, v213
    s_waitcnt lgkmcnt(8)
    v_mfma_f32_32x32x16_bf16 v[160:175], a[32:35], v[96:99], v[160:175]
    ds_read_b128 a[16:19], v8 offset:32768
    v_exp_f32 v210, v72
    v_exp_f32 v211, v73
    v_mfma_f32_32x32x16_bf16 v[160:175], a[36:39], v[100:103], v[160:175]
    ds_read_b128 a[20:23], v9 offset:32768
    v_add_f32 v208, v208, v210
    v_add_f32 v208, v208, v211
    v_cvt_pk_bf16_f32 v116, v210, v211
    v_exp_f32 v212, v74
    v_mfma_f32_32x32x16_bf16 v[160:175], a[40:43], v[104:107], v[160:175]
    ds_read_b128 a[24:27], v10 offset:32768
    v_exp_f32 v213, v75
    v_add_f32 v208, v208, v212
    v_add_f32 v208, v208, v213
    v_cvt_pk_bf16_f32 v117, v212, v213
    v_mfma_f32_32x32x16_bf16 v[160:175], a[44:47], v[108:111], v[160:175]
    ds_read_b128 a[28:31], v11 offset:32768
    v_exp_f32 v210, v76
    v_exp_f32 v211, v77
    v_add_f32 v208, v208, v210
    s_waitcnt lgkmcnt(4)
    v_mfma_f32_32x32x16_bf16 v[176:191], a[0:3], v[96:99], v[176:191]
    ds_read_b128 a[32:35], v12 offset:32768
    s_waitcnt vmcnt(8)
    s_add_u32 s45, s48, 0
    v_add_u32 v31, s45, v16
    ds_read_b64_tr_b16 a[64:65], v31 offset:0
    ds_read_b64_tr_b16 a[66:67], v31 offset:2048
    v_add_f32 v208, v208, v211
    v_cvt_pk_bf16_f32 v118, v210, v211
    v_mfma_f32_32x32x16_bf16 v[176:191], a[4:7], v[100:103], v[176:191]
    ds_read_b128 a[36:39], v13 offset:32768
    ds_read_b64_tr_b16 a[80:81], v31 offset:4096
    ds_read_b64_tr_b16 a[82:83], v31 offset:6144
    v_exp_f32 v212, v78
    v_exp_f32 v213, v79
    v_mfma_f32_32x32x16_bf16 v[176:191], a[8:11], v[104:107], v[176:191]
    ds_read_b128 a[40:43], v14 offset:32768
    v_add_u32 v31, s45, v17
    ds_read_b64_tr_b16 a[68:69], v31 offset:0
    v_add_f32 v208, v208, v212
    v_add_f32 v208, v208, v213
    v_cvt_pk_bf16_f32 v119, v212, v213
    v_mfma_f32_32x32x16_bf16 v[176:191], a[12:15], v[108:111], v[176:191]
    ds_read_b128 a[44:47], v15 offset:32768
    ds_read_b64_tr_b16 a[70:71], v31 offset:2048
    v_exp_f32 v210, v80
    v_exp_f32 v211, v81
    s_waitcnt lgkmcnt(10)
    v_mfma_f32_32x32x16_bf16 v[32:47], a[16:19], a[128:131], v[192:207]
    ds_read_b128 a[0:3], v8 offset:40960
    ds_read_b64_tr_b16 a[84:85], v31 offset:4096
    ds_read_b64_tr_b16 a[86:87], v31 offset:6144
    v_add_f32 v208, v208, v210
    v_add_f32 v208, v208, v211
    v_cvt_pk_bf16_f32 v120, v210, v211
    v_mfma_f32_32x32x16_bf16 v[32:47], a[20:23], a[132:135], v[32:47]
    ds_read_b128 a[4:7], v9 offset:40960
    v_add_u32 v31, s45, v18
    ds_read_b64_tr_b16 a[72:73], v31 offset:0
    ds_read_b64_tr_b16 a[74:75], v31 offset:2048
    v_exp_f32 v212, v82
    v_mfma_f32_32x32x16_bf16 v[32:47], a[24:27], a[136:139], v[32:47]
    ds_read_b128 a[8:11], v10 offset:40960
    ds_read_b64_tr_b16 a[88:89], v31 offset:4096
    v_exp_f32 v213, v83
    v_add_f32 v208, v208, v212
    v_add_f32 v208, v208, v213
    v_cvt_pk_bf16_f32 v121, v212, v213
    v_mfma_f32_32x32x16_bf16 v[32:47], a[28:31], a[140:143], v[32:47]
    ds_read_b128 a[12:15], v11 offset:40960
    ds_read_b64_tr_b16 a[90:91], v31 offset:6144
    v_exp_f32 v210, v84
    v_exp_f32 v211, v85
    s_waitcnt lgkmcnt(11)
    v_mfma_f32_32x32x16_bf16 v[32:47], a[32:35], a[144:147], v[32:47]
    ds_read_b128 a[16:19], v12 offset:40960
    v_add_u32 v31, s45, v19
    ds_read_b64_tr_b16 a[76:77], v31 offset:0
    ds_read_b64_tr_b16 a[78:79], v31 offset:2048
    v_add_f32 v208, v208, v210
    v_add_f32 v208, v208, v211
    v_cvt_pk_bf16_f32 v122, v210, v211
    v_mfma_f32_32x32x16_bf16 v[32:47], a[36:39], a[148:151], v[32:47]
    ds_read_b128 a[20:23], v13 offset:40960
    ds_read_b64_tr_b16 a[92:93], v31 offset:4096
    ds_read_b64_tr_b16 a[94:95], v31 offset:6144
    v_exp_f32 v212, v86
    v_exp_f32 v213, v87
    v_mfma_f32_32x32x16_bf16 v[32:47], a[40:43], a[152:155], v[32:47]
    ds_read_b128 a[24:27], v14 offset:40960
    s_waitcnt lgkmcnt(1)
    s_add_u32 s46, s39, 1
    s_and_b32 s46, s46, 15
    s_lshl_b32 s46, s46, 15
    s_add_u32 m0, s48, 0
    s_nop 0
    buffer_load_dwordx4 v20, s[24:27], s46 offen lds
    v_add_f32 v208, v208, v212
    v_add_f32 v208, v208, v213
    v_cvt_pk_bf16_f32 v123, v212, v213
    v_mfma_f32_32x32x16_bf16 v[32:47], a[44:47], a[156:159], v[32:47]
    ds_read_b128 a[28:31], v15 offset:40960
    v_exp_f32 v210, v88
    v_exp_f32 v211, v89
    v_add_f32 v208, v208, v210
    v_add_f32 v208, v208, v211
    s_barrier
    v_mfma_f32_32x32x16_bf16 v[48:63], a[0:3], a[128:131], v[192:207]
    ds_read_b64_tr_b16 a[32:33], v220 offset:16384
    ds_read_b64_tr_b16 a[34:35], v220 offset:18432
    buffer_load_dwordx4 v21, s[24:27], s46 offen offset:1024 lds
    v_cvt_pk_bf16_f32 v124, v210, v211
    v_exp_f32 v212, v90
    v_mfma_f32_32x32x16_bf16 v[48:63], a[4:7], a[132:135], v[48:63]
    ds_read_b64_tr_b16 a[36:37], v220 offset:20480
    ds_read_b64_tr_b16 a[38:39], v220 offset:22528
    v_exp_f32 v213, v91
    v_add_f32 v208, v208, v212
    v_add_f32 v208, v208, v213
    v_cvt_pk_bf16_f32 v125, v212, v213
    v_mfma_f32_32x32x16_bf16 v[48:63], a[8:11], a[136:139], v[48:63]
    ds_read_b64_tr_b16 a[40:41], v220 offset:24576
    ds_read_b64_tr_b16 a[42:43], v220 offset:26624
    buffer_load_dwordx4 v22, s[24:27], s46 offen offset:2048 lds
    v_exp_f32 v210, v92
    v_mfma_f32_32x32x16_bf16 v[48:63], a[12:15], a[140:143], v[48:63]
    ds_read_b64_tr_b16 a[44:45], v220 offset:28672
    ds_read_b64_tr_b16 a[46:47], v220 offset:30720
    v_exp_f32 v211, v93
    v_add_f32 v208, v208, v210
    v_add_f32 v208, v208, v211
    v_cvt_pk_bf16_f32 v126, v210, v211
    s_waitcnt lgkmcnt(8)
    v_mfma_f32_32x32x16_bf16 v[48:63], a[16:19], a[144:147], v[48:63]
    ds_read_b64_tr_b16 a[0:1], v221 offset:16384
    ds_read_b64_tr_b16 a[2:3], v221 offset:18432
    buffer_load_dwordx4 v23, s[24:27], s46 offen offset:3072 lds
    v_exp_f32 v212, v94
    v_exp_f32 v213, v95
    v_mfma_f32_32x32x16_bf16 v[48:63], a[20:23], a[148:151], v[48:63]
    ds_read_b64_tr_b16 a[4:5], v221 offset:20480
    ds_read_b64_tr_b16 a[6:7], v221 offset:22528
    v_add_f32 v208, v208, v212
    v_add_f32 v208, v208, v213
    v_cvt_pk_bf16_f32 v127, v212, v213
    v_mfma_f32_32x32x16_bf16 v[48:63], a[24:27], a[152:155], v[48:63]
    ds_read_b64_tr_b16 a[8:9], v221 offset:24576
    ds_read_b64_tr_b16 a[10:11], v221 offset:26624
    s_add_u32 m0, s48, 4096
    s_add_u32 s46, s46, 16384
    buffer_load_dwordx4 v20, s[24:27], s46 offen lds
    v_mfma_f32_32x32x16_bf16 v[48:63], a[28:31], a[156:159], v[48:63]
    ds_read_b64_tr_b16 a[12:13], v221 offset:28672
    ds_read_b64_tr_b16 a[14:15], v221 offset:30720
    v_cmp_lt_f32 vcc, 0x44800000, v208
    s_nop 3
    s_nop 2
    s_cmp_lg_u64 vcc, 0
    s_cbranch_scc1 L_rg3
L_rg3_back:
    v_add_f32 v24, v24, v208
    s_waitcnt lgkmcnt(8)
    v_mfma_f32_32x32x16_bf16 v[128:143], a[32:35], v[112:115], v[128:143]
    ds_read_b64_tr_b16 a[16:17], v222 offset:16384
    ds_read_b64_tr_b16 a[18:19], v222 offset:18432
    buffer_load_dwordx4 v21, s[24:27], s46 offen offset:1024 lds
    v_exp_f32 v210, v32
    v_mfma_f32_32x32x16_bf16 v[128:143], a[36:39], v[116:119], v[128:143]
    ds_read_b64_tr_b16 a[20:21], v222 offset:20480
    ds_read_b64_tr_b16 a[22:23], v222 offset:22528
    v_exp_f32 v211, v33
    s_nop 0
    v_add_f32 v208, v210, v211
    v_cvt_pk_bf16_f32 v96, v210, v211
    v_mfma_f32_32x32x16_bf16 v[128:143], a[40:43], v[120:123], v[128:143]
    ds_read_b64_tr_b16 a[24:25], v222 offset:24576
    ds_read_b64_tr_b16 a[26:27], v222 offset:26624
    buffer_load_dwordx4 v22, s[24:27], s46 offen offset:2048 lds
    v_exp_f32 v212, v34
    v_exp_f32 v213, v35
    v_mfma_f32_32x32x16_bf16 v[128:143], a[44:47], v[124:127], v[128:143]
    ds_read_b64_tr_b16 a[28:29], v222 offset:28672
    ds_read_b64_tr_b16 a[30:31], v222 offset:30720
    v_add_f32 v208, v208, v212
    v_add_f32 v208, v208, v213
    v_cvt_pk_bf16_f32 v97, v212, v213
    s_waitcnt lgkmcnt(8)
    v_mfma_f32_32x32x16_bf16 v[144:159], a[0:3], v[112:115], v[144:159]
    ds_read_b64_tr_b16 a[32:33], v223 offset:16384
    ds_read_b64_tr_b16 a[34:35], v223 offset:18432
    buffer_load_dwordx4 v23, s[24:27], s46 offen offset:3072 lds
    v_exp_f32 v210, v36
    v_exp_f32 v211, v37
    v_mfma_f32_32x32x16_bf16 v[144:159], a[4:7], v[116:119], v[144:159]
    ds_read_b64_tr_b16 a[36:37], v223 offset:20480
    ds_read_b64_tr_b16 a[38:39], v223 offset:22528
    v_add_f32 v208, v208, v210
    v_add_f32 v208, v208, v211
    v_cvt_pk_bf16_f32 v98, v210, v211
    v_mfma_f32_32x32x16_bf16 v[144:159], a[8:11], v[120:123], v[144:159]
    ds_read_b64_tr_b16 a[40:41], v223 offset:24576
    ds_read_b64_tr_b16 a[42:43], v223 offset:26624
    s_add_u32 m0, s43, 81920
    s_add_u32 s47, s43, 81920
    buffer_load_dwordx4 v6, s[16:19], s47 offen nt lds
    v_exp_f32 v212, v38
    v_exp_f32 v213, v39
    v_mfma_f32_32x32x16_bf16 v[144:159], a[12:15], v[124:127], v[144:159]
    ds_read_b64_tr_b16 a[44:45], v223 offset:28672
    ds_read_b64_tr_b16 a[46:47], v223 offset:30720
    v_add_f32 v208, v208, v212
    v_add_f32 v208, v208, v213
    v_cvt_pk_bf16_f32 v99, v212, v213
    s_waitcnt lgkmcnt(8)
    v_add_u32 v8, 0x10000, v8
    v_add_u32 v9, 0x10000, v9
    v_add_u32 v10, 0x10000, v10
    v_add_u32 v11, 0x10000, v11
    v_add_u32 v12, 0x10000, v12
    v_add_u32 v13, 0x10000, v13
    v_add_u32 v14, 0x10000, v14
    v_add_u32 v15, 0x10000, v15
    v_mfma_f32_32x32x16_bf16 v[160:175], a[16:19], v[112:115], v[160:175]
    ds_read_b128 a[0:3], v8 offset:0
    buffer_load_dwordx4 v6, s[16:19], s47 offen offset:1024 nt lds
    v_exp_f32 v210, v40
    v_exp_f32 v211, v41
    v_mfma_f32_32x32x16_bf16 v[160:175], a[20:23], v[116:119], v[160:175]
    ds_read_b128 a[4:7], v9 offset:0
    v_add_f32 v208, v208, v210
    v_add_f32 v208, v208, v211
    v_cvt_pk_bf16_f32 v100, v210, v211
    v_exp_f32 v212, v42
    v_mfma_f32_32x32x16_bf16 v[160:175], a[24:27], v[120:123], v[160:175]
    ds_read_b128 a[8:11], v10 offset:0
    buffer_load_dwordx4 v6, s[16:19], s47 offen offset:2048 nt lds
    v_exp_f32 v213, v43
    v_add_f32 v208, v208, v212
    v_mfma_f32_32x32x16_bf16 v[160:175], a[28:31], v[124:127], v[160:175]
    ds_read_b128 a[12:15], v11 offset:0
    v_add_f32 v208, v208, v213
    v_cvt_pk_bf16_f32 v101, v212, v213
    v_exp_f32 v210, v44
    v_exp_f32 v211, v45
    s_waitcnt lgkmcnt(4)
    v_mfma_f32_32x32x16_bf16 v[176:191], a[32:35], v[112:115], v[176:191]
    ds_read_b128 a[16:19], v12 offset:0
    buffer_load_dwordx4 v6, s[16:19], s47 offen offset:3072 nt lds
    v_add_f32 v208, v208, v210
    v_add_f32 v208, v208, v211
    v_cvt_pk_bf16_f32 v102, v210, v211
    v_mfma_f32_32x32x16_bf16 v[176:191], a[36:39], v[116:119], v[176:191]
    ds_read_b128 a[20:23], v13 offset:0
    v_exp_f32 v212, v46
    v_exp_f32 v213, v47
    v_add_f32 v208, v208, v212
    v_mfma_f32_32x32x16_bf16 v[176:191], a[40:43], v[120:123], v[176:191]
    ds_read_b128 a[24:27], v14 offset:0
    s_add_u32 m0, s43, 65536
    s_add_u32 s47, s43, 114688
    buffer_load_dwordx4 v2, s[12:15], s47 offen nt lds
    v_add_f32 v208, v208, v213
    v_cvt_pk_bf16_f32 v103, v212, v213
    v_exp_f32 v210, v48
    v_mfma_f32_32x32x16_bf16 v[176:191], a[44:47], v[124:127], v[176:191]
    ds_read_b128 a[28:31], v15 offset:0
    v_exp_f32 v211, v49
    v_add_f32 v208, v208, v210
    v_add_f32 v208, v208, v211
    s_waitcnt lgkmcnt(4)
    v_mfma_f32_32x32x16_bf16 v[64:79], a[0:3], a[128:131], v[192:207]
    ds_read_b128 a[32:35], v8 offset:8192
    buffer_load_dwordx4 v3, s[12:15], s47 offen offset:1024 nt lds
    v_cvt_pk_bf16_f32 v104, v210, v211
    v_exp_f32 v212, v50
    v_exp_f32 v213, v51
    v_mfma_f32_32x32x16_bf16 v[64:79], a[4:7], a[132:135], v[64:79]
    ds_read_b128 a[36:39], v9 offset:8192
    v_add_f32 v208, v208, v212
    v_add_f32 v208, v208, v213
    v_cvt_pk_bf16_f32 v105, v212, v213
    v_mfma_f32_32x32x16_bf16 v[64:79], a[8:11], a[136:139], v[64:79]
    ds_read_b128 a[40:43], v10 offset:8192
    buffer_load_dwordx4 v4, s[12:15], s47 offen offset:2048 nt lds
    v_exp_f32 v210, v52
    v_exp_f32 v211, v53
    v_mfma_f32_32x32x16_bf16 v[64:79], a[12:15], a[140:143], v[64:79]
    ds_read_b128 a[44:47], v11 offset:8192
    v_add_f32 v208, v208, v210
    v_add_f32 v208, v208, v211
    v_cvt_pk_bf16_f32 v106, v210, v211
    v_exp_f32 v212, v54
    s_waitcnt lgkmcnt(4)
    v_mfma_f32_32x32x16_bf16 v[64:79], a[16:19], a[144:147], v[64:79]
    ds_read_b128 a[0:3], v12 offset:8192
    buffer_load_dwordx4 v5, s[12:15], s47 offen offset:3072 nt lds
    v_exp_f32 v213, v55
    v_add_f32 v208, v208, v212
    v_add_f32 v208, v208, v213
    v_mfma_f32_32x32x16_bf16 v[64:79], a[20:23], a[148:151], v[64:79]
    ds_read_b128 a[4:7], v13 offset:8192
    v_cvt_pk_bf16_f32 v107, v212, v213
    v_exp_f32 v210, v56
    v_exp_f32 v211, v57
    v_mfma_f32_32x32x16_bf16 v[64:79], a[24:27], a[152:155], v[64:79]
    ds_read_b128 a[8:11], v14 offset:8192
    v_add_f32 v208, v208, v210
    v_add_f32 v208, v208, v211
    v_cvt_pk_bf16_f32 v108, v210, v211
    v_mfma_f32_32x32x16_bf16 v[64:79], a[28:31], a[156:159], v[64:79]
    ds_read_b128 a[12:15], v15 offset:8192
    v_exp_f32 v212, v58
    v_exp_f32 v213, v59
    v_add_f32 v208, v208, v212
    s_waitcnt vmcnt(20)
    s_waitcnt vmcnt(16)
    s_barrier
    s_waitcnt lgkmcnt(4)
    v_mfma_f32_32x32x16_bf16 v[80:95], a[32:35], a[128:131], v[192:207]
    ds_read_b64_tr_b16 a[16:17], v16 offset:49152
    ds_read_b64_tr_b16 a[18:19], v16 offset:51200
    s_add_u32 m0, s43, 114688
    s_add_u32 s47, s43, 98304
    buffer_load_dwordx4 v6, s[16:19], s47 offen nt lds
    v_add_f32 v208, v208, v213
    v_cvt_pk_bf16_f32 v109, v212, v213
    v_mfma_f32_32x32x16_bf16 v[80:95], a[36:39], a[132:135], v[80:95]
    ds_read_b64_tr_b16 a[20:21], v16 offset:53248
    ds_read_b64_tr_b16 a[22:23], v16 offset:55296
    v_exp_f32 v210, v60
    v_exp_f32 v211, v61
    v_mfma_f32_32x32x16_bf16 v[80:95], a[40:43], a[136:139], v[80:95]
    ds_read_b64_tr_b16 a[24:25], v16 offset:57344
    ds_read_b64_tr_b16 a[26:27], v16 offset:59392
    buffer_load_dwordx4 v6, s[16:19], s47 offen offset:1024 nt lds
    v_add_f32 v208, v208, v210
    v_add_f32 v208, v208, v211
    v_cvt_pk_bf16_f32 v110, v210, v211
    v_mfma_f32_32x32x16_bf16 v[80:95], a[44:47], a[140:143], v[80:95]
    ds_read_b64_tr_b16 a[28:29], v16 offset:61440
    ds_read_b64_tr_b16 a[30:31], v16 offset:63488
    v_exp_f32 v212, v62
    s_waitcnt lgkmcnt(8)
    v_mfma_f32_32x32x16_bf16 v[80:95], a[0:3], a[144:147], v[80:95]
    ds_read_b64_tr_b16 a[32:33], v17 offset:49152
    ds_read_b64_tr_b16 a[34:35], v17 offset:51200
    buffer_load_dwordx4 v6, s[16:19], s47 offen offset:2048 nt lds
    v_exp_f32 v213, v63
    v_add_f32 v208, v208, v212
    v_mfma_f32_32x32x16_bf16 v[80:95], a[4:7], a[148:151], v[80:95]
    ds_read_b64_tr_b16 a[36:37], v17 offset:53248
    ds_read_b64_tr_b16 a[38:39], v17 offset:55296
    v_add_f32 v208, v208, v213
    v_cvt_pk_bf16_f32 v111, v212, v213
    v_mfma_f32_32x32x16_bf16 v[80:95], a[8:11], a[152:155], v[80:95]
    ds_read_b64_tr_b16 a[40:41], v17 offset:57344
    ds_read_b64_tr_b16 a[42:43], v17 offset:59392
    buffer_load_dwordx4 v6, s[16:19], s47 offen offset:3072 nt lds
    v_mfma_f32_32x32x16_bf16 v[80:95], a[12:15], a[156:159], v[80:95]
    ds_read_b64_tr_b16 a[44:45], v17 offset:61440
    ds_read_b64_tr_b16 a[46:47], v17 offset:63488
    v_cmp_lt_f32 vcc, 0x44800000, v208
    s_nop 3
    s_nop 2
    s_cmp_lg_u64 vcc, 0
    s_cbranch_scc1 L_rg4
L_rg4_back:
    v_add_f32 v24, v24, v208
    s_waitcnt lgkmcnt(8)
    v_mfma_f32_32x32x16_bf16 v[128:143], a[16:19], v[96:99], v[128:143]
    ds_read_b64_tr_b16 a[0:1], v18 offset:49152
    ds_read_b64_tr_b16 a[2:3], v18 offset:51200
    s_add_u32 m0, s43, 98304
    s_add_u32 s47, s43, 114688
    buffer_load_dwordx4 v6, s[16:19], s47 offen nt lds
    v_exp_f32 v210, v64
    v_mfma_f32_32x32x16_bf16 v[128:143], a[20:23], v[100:103], v[128:143]
    ds_read_b64_tr_b16 a[4:5], v18 offset:53248
    ds_read_b64_tr_b16 a[6:7], v18 offset:55296
    v_exp_f32 v211, v65
    s_nop 0
    v_add_f32 v208, v210, v211
    v_cvt_pk_bf16_f32 v112, v210, v211
    v_mfma_f32_32x32x16_bf16 v[128:143], a[24:27], v[104:107], v[128:143]
    ds_read_b64_tr_b16 a[8:9], v18 offset:57344
    ds_read_b64_tr_b16 a[10:11], v18 offset:59392
    buffer_load_dwordx4 v6, s[16:19], s47 offen offset:1024 nt lds
    v_exp_f32 v212, v66
    v_exp_f32 v213, v67
    v_mfma_f32_32x32x16_bf16 v[128:143], a[28:31], v[108:111], v[128:143]
    ds_read_b64_tr_b16 a[12:13], v18 offset:61440
    ds_read_b64_tr_b16 a[14:15], v18 offset:63488
    v_add_f32 v208, v208, v212
    v_add_f32 v208, v208, v213
    v_cvt_pk_bf16_f32 v113, v212, v213
    s_waitcnt lgkmcnt(8)
    v_mfma_f32_32x32x16_bf16 v[144:159], a[32:35], v[96:99], v[144:159]
    ds_read_b64_tr_b16 a[16:17], v19 offset:49152
    ds_read_b64_tr_b16 a[18:19], v19 offset:51200
    buffer_load_dwordx4 v6, s[16:19], s47 offen offset:2048 nt lds
    v_exp_f32 v210, v68
    v_exp_f32 v211, v69
    v_mfma_f32_32x32x16_bf16 v[144:159], a[36:39], v[100:103], v[144:159]
    ds_read_b64_tr_b16 a[20:21], v19 offset:53248
    ds_read_b64_tr_b16 a[22:23], v19 offset:55296
    v_add_f32 v208, v208, v210
    v_add_f32 v208, v208, v211
    v_cvt_pk_bf16_f32 v114, v210, v211
    v_mfma_f32_32x32x16_bf16 v[144:159], a[40:43], v[104:107], v[144:159]
    ds_read_b64_tr_b16 a[24:25], v19 offset:57344
    ds_read_b64_tr_b16 a[26:27], v19 offset:59392
    buffer_load_dwordx4 v6, s[16:19], s47 offen offset:3072 nt lds
    v_exp_f32 v212, v70
    v_exp_f32 v213, v71
    v_mfma_f32_32x32x16_bf16 v[144:159], a[44:47], v[108:111], v[144:159]
    ds_read_b64_tr_b16 a[28:29], v19 offset:61440
    ds_read_b64_tr_b16 a[30:31], v19 offset:63488
    v_add_f32 v208, v208, v212
    v_add_f32 v208, v208, v213
    v_cvt_pk_bf16_f32 v115, v212, v213
    s_waitcnt lgkmcnt(8)
    v_add_u32 v8, 0xfffe0000, v8
    v_add_u32 v9, 0xfffe0000, v9
    v_add_u32 v10, 0xfffe0000, v10
    v_add_u32 v11, 0xfffe0000, v11
    v_add_u32 v12, 0xfffe0000, v12
    v_add_u32 v13, 0xfffe0000, v13
    v_add_u32 v14, 0xfffe0000, v14
    v_add_u32 v15, 0xfffe0000, v15
    v_mfma_f32_32x32x16_bf16 v[160:175], a[0:3], v[96:99], v[160:175]
    ds_read_b128 a[32:35], v8 offset:32768
    v_exp_f32 v210, v72
    v_exp_f32 v211, v73
    v_mfma_f32_32x32x16_bf16 v[160:175], a[4:7], v[100:103], v[160:175]
    ds_read_b128 a[36:39], v9 offset:32768
    v_add_f32 v208, v208, v210
    v_add_f32 v208, v208, v211
    v_cvt_pk_bf16_f32 v116, v210, v211
    v_exp_f32 v212, v74
    v_mfma_f32_32x32x16_bf16 v[160:175], a[8:11], v[104:107], v[160:175]
    ds_read_b128 a[40:43], v10 offset:32768
    v_exp_f32 v213, v75
    v_add_f32 v208, v208, v212
    v_add_f32 v208, v208, v213
    v_cvt_pk_bf16_f32 v117, v212, v213
    v_mfma_f32_32x32x16_bf16 v[160:175], a[12:15], v[108:111], v[160:175]
    ds_read_b128 a[44:47], v11 offset:32768
    v_exp_f32 v210, v76
    v_exp_f32 v211, v77
    v_add_f32 v208, v208, v210
    s_waitcnt lgkmcnt(4)
    v_mfma_f32_32x32x16_bf16 v[176:191], a[16:19], v[96:99], v[176:191]
    ds_read_b128 a[0:3], v12 offset:32768
    s_waitcnt vmcnt(16)
    s_add_u32 s45, s48, 0
    v_add_u32 v31, s45, v16
    ds_read_b64_tr_b16 a[96:97], v31 offset:0
    ds_read_b64_tr_b16 a[98:99], v31 offset:2048
    v_add_f32 v208, v208, v211
    v_cvt_pk_bf16_f32 v118, v210, v211
    v_mfma_f32_32x32x16_bf16 v[176:191], a[20:23], v[100:103], v[176:191]
    ds_read_b128 a[4:7], v13 offset:32768
    ds_read_b64_tr_b16 a[112:113], v31 offset:4096
    ds_read_b64_tr_b16 a[114:115], v31 offset:6144
    v_exp_f32 v212, v78
    v_exp_f32 v213, v79
    v_mfma_f32_32x32x16_bf16 v[176:191], a[24:27], v[104:107], v[176:191]
    ds_read_b128 a[8:11], v14 offset:32768
    v_add_u32 v31, s45, v17
    ds_read_b64_tr_b16 a[100:101], v31 offset:0
    v_add_f32 v208, v208, v212
    v_add_f32 v208, v208, v213
    v_cvt_pk_bf16_f32 v119, v212, v213
    v_mfma_f32_32x32x16_bf16 v[176:191], a[28:31], v[108:111], v[176:191]
    ds_read_b128 a[12:15], v15 offset:32768
    ds_read_b64_tr_b16 a[102:103], v31 offset:2048
    v_exp_f32 v210, v80
    v_exp_f32 v211, v81
    s_waitcnt lgkmcnt(10)
    v_mfma_f32_32x32x16_bf16 v[32:47], a[32:35], a[128:131], v[192:207]
    ds_read_b128 a[16:19], v8 offset:40960
    ds_read_b64_tr_b16 a[116:117], v31 offset:4096
    ds_read_b64_tr_b16 a[118:119], v31 offset:6144
    v_add_f32 v208, v208, v210
    v_add_f32 v208, v208, v211
    v_cvt_pk_bf16_f32 v120, v210, v211
    v_mfma_f32_32x32x16_bf16 v[32:47], a[36:39], a[132:135], v[32:47]
    ds_read_b128 a[20:23], v9 offset:40960
    v_add_u32 v31, s45, v18
    ds_read_b64_tr_b16 a[104:105], v31 offset:0
    ds_read_b64_tr_b16 a[106:107], v31 offset:2048
    v_exp_f32 v212, v82
    v_mfma_f32_32x32x16_bf16 v[32:47], a[40:43], a[136:139], v[32:47]
    ds_read_b128 a[24:27], v10 offset:40960
    ds_read_b64_tr_b16 a[120:121], v31 offset:4096
    v_exp_f32 v213, v83
    v_add_f32 v208, v208, v212
    v_add_f32 v208, v208, v213
    v_cvt_pk_bf16_f32 v121, v212, v213
    v_mfma_f32_32x32x16_bf16 v[32:47], a[44:47], a[140:143], v[32:47]
    ds_read_b128 a[28:31], v11 offset:40960
    ds_read_b64_tr_b16 a[122:123], v31 offset:6144
    v_exp_f32 v210, v84
    v_exp_f32 v211, v85
    s_waitcnt lgkmcnt(11)
    v_mfma_f32_32x32x16_bf16 v[32:47], a[0:3], a[144:147], v[32:47]
    ds_read_b128 a[32:35], v12 offset:40960
    v_add_u32 v31, s45, v19
    ds_read_b64_tr_b16 a[108:109], v31 offset:0
    ds_read_b64_tr_b16 a[110:111], v31 offset:2048
    v_add_f32 v208, v208, v210
    v_add_f32 v208, v208, v211
    v_cvt_pk_bf16_f32 v122, v210, v211
    v_mfma_f32_32x32x16_bf16 v[32:47], a[4:7], a[148:151], v[32:47]
    ds_read_b128 a[36:39], v13 offset:40960
    ds_read_b64_tr_b16 a[124:125], v31 offset:4096
    ds_read_b64_tr_b16 a[126:127], v31 offset:6144
    v_exp_f32 v212, v86
    v_exp_f32 v213, v87
    v_mfma_f32_32x32x16_bf16 v[32:47], a[8:11], a[152:155], v[32:47]
    ds_read_b128 a[40:43], v14 offset:40960
    s_waitcnt lgkmcnt(1)
    s_add_u32 s46, s39, 2
    s_and_b32 s46, s46, 15
    s_lshl_b32 s46, s46, 15
    s_add_u32 m0, s48, 0
    s_nop 0
    buffer_load_dwordx4 v20, s[24:27], s46 offen lds
    v_add_f32 v208, v208, v212
    v_add_f32 v208, v208, v213
    v_cvt_pk_bf16_f32 v123, v212, v213
    v_mfma_f32_32x32x16_bf16 v[32:47], a[12:15], a[156:159], v[32:47]
    ds_read_b128 a[44:47], v15 offset:40960
    v_exp_f32 v210, v88
    v_exp_f32 v211, v89
    v_add_f32 v208, v208, v210
    v_add_f32 v208, v208, v211
    s_waitcnt vmcnt(13)
    s_waitcnt vmcnt(9)
    s_barrier
    v_mfma_f32_32x32x16_bf16 v[48:63], a[16:19], a[128:131], v[192:207]
    ds_read_b64_tr_b16 a[0:1], v216 offset:16384
    ds_read_b64_tr_b16 a[2:3], v216 offset:18432
    buffer_load_dwordx4 v21, s[24:27], s46 offen offset:1024 lds
    v_cvt_pk_bf16_f32 v124, v210, v211
    v_exp_f32 v212, v90
    v_mfma_f32_32x32x16_bf16 v[48:63], a[20:23], a[132:135], v[48:63]
    ds_read_b64_tr_b16 a[4:5], v216 offset:20480
    ds_read_b64_tr_b16 a[6:7], v216 offset:22528
    v_exp_f32 v213, v91
    v_add_f32 v208, v208, v212
    v_add_f32 v208, v208, v213
    v_cvt_pk_bf16_f32 v125, v212, v213
    v_mfma_f32_32x32x16_bf16 v[48:63], a[24:27], a[136:139], v[48:63]
    ds_read_b64_tr_b16 a[8:9], v216 offset:24576
    ds_read_b64_tr_b16 a[10:11], v216 offset:26624
    buffer_load_dwordx4 v22, s[24:27], s46 offen offset:2048 lds
    v_exp_f32 v210, v92
    v_mfma_f32_32x32x16_bf16 v[48:63], a[28:31], a[140:143], v[48:63]
    ds_read_b64_tr_b16 a[12:13], v216 offset:28672
    ds_read_b64_tr_b16 a[14:15], v216 offset:30720
    v_exp_f32 v211, v93
    v_add_f32 v208, v208, v210
    v_add_f32 v208, v208, v211
    v_cvt_pk_bf16_f32 v126, v210, v211
    s_waitcnt lgkmcnt(8)
    v_mfma_f32_32x32x16_bf16 v[48:63], a[32:35], a[144:147], v[48:63]
    ds_read_b64_tr_b16 a[16:17], v217 offset:16384
    ds_read_b64_tr_b16 a[18:19], v217 offset:18432
    buffer_load_dwordx4 v23, s[24:27], s46 offen offset:3072 lds
    v_exp_f32 v212, v94
    v_exp_f32 v213, v95
    v_mfma_f32_32x32x16_bf16 v[48:63], a[36:39], a[148:151], v[48:63]
    ds_read_b64_tr_b16 a[20:21], v217 offset:20480
    ds_read_b64_tr_b16 a[22:23], v217 offset:22528
    v_add_f32 v208, v208, v212
    v_add_f32 v208, v208, v213
    v_cvt_pk_bf16_f32 v127, v212, v213
    v_mfma_f32_32x32x16_bf16 v[48:63], a[40:43], a[152:155], v[48:63]
    ds_read_b64_tr_b16 a[24:25], v217 offset:24576
    ds_read_b64_tr_b16 a[26:27], v217 offset:26624
    s_add_u32 m0, s48, 4096
    s_add_u32 s46, s46, 16384
    buffer_load_dwordx4 v20, s[24:27], s46 offen lds
    v_mfma_f32_32x32x16_bf16 v[48:63], a[44:47], a[156:159], v[48:63]
    ds_read_b64_tr_b16 a[28:29], v217 offset:28672
    ds_read_b64_tr_b16 a[30:31], v217 offset:30720
    v_cmp_lt_f32 vcc, 0x44800000, v208
    s_nop 3
    s_nop 2
    s_cmp_lg_u64 vcc, 0
    s_cbranch_scc1 L_rg5
L_rg5_back:
    v_add_f32 v24, v24, v208
    s_waitcnt lgkmcnt(8)
    v_mfma_f32_32x32x16_bf16 v[128:143], a[0:3], v[112:115], v[128:143]
    ds_read_b64_tr_b16 a[32:33], v218 offset:16384
    ds_read_b64_tr_b16 a[34:35], v218 offset:18432
    buffer_load_dwordx4 v21, s[24:27], s46 offen offset:1024 lds
    v_exp_f32 v210, v32
    v_mfma_f32_32x32x16_bf16 v[128:143], a[4:7], v[116:119], v[128:143]
    ds_read_b64_tr_b16 a[36:37], v218 offset:20480
    ds_read_b64_tr_b16 a[38:39], v218 offset:22528
    v_exp_f32 v211, v33
    s_nop 0
    v_add_f32 v208, v210, v211
    v_cvt_pk_bf16_f32 v96, v210, v211
    v_mfma_f32_32x32x16_bf16 v[128:143], a[8:11], v[120:123], v[128:143]
    ds_read_b64_tr_b16 a[40:41], v218 offset:24576
    ds_read_b64_tr_b16 a[42:43], v218 offset:26624
    buffer_load_dwordx4 v22, s[24:27], s46 offen offset:2048 lds
    v_exp_f32 v212, v34
    v_exp_f32 v213, v35
    v_mfma_f32_32x32x16_bf16 v[128:143], a[12:15], v[124:127], v[128:143]
    ds_read_b64_tr_b16 a[44:45], v218 offset:28672
    ds_read_b64_tr_b16 a[46:47], v218 offset:30720
    v_add_f32 v208, v208, v212
    v_add_f32 v208, v208, v213
    v_cvt_pk_bf16_f32 v97, v212, v213
    s_waitcnt lgkmcnt(8)
    v_mfma_f32_32x32x16_bf16 v[144:159], a[16:19], v[112:115], v[144:159]
    ds_read_b64_tr_b16 a[0:1], v219 offset:16384
    ds_read_b64_tr_b16 a[2:3], v219 offset:18432
    buffer_load_dwordx4 v23, s[24:27], s46 offen offset:3072 lds
    v_exp_f32 v210, v36
    v_exp_f32 v211, v37
    v_mfma_f32_32x32x16_bf16 v[144:159], a[20:23], v[116:119], v[144:159]
    ds_read_b64_tr_b16 a[4:5], v219 offset:20480
    ds_read_b64_tr_b16 a[6:7], v219 offset:22528
    v_add_f32 v208, v208, v210
    v_add_f32 v208, v208, v211
    v_cvt_pk_bf16_f32 v98, v210, v211
    v_mfma_f32_32x32x16_bf16 v[144:159], a[24:27], v[120:123], v[144:159]
    ds_read_b64_tr_b16 a[8:9], v219 offset:24576
    ds_read_b64_tr_b16 a[10:11], v219 offset:26624
    s_add_u32 s46, s39, 3
    s_and_b32 s46, s46, 15
    s_lshl_b32 s46, s46, 15
    s_add_u32 m0, s48, 131072
    s_nop 0
    buffer_load_dwordx4 v20, s[24:27], s46 offen lds
    v_exp_f32 v212, v38
    v_exp_f32 v213, v39
    v_mfma_f32_32x32x16_bf16 v[144:159], a[28:31], v[124:127], v[144:159]
    ds_read_b64_tr_b16 a[12:13], v219 offset:28672
    ds_read_b64_tr_b16 a[14:15], v219 offset:30720
    v_add_f32 v208, v208, v212
    v_add_f32 v208, v208, v213
    v_cvt_pk_bf16_f32 v99, v212, v213
    s_waitcnt lgkmcnt(8)
    v_add_u32 v8, 0x10000, v8
    v_add_u32 v9, 0x10000, v9
    v_add_u32 v10, 0x10000, v10
    v_add_u32 v11, 0x10000, v11
    v_add_u32 v12, 0x10000, v12
    v_add_u32 v13, 0x10000, v13
    v_add_u32 v14, 0x10000, v14
    v_add_u32 v15, 0x10000, v15
    v_mfma_f32_32x32x16_bf16 v[160:175], a[32:35], v[112:115], v[160:175]
    ds_read_b128 a[16:19], v8 offset:0
    buffer_load_dwordx4 v21, s[24:27], s46 offen offset:1024 lds
    v_exp_f32 v210, v40
    v_exp_f32 v211, v41
    v_mfma_f32_32x32x16_bf16 v[160:175], a[36:39], v[116:119], v[160:175]
    ds_read_b128 a[20:23], v9 offset:0
    v_add_f32 v208, v208, v210
    v_add_f32 v208, v208, v211
    v_cvt_pk_bf16_f32 v100, v210, v211
    v_exp_f32 v212, v42
    v_mfma_f32_32x32x16_bf16 v[160:175], a[40:43], v[120:123], v[160:175]
    ds_read_b128 a[24:27], v10 offset:0
    buffer_load_dwordx4 v22, s[24:27], s46 offen offset:2048 lds
    v_exp_f32 v213, v43
    v_add_f32 v208, v208, v212
    v_mfma_f32_32x32x16_bf16 v[160:175], a[44:47], v[124:127], v[160:175]
    ds_read_b128 a[28:31], v11 offset:0
    v_add_f32 v208, v208, v213
    v_cvt_pk_bf16_f32 v101, v212, v213
    v_exp_f32 v210, v44
    v_exp_f32 v211, v45
    s_waitcnt lgkmcnt(4)
    v_mfma_f32_32x32x16_bf16 v[176:191], a[0:3], v[112:115], v[176:191]
    ds_read_b128 a[32:35], v12 offset:0
    buffer_load_dwordx4 v23, s[24:27], s46 offen offset:3072 lds
    v_add_f32 v208, v208, v210
    v_add_f32 v208, v208, v211
    v_cvt_pk_bf16_f32 v102, v210, v211
    v_mfma_f32_32x32x16_bf16 v[176:191], a[4:7], v[116:119], v[176:191]
    ds_read_b128 a[36:39], v13 offset:0
    v_exp_f32 v212, v46
    v_exp_f32 v213, v47
    v_add_f32 v208, v208, v212
    v_mfma_f32_32x32x16_bf16 v[176:191], a[8:11], v[120:123], v[176:191]
    ds_read_b128 a[40:43], v14 offset:0
    s_add_u32 m0, s48, 135168
    s_add_u32 s46, s46, 16384
    buffer_load_dwordx4 v20, s[24:27], s46 offen lds
    v_add_f32 v208, v208, v213
    v_cvt_pk_bf16_f32 v103, v212, v213
    v_exp_f32 v210, v48
    v_mfma_f32_32x32x16_bf16 v[176:191], a[12:15], v[124:127], v[176:191]
    ds_read_b128 a[44:47], v15 offset:0
    v_exp_f32 v211, v49
    v_add_f32 v208, v208, v210
    v_add_f32 v208, v208, v211
    s_waitcnt lgkmcnt(4)
    v_mfma_f32_32x32x16_bf16 v[64:79], a[16:19], a[128:131], v[192:207]
    ds_read_b128 a[0:3], v8 offset:8192
    buffer_load_dwordx4 v21, s[24:27], s46 offen offset:1024 lds
    v_cvt_pk_bf16_f32 v104, v210, v211
    v_exp_f32 v212, v50
    v_exp_f32 v213, v51
    v_mfma_f32_32x32x16_bf16 v[64:79], a[20:23], a[132:135], v[64:79]
    ds_read_b128 a[4:7], v9 offset:8192
    v_add_f32 v208, v208, v212
    v_add_f32 v208, v208, v213
    v_cvt_pk_bf16_f32 v105, v212, v213
    v_mfma_f32_32x32x16_bf16 v[64:79], a[24:27], a[136:139], v[64:79]
    ds_read_b128 a[8:11], v10 offset:8192
    buffer_load_dwordx4 v22, s[24:27], s46 offen offset:2048 lds
    v_exp_f32 v210, v52
    v_exp_f32 v211, v53
    v_mfma_f32_32x32x16_bf16 v[64:79], a[28:31], a[140:143], v[64:79]
    ds_read_b128 a[12:15], v11 offset:8192
    v_add_f32 v208, v208, v210
    v_add_f32 v208, v208, v211
    v_cvt_pk_bf16_f32 v106, v210, v211
    v_exp_f32 v212, v54
    s_waitcnt lgkmcnt(4)
    v_mfma_f32_32x32x16_bf16 v[64:79], a[32:35], a[144:147], v[64:79]
    ds_read_b128 a[16:19], v12 offset:8192
    buffer_load_dwordx4 v23, s[24:27], s46 offen offset:3072 lds
    v_exp_f32 v213, v55
    v_add_f32 v208, v208, v212
    v_mfma_f32_32x32x16_bf16 v[64:79], a[36:39], a[148:151], v[64:79]
    ds_read_b128 a[20:23], v13 offset:8192
    v_add_f32 v208, v208, v213
    v_cvt_pk_bf16_f32 v107, v212, v213
    v_exp_f32 v210, v56
    v_mfma_f32_32x32x16_bf16 v[64:79], a[40:43], a[152:155], v[64:79]
    ds_read_b128 a[24:27], v14 offset:8192
    v_exp_f32 v211, v57
    v_add_f32 v208, v208, v210
    v_add_f32 v208, v208, v211
    v_cvt_pk_bf16_f32 v108, v210, v211
    v_mfma_f32_32x32x16_bf16 v[64:79], a[44:47], a[156:159], v[64:79]
    ds_read_b128 a[28:31], v15 offset:8192
    v_exp_f32 v212, v58
    v_exp_f32 v213, v59
    s_waitcnt vmcnt(20)
    s_waitcnt vmcnt(16)
    s_barrier
    s_waitcnt lgkmcnt(4)
    v_mfma_f32_32x32x16_bf16 v[80:95], a[0:3], a[128:131], v[192:207]
    ds_read_b64_tr_b16 a[32:33], v216 offset:49152
    ds_read_b64_tr_b16 a[34:35], v216 offset:51200
    v_add_f32 v208, v208, v212
    v_add_f32 v208, v208, v213
    v_cvt_pk_bf16_f32 v109, v212, v213
    v_mfma_f32_32x32x16_bf16 v[80:95], a[4:7], a[132:135], v[80:95]
    ds_read_b64_tr_b16 a[36:37], v216 offset:53248
    ds_read_b64_tr_b16 a[38:39], v216 offset:55296
    v_exp_f32 v210, v60
    v_exp_f32 v211, v61
    v_mfma_f32_32x32x16_bf16 v[80:95], a[8:11], a[136:139], v[80:95]
    ds_read_b64_tr_b16 a[40:41], v216 offset:57344
    ds_read_b64_tr_b16 a[42:43], v216 offset:59392
    v_add_f32 v208, v208, v210
    v_add_f32 v208, v208, v211
    v_cvt_pk_bf16_f32 v110, v210, v211
    v_mfma_f32_32x32x16_bf16 v[80:95], a[12:15], a[140:143], v[80:95]
    ds_read_b64_tr_b16 a[44:45], v216 offset:61440
    ds_read_b64_tr_b16 a[46:47], v216 offset:63488
    v_exp_f32 v212, v62
    v_exp_f32 v213, v63
    s_waitcnt lgkmcnt(8)
    v_mfma_f32_32x32x16_bf16 v[80:95], a[16:19], a[144:147], v[80:95]
    ds_read_b64_tr_b16 a[0:1], v217 offset:49152
    ds_read_b64_tr_b16 a[2:3], v217 offset:51200
    s_add_u32 s46, s39, 4
    s_and_b32 s46, s46, 15
    s_lshl_b32 s46, s46, 15
    s_add_u32 m0, s48, 32768
    s_nop 0
    buffer_load_dwordx4 v20, s[24:27], s46 offen lds
    v_add_f32 v208, v208, v212
    v_mfma_f32_32x32x16_bf16 v[80:95], a[20:23], a[148:151], v[80:95]
    ds_read_b64_tr_b16 a[4:5], v217 offset:53248
    ds_read_b64_tr_b16 a[6:7], v217 offset:55296
    v_add_f32 v208, v208, v213
    v_cvt_pk_bf16_f32 v111, v212, v213
    v_mfma_f32_32x32x16_bf16 v[80:95], a[24:27], a[152:155], v[80:95]
    ds_read_b64_tr_b16 a[8:9], v217 offset:57344
    ds_read_b64_tr_b16 a[10:11], v217 offset:59392
    buffer_load_dwordx4 v21, s[24:27], s46 offen offset:1024 lds
    v_mfma_f32_32x32x16_bf16 v[80:95], a[28:31], a[156:159], v[80:95]
    ds_read_b64_tr_b16 a[12:13], v217 offset:61440
    ds_read_b64_tr_b16 a[14:15], v217 offset:63488
    v_cmp_lt_f32 vcc, 0x44800000, v208
    s_nop 3
    s_nop 2
    s_cmp_lg_u64 vcc, 0
    s_cbranch_scc1 L_rg6
L_rg6_back:
    v_add_f32 v24, v24, v208
    s_waitcnt lgkmcnt(8)
    v_mfma_f32_32x32x16_bf16 v[128:143], a[32:35], v[96:99], v[128:143]
    ds_read_b64_tr_b16 a[16:17], v218 offset:49152
    ds_read_b64_tr_b16 a[18:19], v218 offset:51200
    buffer_load_dwordx4 v22, s[24:27], s46 offen offset:2048 lds
    v_exp_f32 v210, v64
    v_exp_f32 v211, v65
    s_nop 0
    v_add_f32 v208, v210, v211
    v_cvt_pk_bf16_f32 v112, v210, v211
    v_exp_f32 v212, v66
    v_mfma_f32_32x32x16_bf16 v[128:143], a[36:39], v[100:103], v[128:143]
    ds_read_b64_tr_b16 a[20:21], v218 offset:53248
    ds_read_b64_tr_b16 a[22:23], v218 offset:55296
    v_exp_f32 v213, v67
    v_add_f32 v208, v208, v212
    v_add_f32 v208, v208, v213
    v_cvt_pk_bf16_f32 v113, v212, v213
    v_exp_f32 v210, v68
    v_mfma_f32_32x32x16_bf16 v[128:143], a[40:43], v[104:107], v[128:143]
    ds_read_b64_tr_b16 a[24:25], v218 offset:57344
    ds_read_b64_tr_b16 a[26:27], v218 offset:59392
    buffer_load_dwordx4 v23, s[24:27], s46 offen offset:3072 lds
    v_exp_f32 v211, v69
    v_add_f32 v208, v208, v210
    v_add_f32 v208, v208, v211
    v_cvt_pk_bf16_f32 v114, v210, v211
    v_exp_f32 v212, v70
    v_exp_f32 v213, v71
    v_mfma_f32_32x32x16_bf16 v[128:143], a[44:47], v[108:111], v[128:143]
    ds_read_b64_tr_b16 a[28:29], v218 offset:61440
    ds_read_b64_tr_b16 a[30:31], v218 offset:63488
    v_add_f32 v208, v208, v212
    v_add_f32 v208, v208, v213
    v_cvt_pk_bf16_f32 v115, v212, v213
    v_exp_f32 v210, v72
    v_exp_f32 v211, v73
    s_waitcnt lgkmcnt(8)
    v_mfma_f32_32x32x16_bf16 v[144:159], a[0:3], v[96:99], v[144:159]
    ds_read_b64_tr_b16 a[32:33], v219 offset:49152
    ds_read_b64_tr_b16 a[34:35], v219 offset:51200
    s_add_u32 m0, s48, 36864
    s_add_u32 s46, s46, 16384
    buffer_load_dwordx4 v20, s[24:27], s46 offen lds
    v_add_f32 v208, v208, v210
    v_add_f32 v208, v208, v211
    v_cvt_pk_bf16_f32 v116, v210, v211
    v_exp_f32 v212, v74
    v_exp_f32 v213, v75
    v_add_f32 v208, v208, v212
    v_mfma_f32_32x32x16_bf16 v[144:159], a[4:7], v[100:103], v[144:159]
    ds_read_b64_tr_b16 a[36:37], v219 offset:53248
    ds_read_b64_tr_b16 a[38:39], v219 offset:55296
    v_add_f32 v208, v208, v213
    v_cvt_pk_bf16_f32 v117, v212, v213
    v_exp_f32 v210, v76
    v_exp_f32 v211, v77
    v_add_f32 v208, v208, v210
    v_add_f32 v208, v208, v211
    v_mfma_f32_32x32x16_bf16 v[144:159], a[8:11], v[104:107], v[144:159]
    ds_read_b64_tr_b16 a[40:41], v219 offset:57344
    ds_read_b64_tr_b16 a[42:43], v219 offset:59392
    buffer_load_dwordx4 v21, s[24:27], s46 offen offset:1024 lds
    v_cvt_pk_bf16_f32 v118, v210, v211
    v_exp_f32 v212, v78
    v_exp_f32 v213, v79
    v_add_f32 v208, v208, v212
    v_add_f32 v208, v208, v213
    v_mfma_f32_32x32x16_bf16 v[144:159], a[12:15], v[108:111], v[144:159]
    ds_read_b64_tr_b16 a[44:45], v219 offset:61440
    ds_read_b64_tr_b16 a[46:47], v219 offset:63488
    v_cvt_pk_bf16_f32 v119, v212, v213
    v_exp_f32 v210, v80
    v_exp_f32 v211, v81
    v_add_f32 v208, v208, v210
    v_add_f32 v208, v208, v211
    v_cvt_pk_bf16_f32 v120, v210, v211
    s_waitcnt lgkmcnt(8)
    v_mfma_f32_32x32x16_bf16 v[160:175], a[16:19], v[96:99], v[160:175]
    ds_read_b64_tr_b16 a[0:1], v216 offset:32768
    ds_read_b64_tr_b16 a[2:3], v216 offset:34816
    buffer_load_dwordx4 v22, s[24:27], s46 offen offset:2048 lds
    v_exp_f32 v212, v82
    v_exp_f32 v213, v83
    v_add_f32 v208, v208, v212
    v_add_f32 v208, v208, v213
    v_cvt_pk_bf16_f32 v121, v212, v213
    v_mfma_f32_32x32x16_bf16 v[160:175], a[20:23], v[100:103], v[160:175]
    ds_read_b64_tr_b16 a[4:5], v216 offset:36864
    ds_read_b64_tr_b16 a[6:7], v216 offset:38912
    v_exp_f32 v210, v84
    v_exp_f32 v211, v85
    v_add_f32 v208, v208, v210
    v_add_f32 v208, v208, v211
    v_cvt_pk_bf16_f32 v122, v210, v211
    v_exp_f32 v212, v86
    v_mfma_f32_32x32x16_bf16 v[160:175], a[24:27], v[104:107], v[160:175]
    ds_read_b64_tr_b16 a[8:9], v216 offset:40960
    ds_read_b64_tr_b16 a[10:11], v216 offset:43008
    buffer_load_dwordx4 v23, s[24:27], s46 offen offset:3072 lds
    v_exp_f32 v213, v87
    v_add_f32 v208, v208, v212
    v_add_f32 v208, v208, v213
    v_cvt_pk_bf16_f32 v123, v212, v213
    v_exp_f32 v210, v88
    v_mfma_f32_32x32x16_bf16 v[160:175], a[28:31], v[108:111], v[160:175]
    ds_read_b64_tr_b16 a[12:13], v216 offset:45056
    ds_read_b64_tr_b16 a[14:15], v216 offset:47104
    v_exp_f32 v211, v89
    v_add_f32 v208, v208, v210
    v_add_f32 v208, v208, v211
    v_cvt_pk_bf16_f32 v124, v210, v211
    v_exp_f32 v212, v90
    s_barrier
    s_waitcnt lgkmcnt(8)
    v_mfma_f32_32x32x16_bf16 v[176:191], a[32:35], v[96:99], v[176:191]
    ds_read_b64_tr_b16 a[16:17], v217 offset:32768
    ds_read_b64_tr_b16 a[18:19], v217 offset:34816
    v_exp_f32 v213, v91
    v_add_f32 v208, v208, v212
    v_add_f32 v208, v208, v213
    v_cvt_pk_bf16_f32 v125, v212, v213
    v_exp_f32 v210, v92
    v_mfma_f32_32x32x16_bf16 v[176:191], a[36:39], v[100:103], v[176:191]
    ds_read_b64_tr_b16 a[20:21], v217 offset:36864
    ds_read_b64_tr_b16 a[22:23], v217 offset:38912
    v_exp_f32 v211, v93
    v_add_f32 v208, v208, v210
    v_add_f32 v208, v208, v211
    v_cvt_pk_bf16_f32 v126, v210, v211
    v_exp_f32 v212, v94
    v_mfma_f32_32x32x16_bf16 v[176:191], a[40:43], v[104:107], v[176:191]
    ds_read_b64_tr_b16 a[24:25], v217 offset:40960
    ds_read_b64_tr_b16 a[26:27], v217 offset:43008
    v_exp_f32 v213, v95
    v_add_f32 v208, v208, v212
    v_add_f32 v208, v208, v213
    v_cvt_pk_bf16_f32 v127, v212, v213
    v_mfma_f32_32x32x16_bf16 v[176:191], a[44:47], v[108:111], v[176:191]
    ds_read_b64_tr_b16 a[28:29], v217 offset:45056
    ds_read_b64_tr_b16 a[30:31], v217 offset:47104
    v_cmp_lt_f32 vcc, 0x44800000, v208
    s_nop 3
    s_nop 2
    s_cmp_lg_u64 vcc, 0
    s_cbranch_scc1 L_rg7
L_rg7_back:
    v_add_f32 v24, v24, v208
    s_waitcnt lgkmcnt(8)
    v_mfma_f32_32x32x16_bf16 v[128:143], a[0:3], v[112:115], v[128:143]
    ds_read_b64_tr_b16 a[32:33], v218 offset:32768
    ds_read_b64_tr_b16 a[34:35], v218 offset:34816
    v_mov_b32 v27, v24
    s_nop 1
    v_permlane32_swap_b32 v24, v27
    v_add_f32 v24, v24, v27
    v_add_u32 v28, s48, v7
    v_add_u32 v28, 65536, v28
    v_mfma_f32_32x32x16_bf16 v[128:143], a[4:7], v[116:119], v[128:143]
    ds_read_b64_tr_b16 a[36:37], v218 offset:36864
    ds_read_b64_tr_b16 a[38:39], v218 offset:38912
    v_rcp_f32 v25, v24
    v_mfma_f32_32x32x16_bf16 v[128:143], a[8:11], v[120:123], v[128:143]
    ds_read_b64_tr_b16 a[40:41], v218 offset:40960
    ds_read_b64_tr_b16 a[42:43], v218 offset:43008
    v_mfma_f32_32x32x16_bf16 v[128:143], a[12:15], v[124:127], v[128:143]
    ds_read_b64_tr_b16 a[44:45], v218 offset:45056
    ds_read_b64_tr_b16 a[46:47], v218 offset:47104
    s_waitcnt lgkmcnt(8)
    v_mfma_f32_32x32x16_bf16 v[144:159], a[16:19], v[112:115], v[144:159]
    ds_read_b64_tr_b16 a[0:1], v219 offset:32768
    ds_read_b64_tr_b16 a[2:3], v219 offset:34816
    s_nop 5
    v_mul_f32 v128, v25, v128
    v_mul_f32 v129, v25, v129
    v_mul_f32 v130, v25, v130
    v_mul_f32 v131, v25, v131
    v_mul_f32 v132, v25, v132
    v_mul_f32 v133, v25, v133
    v_mul_f32 v134, v25, v134
    v_mul_f32 v135, v25, v135
    v_cvt_pk_bf16_f32 v128, v128, v129
    v_cvt_pk_bf16_f32 v129, v130, v131
    v_cvt_pk_bf16_f32 v130, v132, v133
    v_mfma_f32_32x32x16_bf16 v[144:159], a[20:23], v[116:119], v[144:159]
    ds_read_b64_tr_b16 a[4:5], v219 offset:36864
    ds_read_b64_tr_b16 a[6:7], v219 offset:38912
    v_cvt_pk_bf16_f32 v131, v134, v135
    ds_write_b128 v28, v[128:131] offset:0
    v_mul_f32 v136, v25, v136
    v_mul_f32 v137, v25, v137
    v_mul_f32 v138, v25, v138
    v_mul_f32 v139, v25, v139
    v_mul_f32 v140, v25, v140
    v_mfma_f32_32x32x16_bf16 v[144:159], a[24:27], v[120:123], v[144:159]
    ds_read_b64_tr_b16 a[8:9], v219 offset:40960
    ds_read_b64_tr_b16 a[10:11], v219 offset:43008
    v_mul_f32 v141, v25, v141
    v_mul_f32 v142, v25, v142
    v_mul_f32 v143, v25, v143
    v_cvt_pk_bf16_f32 v136, v136, v137
    v_cvt_pk_bf16_f32 v137, v138, v139
    v_cvt_pk_bf16_f32 v138, v140, v141
    v_cvt_pk_bf16_f32 v139, v142, v143
    v_mfma_f32_32x32x16_bf16 v[144:159], a[28:31], v[124:127], v[144:159]
    ds_read_b64_tr_b16 a[12:13], v219 offset:45056
    ds_read_b64_tr_b16 a[14:15], v219 offset:47104
    ds_write_b128 v28, v[136:139] offset:1024
    s_waitcnt lgkmcnt(10)
    v_mfma_f32_32x32x16_bf16 v[160:175], a[32:35], v[112:115], v[160:175]
    s_nop 6
    v_mul_f32 v144, v25, v144
    v_mul_f32 v145, v25, v145
    v_mul_f32 v146, v25, v146
    v_mul_f32 v147, v25, v147
    v_mul_f32 v148, v25, v148
    v_mul_f32 v149, v25, v149
    v_mul_f32 v150, v25, v150
    v_mul_f32 v151, v25, v151
    v_cvt_pk_bf16_f32 v144, v144, v145
    v_cvt_pk_bf16_f32 v145, v146, v147
    v_cvt_pk_bf16_f32 v146, v148, v149
    v_cvt_pk_bf16_f32 v147, v150, v151
    ds_write_b128 v28, v[144:147] offset:2048
    v_mul_f32 v152, v25, v152
    v_mfma_f32_32x32x16_bf16 v[160:175], a[36:39], v[116:119], v[160:175]
    v_mul_f32 v153, v25, v153
    v_mul_f32 v154, v25, v154
    v_mul_f32 v155, v25, v155
    v_mul_f32 v156, v25, v156
    v_mul_f32 v157, v25, v157
    v_mul_f32 v158, v25, v158
    v_mul_f32 v159, v25, v159
    v_cvt_pk_bf16_f32 v152, v152, v153
    v_cvt_pk_bf16_f32 v153, v154, v155
    v_mfma_f32_32x32x16_bf16 v[160:175], a[40:43], v[120:123], v[160:175]
    v_cvt_pk_bf16_f32 v154, v156, v157
    v_cvt_pk_bf16_f32 v155, v158, v159
    ds_write_b128 v28, v[152:155] offset:3072
    v_mfma_f32_32x32x16_bf16 v[160:175], a[44:47], v[124:127], v[160:175]
    s_waitcnt lgkmcnt(3)
    v_mfma_f32_32x32x16_bf16 v[176:191], a[0:3], v[112:115], v[176:191]
    s_nop 9
    v_mul_f32 v160, v25, v160
    v_mul_f32 v161, v25, v161
    v_mul_f32 v162, v25, v162
    v_mul_f32 v163, v25, v163
    v_mul_f32 v164, v25, v164
    v_mul_f32 v165, v25, v165
    v_mul_f32 v166, v25, v166
    v_mul_f32 v167, v25, v167
    v_cvt_pk_bf16_f32 v160, v160, v161
    v_cvt_pk_bf16_f32 v161, v162, v163
    v_cvt_pk_bf16_f32 v162, v164, v165
    v_cvt_pk_bf16_f32 v163, v166, v167
    ds_write_b128 v28, v[160:163] offset:4096
    v_mul_f32 v168, v25, v168
    v_mul_f32 v169, v25, v169
    v_mul_f32 v170, v25, v170
    v_mul_f32 v171, v25, v171
    v_mfma_f32_32x32x16_bf16 v[176:191], a[4:7], v[116:119], v[176:191]
    v_mul_f32 v172, v25, v172
    v_mul_f32 v173, v25, v173
    v_mul_f32 v174, v25, v174
    v_mul_f32 v175, v25, v175
    v_cvt_pk_bf16_f32 v168, v168, v169
    v_cvt_pk_bf16_f32 v169, v170, v171
    v_cvt_pk_bf16_f32 v170, v172, v173
    v_cvt_pk_bf16_f32 v171, v174, v175
    ds_write_b128 v28, v[168:171] offset:5120
    v_mfma_f32_32x32x16_bf16 v[176:191], a[8:11], v[120:123], v[176:191]
    v_mfma_f32_32x32x16_bf16 v[176:191], a[12:15], v[124:127], v[176:191]
    s_nop 11
    v_mul_f32 v176, v25, v176
    v_mul_f32 v177, v25, v177
    v_mul_f32 v178, v25, v178
    v_mul_f32 v179, v25, v179
    v_mul_f32 v180, v25, v180
    v_mul_f32 v181, v25, v181
    v_mul_f32 v182, v25, v182
    v_mul_f32 v183, v25, v183
    v_cvt_pk_bf16_f32 v176, v176, v177
    v_cvt_pk_bf16_f32 v177, v178, v179
    v_cvt_pk_bf16_f32 v178, v180, v181
    v_cvt_pk_bf16_f32 v179, v182, v183
    ds_write_b128 v28, v[176:179] offset:6144
    v_mul_f32 v184, v25, v184
    v_mul_f32 v185, v25, v185
    v_mul_f32 v186, v25, v186
    v_mul_f32 v187, v25, v187
    v_mul_f32 v188, v25, v188
    v_mul_f32 v189, v25, v189
    v_mul_f32 v190, v25, v190
    v_mul_f32 v191, v25, v191
    v_cvt_pk_bf16_f32 v184, v184, v185
    v_cvt_pk_bf16_f32 v185, v186, v187
    v_cvt_pk_bf16_f32 v186, v188, v189
    v_cvt_pk_bf16_f32 v187, v190, v191
    ds_write_b128 v28, v[184:187] offset:7168
    s_lshl_b32 s44, s36, 3
    v_mov_b32 v27, s44
    global_load_dword v0, v27, s[92:93] sc1
    v_add_u32 v32, s48, v16
    v_add_u32 v36, 65536, v32
    v_add_u32 v40, 131072, v32
    v_add_u32 v33, s48, v17
    v_add_u32 v37, 65536, v33
    v_add_u32 v41, 131072, v33
    v_add_u32 v34, s48, v18
    v_add_u32 v38, 65536, v34
    v_add_u32 v42, 131072, v34
    v_add_u32 v35, s48, v19
    v_add_u32 v39, 65536, v35
    v_add_u32 v43, 131072, v35
    s_waitcnt lgkmcnt(0)
    s_barrier
    s_add_u32 s44, s39, 5
    s_and_b32 s44, s44, 15
    s_lshl_b32 s44, s44, 15
    s_add_u32 m0, s48, 98304
    s_nop 0
    buffer_load_dwordx4 v20, s[24:27], s44 offen lds
    buffer_load_dwordx4 v21, s[24:27], s44 offen offset:1024 lds
    buffer_load_dwordx4 v22, s[24:27], s44 offen offset:2048 lds
    buffer_load_dwordx4 v23, s[24:27], s44 offen offset:3072 lds
    s_add_u32 m0, s48, 102400
    s_add_u32 s44, s44, 16384
    buffer_load_dwordx4 v20, s[24:27], s44 offen lds
    buffer_load_dwordx4 v21, s[24:27], s44 offen offset:1024 lds
    buffer_load_dwordx4 v22, s[24:27], s44 offen offset:2048 lds
    buffer_load_dwordx4 v23, s[24:27], s44 offen offset:3072 lds
    s_waitcnt vmcnt(25)
    s_add_u32 s45, s39, 2
    s_and_b32 s45, s45, 15
    s_lshl_b32 s45, s45, 11
    s_add_u32 s45, s45, 65536
    v_add_u32 v30, s45, v7
    ds_read_b128 v[112:115], v30 offset:0
    ds_read_b64_tr_b16 v[64:65], v32 offset:0
    ds_read_b64_tr_b16 v[66:67], v32 offset:2048
    ds_read_b64_tr_b16 v[68:69], v33 offset:0
    ds_read_b64_tr_b16 v[70:71], v33 offset:2048
    ds_read_b64_tr_b16 v[72:73], v34 offset:0
    ds_read_b64_tr_b16 v[74:75], v34 offset:2048
    ds_read_b64_tr_b16 v[76:77], v35 offset:0
    ds_read_b64_tr_b16 v[78:79], v35 offset:2048
    ds_read_b128 v[116:119], v30 offset:1024
    ds_read_b64_tr_b16 v[80:81], v32 offset:4096
    ds_read_b64_tr_b16 v[82:83], v32 offset:6144
    ds_read_b64_tr_b16 v[84:85], v33 offset:4096
    ds_read_b64_tr_b16 v[86:87], v33 offset:6144
    ds_read_b64_tr_b16 v[88:89], v34 offset:4096
    ds_read_b64_tr_b16 v[90:91], v34 offset:6144
    ds_read_b64_tr_b16 v[92:93], v35 offset:4096
    ds_read_b64_tr_b16 v[94:95], v35 offset:6144
    s_waitcnt lgkmcnt(15)
    s_waitcnt lgkmcnt(9)
    s_waitcnt vmcnt(17)
    v_mfma_f32_32x32x16_bf16 v[128:143], v[64:67], v[112:115], 0
    s_add_u32 s45, s39, 3
    s_and_b32 s45, s45, 15
    s_lshl_b32 s45, s45, 11
    v_mfma_f32_32x32x16_bf16 v[144:159], v[68:71], v[112:115], 0
    s_add_u32 s45, s45, 65536
    v_add_u32 v30, s45, v7
    ds_read_b128 v[120:123], v30 offset:0
    ds_read_b64_tr_b16 v[96:97], v40 offset:0
    v_mfma_f32_32x32x16_bf16 v[160:175], v[72:75], v[112:115], 0
    ds_read_b64_tr_b16 v[98:99], v40 offset:2048
    ds_read_b64_tr_b16 v[100:101], v41 offset:0
    ds_read_b64_tr_b16 v[102:103], v41 offset:2048
    v_mfma_f32_32x32x16_bf16 v[176:191], v[76:79], v[112:115], 0
    ds_read_b64_tr_b16 v[104:105], v42 offset:0
    ds_read_b64_tr_b16 v[106:107], v42 offset:2048
    ds_read_b64_tr_b16 v[108:109], v43 offset:0
    ds_read_b64_tr_b16 v[110:111], v43 offset:2048
    s_waitcnt lgkmcnt(15)
    s_waitcnt lgkmcnt(9)
    s_add_u32 s44, s39, 6
    s_and_b32 s44, s44, 15
    s_lshl_b32 s44, s44, 15
    s_add_u32 m0, s48, 0
    s_nop 0
    buffer_load_dwordx4 v20, s[24:27], s44 offen lds
    buffer_load_dwordx4 v21, s[24:27], s44 offen offset:1024 lds
    buffer_load_dwordx4 v22, s[24:27], s44 offen offset:2048 lds
    buffer_load_dwordx4 v23, s[24:27], s44 offen offset:3072 lds
    s_add_u32 m0, s48, 4096
    s_add_u32 s44, s44, 16384
    buffer_load_dwordx4 v20, s[24:27], s44 offen lds
    buffer_load_dwordx4 v21, s[24:27], s44 offen offset:1024 lds
    buffer_load_dwordx4 v22, s[24:27], s44 offen offset:2048 lds
    buffer_load_dwordx4 v23, s[24:27], s44 offen offset:3072 lds
    v_mfma_f32_32x32x16_bf16 v[128:143], v[80:83], v[116:119], v[128:143]
    ds_read_b128 v[112:115], v30 offset:1024
    ds_read_b64_tr_b16 v[64:65], v40 offset:4096
    v_mfma_f32_32x32x16_bf16 v[144:159], v[84:87], v[116:119], v[144:159]
    ds_read_b64_tr_b16 v[66:67], v40 offset:6144
    ds_read_b64_tr_b16 v[68:69], v41 offset:4096
    v_mfma_f32_32x32x16_bf16 v[160:175], v[88:91], v[116:119], v[160:175]
    ds_read_b64_tr_b16 v[70:71], v41 offset:6144
    ds_read_b64_tr_b16 v[72:73], v42 offset:4096
    v_mfma_f32_32x32x16_bf16 v[176:191], v[92:95], v[116:119], v[176:191]
    ds_read_b64_tr_b16 v[74:75], v42 offset:6144
    ds_read_b64_tr_b16 v[76:77], v43 offset:4096
    ds_read_b64_tr_b16 v[78:79], v43 offset:6144
    s_waitcnt lgkmcnt(15)
    s_waitcnt lgkmcnt(9)
    s_waitcnt vmcnt(17)
    v_mfma_f32_32x32x16_bf16 v[128:143], v[96:99], v[120:123], v[128:143]
    s_add_u32 s45, s39, 4
    s_and_b32 s45, s45, 15
    s_lshl_b32 s45, s45, 11
    v_mfma_f32_32x32x16_bf16 v[144:159], v[100:103], v[120:123], v[144:159]
    s_add_u32 s45, s45, 65536
    v_add_u32 v30, s45, v7
    ds_read_b128 v[116:119], v30 offset:0
    ds_read_b64_tr_b16 v[80:81], v32 offset:32768
    v_mfma_f32_32x32x16_bf16 v[160:175], v[104:107], v[120:123], v[160:175]
    ds_read_b64_tr_b16 v[82:83], v32 offset:34816
    ds_read_b64_tr_b16 v[84:85], v33 offset:32768
    ds_read_b64_tr_b16 v[86:87], v33 offset:34816
    v_mfma_f32_32x32x16_bf16 v[176:191], v[108:111], v[120:123], v[176:191]
    ds_read_b64_tr_b16 v[88:89], v34 offset:32768
    ds_read_b64_tr_b16 v[90:91], v34 offset:34816
    ds_read_b64_tr_b16 v[92:93], v35 offset:32768
    ds_read_b64_tr_b16 v[94:95], v35 offset:34816
    s_waitcnt lgkmcnt(15)
    s_waitcnt lgkmcnt(9)
    s_add_u32 s44, s39, 7
    s_and_b32 s44, s44, 15
    s_lshl_b32 s44, s44, 15
    s_add_u32 m0, s48, 131072
    s_nop 0
    buffer_load_dwordx4 v20, s[24:27], s44 offen lds
    buffer_load_dwordx4 v21, s[24:27], s44 offen offset:1024 lds
    buffer_load_dwordx4 v22, s[24:27], s44 offen offset:2048 lds
    buffer_load_dwordx4 v23, s[24:27], s44 offen offset:3072 lds
    s_add_u32 m0, s48, 135168
    s_add_u32 s44, s44, 16384
    buffer_load_dwordx4 v20, s[24:27], s44 offen lds
    buffer_load_dwordx4 v21, s[24:27], s44 offen offset:1024 lds
    buffer_load_dwordx4 v22, s[24:27], s44 offen offset:2048 lds
    buffer_load_dwordx4 v23, s[24:27], s44 offen offset:3072 lds
    v_mfma_f32_32x32x16_bf16 v[128:143], v[64:67], v[112:115], v[128:143]
    ds_read_b128 v[120:123], v30 offset:1024
    ds_read_b64_tr_b16 v[96:97], v32 offset:36864
    v_mfma_f32_32x32x16_bf16 v[144:159], v[68:71], v[112:115], v[144:159]
    ds_read_b64_tr_b16 v[98:99], v32 offset:38912
    ds_read_b64_tr_b16 v[100:101], v33 offset:36864
    v_mfma_f32_32x32x16_bf16 v[160:175], v[72:75], v[112:115], v[160:175]
    ds_read_b64_tr_b16 v[102:103], v33 offset:38912
    ds_read_b64_tr_b16 v[104:105], v34 offset:36864
    v_mfma_f32_32x32x16_bf16 v[176:191], v[76:79], v[112:115], v[176:191]
    ds_read_b64_tr_b16 v[106:107], v34 offset:38912
    ds_read_b64_tr_b16 v[108:109], v35 offset:36864
    ds_read_b64_tr_b16 v[110:111], v35 offset:38912
    s_waitcnt lgkmcnt(15)
    s_waitcnt lgkmcnt(9)
    v_mfma_f32_32x32x16_bf16 v[128:143], v[80:83], v[116:119], v[128:143]
    s_add_u32 s45, s39, 0
    v_mfma_f32_32x32x16_bf16 v[144:159], v[84:87], v[116:119], v[144:159]
    s_and_b32 s45, s45, 15
    s_lshl_b32 s45, s45, 11
    v_mfma_f32_32x32x16_bf16 v[160:175], v[88:91], v[116:119], v[160:175]
    s_add_u32 s45, s45, 65536
    v_mfma_f32_32x32x16_bf16 v[176:191], v[92:95], v[116:119], v[176:191]
    v_add_u32 v30, s45, v7
    ds_read_b128 v[112:115], v30 offset:0
    s_waitcnt lgkmcnt(9)
    s_waitcnt lgkmcnt(1)
    s_add_u32 s44, s39, 8
    s_and_b32 s44, s44, 15
    s_lshl_b32 s44, s44, 15
    s_add_u32 m0, s48, 32768
    s_nop 0
    buffer_load_dwordx4 v20, s[24:27], s44 offen lds
    buffer_load_dwordx4 v21, s[24:27], s44 offen offset:1024 lds
    buffer_load_dwordx4 v22, s[24:27], s44 offen offset:2048 lds
    buffer_load_dwordx4 v23, s[24:27], s44 offen offset:3072 lds
    s_add_u32 m0, s48, 36864
    s_add_u32 s44, s44, 16384
    buffer_load_dwordx4 v20, s[24:27], s44 offen lds
    buffer_load_dwordx4 v21, s[24:27], s44 offen offset:1024 lds
    buffer_load_dwordx4 v22, s[24:27], s44 offen offset:2048 lds
    buffer_load_dwordx4 v23, s[24:27], s44 offen offset:3072 lds
    v_mfma_f32_32x32x16_bf16 v[128:143], v[96:99], v[120:123], v[128:143]
    v_mfma_f32_32x32x16_bf16 v[144:159], v[100:103], v[120:123], v[144:159]
    v_mfma_f32_32x32x16_bf16 v[160:175], v[104:107], v[120:123], v[160:175]
    v_mfma_f32_32x32x16_bf16 v[176:191], v[108:111], v[120:123], v[176:191]
    ds_read_b128 v[116:119], v30 offset:1024
    s_waitcnt lgkmcnt(1)
    s_waitcnt vmcnt(24)
    v_mfma_f32_32x32x16_bf16 v[128:143], a[64:67], v[112:115], v[128:143]
    s_add_u32 s45, s39, 5
    s_and_b32 s45, s45, 15
    s_lshl_b32 s45, s45, 11
    v_mfma_f32_32x32x16_bf16 v[144:159], a[68:71], v[112:115], v[144:159]
    s_add_u32 s45, s45, 65536
    v_add_u32 v30, s45, v7
    ds_read_b128 v[120:123], v30 offset:0
    ds_read_b64_tr_b16 v[96:97], v36 offset:32768
    v_mfma_f32_32x32x16_bf16 v[160:175], a[72:75], v[112:115], v[160:175]
    ds_read_b64_tr_b16 v[98:99], v36 offset:34816
    ds_read_b64_tr_b16 v[100:101], v37 offset:32768
    ds_read_b64_tr_b16 v[102:103], v37 offset:34816
    v_mfma_f32_32x32x16_bf16 v[176:191], a[76:79], v[112:115], v[176:191]
    ds_read_b64_tr_b16 v[104:105], v38 offset:32768
    ds_read_b64_tr_b16 v[106:107], v38 offset:34816
    ds_read_b64_tr_b16 v[108:109], v39 offset:32768
    ds_read_b64_tr_b16 v[110:111], v39 offset:34816
    s_waitcnt lgkmcnt(9)
    v_mfma_f32_32x32x16_bf16 v[128:143], a[80:83], v[116:119], v[128:143]
    ds_read_b128 v[112:115], v30 offset:1024
    ds_read_b64_tr_b16 v[64:65], v36 offset:36864
    v_mfma_f32_32x32x16_bf16 v[144:159], a[84:87], v[116:119], v[144:159]
    ds_read_b64_tr_b16 v[66:67], v36 offset:38912
    ds_read_b64_tr_b16 v[68:69], v37 offset:36864
    v_mfma_f32_32x32x16_bf16 v[160:175], a[88:91], v[116:119], v[160:175]
    ds_read_b64_tr_b16 v[70:71], v37 offset:38912
    ds_read_b64_tr_b16 v[72:73], v38 offset:36864
    v_mfma_f32_32x32x16_bf16 v[176:191], a[92:95], v[116:119], v[176:191]
    ds_read_b64_tr_b16 v[74:75], v38 offset:38912
    ds_read_b64_tr_b16 v[76:77], v39 offset:36864
    ds_read_b64_tr_b16 v[78:79], v39 offset:38912
    s_waitcnt lgkmcnt(15)
    s_waitcnt lgkmcnt(9)
    v_mfma_f32_32x32x16_bf16 v[128:143], v[96:99], v[120:123], v[128:143]
    s_add_u32 s45, s39, 1
    v_mfma_f32_32x32x16_bf16 v[144:159], v[100:103], v[120:123], v[144:159]
    s_and_b32 s45, s45, 15
    s_lshl_b32 s45, s45, 11
    v_mfma_f32_32x32x16_bf16 v[160:175], v[104:107], v[120:123], v[160:175]
    s_add_u32 s45, s45, 65536
    v_mfma_f32_32x32x16_bf16 v[176:191], v[108:111], v[120:123], v[176:191]
    v_add_u32 v30, s45, v7
    ds_read_b128 v[116:119], v30 offset:0
    s_waitcnt lgkmcnt(9)
    s_waitcnt lgkmcnt(1)
    s_add_u32 s44, s39, 9
    s_and_b32 s44, s44, 15
    s_lshl_b32 s44, s44, 15
    s_add_u32 m0, s48, 98304
    s_nop 0
    buffer_load_dwordx4 v20, s[24:27], s44 offen lds
    buffer_load_dwordx4 v21, s[24:27], s44 offen offset:1024 lds
    buffer_load_dwordx4 v22, s[24:27], s44 offen offset:2048 lds
    buffer_load_dwordx4 v23, s[24:27], s44 offen offset:3072 lds
    s_add_u32 m0, s48, 102400
    s_add_u32 s44, s44, 16384
    buffer_load_dwordx4 v20, s[24:27], s44 offen lds
    buffer_load_dwordx4 v21, s[24:27], s44 offen offset:1024 lds
    buffer_load_dwordx4 v22, s[24:27], s44 offen offset:2048 lds
    buffer_load_dwordx4 v23, s[24:27], s44 offen offset:3072 lds
    v_mfma_f32_32x32x16_bf16 v[128:143], v[64:67], v[112:115], v[128:143]
    v_mfma_f32_32x32x16_bf16 v[144:159], v[68:71], v[112:115], v[144:159]
    v_mfma_f32_32x32x16_bf16 v[160:175], v[72:75], v[112:115], v[160:175]
    v_mfma_f32_32x32x16_bf16 v[176:191], v[76:79], v[112:115], v[176:191]
    ds_read_b128 v[120:123], v30 offset:1024
    s_waitcnt lgkmcnt(1)
    s_waitcnt vmcnt(24)
    v_mfma_f32_32x32x16_bf16 v[128:143], a[96:99], v[116:119], v[128:143]
    s_add_u32 s45, s39, 6
    s_and_b32 s45, s45, 15
    s_lshl_b32 s45, s45, 11
    v_mfma_f32_32x32x16_bf16 v[144:159], a[100:103], v[116:119], v[144:159]
    s_add_u32 s45, s45, 65536
    v_add_u32 v30, s45, v7
    ds_read_b128 v[112:115], v30 offset:0
    ds_read_b64_tr_b16 v[64:65], v32 offset:0
    v_mfma_f32_32x32x16_bf16 v[160:175], a[104:107], v[116:119], v[160:175]
    ds_read_b64_tr_b16 v[66:67], v32 offset:2048
    ds_read_b64_tr_b16 v[68:69], v33 offset:0
    ds_read_b64_tr_b16 v[70:71], v33 offset:2048
    v_mfma_f32_32x32x16_bf16 v[176:191], a[108:111], v[116:119], v[176:191]
    ds_read_b64_tr_b16 v[72:73], v34 offset:0
    ds_read_b64_tr_b16 v[74:75], v34 offset:2048
    ds_read_b64_tr_b16 v[76:77], v35 offset:0
    ds_read_b64_tr_b16 v[78:79], v35 offset:2048
    s_waitcnt lgkmcnt(9)
    v_mfma_f32_32x32x16_bf16 v[128:143], a[112:115], v[120:123], v[128:143]
    ds_read_b128 v[116:119], v30 offset:1024
    ds_read_b64_tr_b16 v[80:81], v32 offset:4096
    v_mfma_f32_32x32x16_bf16 v[144:159], a[116:119], v[120:123], v[144:159]
    ds_read_b64_tr_b16 v[82:83], v32 offset:6144
    ds_read_b64_tr_b16 v[84:85], v33 offset:4096
    v_mfma_f32_32x32x16_bf16 v[160:175], a[120:123], v[120:123], v[160:175]
    ds_read_b64_tr_b16 v[86:87], v33 offset:6144
    ds_read_b64_tr_b16 v[88:89], v34 offset:4096
    v_mfma_f32_32x32x16_bf16 v[176:191], a[124:127], v[120:123], v[176:191]
    ds_read_b64_tr_b16 v[90:91], v34 offset:6144
    ds_read_b64_tr_b16 v[92:93], v35 offset:4096
    ds_read_b64_tr_b16 v[94:95], v35 offset:6144
    s_waitcnt lgkmcnt(15)
    s_waitcnt lgkmcnt(9)
    s_waitcnt vmcnt(16)
    v_mfma_f32_32x32x16_bf16 v[128:143], v[64:67], v[112:115], v[128:143]
    s_add_u32 s45, s39, 7
    s_and_b32 s45, s45, 15
    s_lshl_b32 s45, s45, 11
    v_mfma_f32_32x32x16_bf16 v[144:159], v[68:71], v[112:115], v[144:159]
    s_add_u32 s45, s45, 65536
    v_add_u32 v30, s45, v7
    ds_read_b128 v[120:123], v30 offset:0
    ds_read_b64_tr_b16 v[96:97], v40 offset:0
    v_mfma_f32_32x32x16_bf16 v[160:175], v[72:75], v[112:115], v[160:175]
    ds_read_b64_tr_b16 v[98:99], v40 offset:2048
    ds_read_b64_tr_b16 v[100:101], v41 offset:0
    ds_read_b64_tr_b16 v[102:103], v41 offset:2048
    v_mfma_f32_32x32x16_bf16 v[176:191], v[76:79], v[112:115], v[176:191]
    ds_read_b64_tr_b16 v[104:105], v42 offset:0
    ds_read_b64_tr_b16 v[106:107], v42 offset:2048
    ds_read_b64_tr_b16 v[108:109], v43 offset:0
    ds_read_b64_tr_b16 v[110:111], v43 offset:2048
    s_waitcnt lgkmcnt(15)
    s_waitcnt lgkmcnt(9)
    s_add_u32 s44, s39, 10
    s_and_b32 s44, s44, 15
    s_lshl_b32 s44, s44, 15
    s_add_u32 m0, s48, 0
    s_nop 0
    buffer_load_dwordx4 v20, s[24:27], s44 offen lds
    buffer_load_dwordx4 v21, s[24:27], s44 offen offset:1024 lds
    buffer_load_dwordx4 v22, s[24:27], s44 offen offset:2048 lds
    buffer_load_dwordx4 v23, s[24:27], s44 offen offset:3072 lds
    s_add_u32 m0, s48, 4096
    s_add_u32 s44, s44, 16384
    buffer_load_dwordx4 v20, s[24:27], s44 offen lds
    buffer_load_dwordx4 v21, s[24:27], s44 offen offset:1024 lds
    buffer_load_dwordx4 v22, s[24:27], s44 offen offset:2048 lds
    buffer_load_dwordx4 v23, s[24:27], s44 offen offset:3072 lds
    v_mfma_f32_32x32x16_bf16 v[128:143], v[80:83], v[116:119], v[128:143]
    ds_read_b128 v[112:115], v30 offset:1024
    ds_read_b64_tr_b16 v[64:65], v40 offset:4096
    v_mfma_f32_32x32x16_bf16 v[144:159], v[84:87], v[116:119], v[144:159]
    ds_read_b64_tr_b16 v[66:67], v40 offset:6144
    ds_read_b64_tr_b16 v[68:69], v41 offset:4096
    v_mfma_f32_32x32x16_bf16 v[160:175], v[88:91], v[116:119], v[160:175]
    ds_read_b64_tr_b16 v[70:71], v41 offset:6144
    ds_read_b64_tr_b16 v[72:73], v42 offset:4096
    v_mfma_f32_32x32x16_bf16 v[176:191], v[92:95], v[116:119], v[176:191]
    ds_read_b64_tr_b16 v[74:75], v42 offset:6144
    ds_read_b64_tr_b16 v[76:77], v43 offset:4096
    ds_read_b64_tr_b16 v[78:79], v43 offset:6144
    s_waitcnt lgkmcnt(15)
    s_waitcnt lgkmcnt(9)
    s_waitcnt vmcnt(16)
    v_mfma_f32_32x32x16_bf16 v[128:143], v[96:99], v[120:123], v[128:143]
    s_add_u32 s45, s39, 8
    s_and_b32 s45, s45, 15
    s_lshl_b32 s45, s45, 11
    v_mfma_f32_32x32x16_bf16 v[144:159], v[100:103], v[120:123], v[144:159]
    s_add_u32 s45, s45, 65536
    v_add_u32 v30, s45, v7
    ds_read_b128 v[116:119], v30 offset:0
    ds_read_b64_tr_b16 v[80:81], v32 offset:32768
    v_mfma_f32_32x32x16_bf16 v[160:175], v[104:107], v[120:123], v[160:175]
    ds_read_b64_tr_b16 v[82:83], v32 offset:34816
    ds_read_b64_tr_b16 v[84:85], v33 offset:32768
    ds_read_b64_tr_b16 v[86:87], v33 offset:34816
    v_mfma_f32_32x32x16_bf16 v[176:191], v[108:111], v[120:123], v[176:191]
    ds_read_b64_tr_b16 v[88:89], v34 offset:32768
    ds_read_b64_tr_b16 v[90:91], v34 offset:34816
    ds_read_b64_tr_b16 v[92:93], v35 offset:32768
    ds_read_b64_tr_b16 v[94:95], v35 offset:34816
    s_waitcnt lgkmcnt(15)
    s_waitcnt lgkmcnt(9)
    s_add_u32 s44, s39, 11
    s_and_b32 s44, s44, 15
    s_lshl_b32 s44, s44, 15
    s_add_u32 m0, s48, 131072
    s_nop 0
    buffer_load_dwordx4 v20, s[24:27], s44 offen lds
    buffer_load_dwordx4 v21, s[24:27], s44 offen offset:1024 lds
    buffer_load_dwordx4 v22, s[24:27], s44 offen offset:2048 lds
    buffer_load_dwordx4 v23, s[24:27], s44 offen offset:3072 lds
    s_add_u32 m0, s48, 135168
    s_add_u32 s44, s44, 16384
    buffer_load_dwordx4 v20, s[24:27], s44 offen lds
    buffer_load_dwordx4 v21, s[24:27], s44 offen offset:1024 lds
    buffer_load_dwordx4 v22, s[24:27], s44 offen offset:2048 lds
    buffer_load_dwordx4 v23, s[24:27], s44 offen offset:3072 lds
    v_mfma_f32_32x32x16_bf16 v[128:143], v[64:67], v[112:115], v[128:143]
    ds_read_b128 v[120:123], v30 offset:1024
    ds_read_b64_tr_b16 v[96:97], v32 offset:36864
    v_mfma_f32_32x32x16_bf16 v[144:159], v[68:71], v[112:115], v[144:159]
    ds_read_b64_tr_b16 v[98:99], v32 offset:38912
    ds_read_b64_tr_b16 v[100:101], v33 offset:36864
    v_mfma_f32_32x32x16_bf16 v[160:175], v[72:75], v[112:115], v[160:175]
    ds_read_b64_tr_b16 v[102:103], v33 offset:38912
    ds_read_b64_tr_b16 v[104:105], v34 offset:36864
    v_mfma_f32_32x32x16_bf16 v[176:191], v[76:79], v[112:115], v[176:191]
    ds_read_b64_tr_b16 v[106:107], v34 offset:38912
    ds_read_b64_tr_b16 v[108:109], v35 offset:36864
    ds_read_b64_tr_b16 v[110:111], v35 offset:38912
    s_waitcnt lgkmcnt(15)
    s_waitcnt lgkmcnt(9)
    s_waitcnt vmcnt(16)
    v_mfma_f32_32x32x16_bf16 v[128:143], v[80:83], v[116:119], v[128:143]
    s_add_u32 s45, s39, 9
    s_and_b32 s45, s45, 15
    s_lshl_b32 s45, s45, 11
    v_mfma_f32_32x32x16_bf16 v[144:159], v[84:87], v[116:119], v[144:159]
    s_add_u32 s45, s45, 65536
    v_add_u32 v30, s45, v7
    ds_read_b128 v[112:115], v30 offset:0
    ds_read_b64_tr_b16 v[64:65], v36 offset:32768
    v_mfma_f32_32x32x16_bf16 v[160:175], v[88:91], v[116:119], v[160:175]
    ds_read_b64_tr_b16 v[66:67], v36 offset:34816
    ds_read_b64_tr_b16 v[68:69], v37 offset:32768
    ds_read_b64_tr_b16 v[70:71], v37 offset:34816
    v_mfma_f32_32x32x16_bf16 v[176:191], v[92:95], v[116:119], v[176:191]
    ds_read_b64_tr_b16 v[72:73], v38 offset:32768
    ds_read_b64_tr_b16 v[74:75], v38 offset:34816
    ds_read_b64_tr_b16 v[76:77], v39 offset:32768
    ds_read_b64_tr_b16 v[78:79], v39 offset:34816
    s_waitcnt lgkmcnt(15)
    s_waitcnt lgkmcnt(9)
    s_add_u32 s44, s39, 12
    s_and_b32 s44, s44, 15
    s_lshl_b32 s44, s44, 15
    s_add_u32 m0, s48, 32768
    s_nop 0
    buffer_load_dwordx4 v20, s[24:27], s44 offen lds
    buffer_load_dwordx4 v21, s[24:27], s44 offen offset:1024 lds
    buffer_load_dwordx4 v22, s[24:27], s44 offen offset:2048 lds
    buffer_load_dwordx4 v23, s[24:27], s44 offen offset:3072 lds
    s_add_u32 m0, s48, 36864
    s_add_u32 s44, s44, 16384
    buffer_load_dwordx4 v20, s[24:27], s44 offen lds
    buffer_load_dwordx4 v21, s[24:27], s44 offen offset:1024 lds
    buffer_load_dwordx4 v22, s[24:27], s44 offen offset:2048 lds
    buffer_load_dwordx4 v23, s[24:27], s44 offen offset:3072 lds
    v_mfma_f32_32x32x16_bf16 v[128:143], v[96:99], v[120:123], v[128:143]
    ds_read_b128 v[116:119], v30 offset:1024
    ds_read_b64_tr_b16 v[80:81], v36 offset:36864
    v_mfma_f32_32x32x16_bf16 v[144:159], v[100:103], v[120:123], v[144:159]
    ds_read_b64_tr_b16 v[82:83], v36 offset:38912
    ds_read_b64_tr_b16 v[84:85], v37 offset:36864
    v_mfma_f32_32x32x16_bf16 v[160:175], v[104:107], v[120:123], v[160:175]
    ds_read_b64_tr_b16 v[86:87], v37 offset:38912
    ds_read_b64_tr_b16 v[88:89], v38 offset:36864
    v_mfma_f32_32x32x16_bf16 v[176:191], v[108:111], v[120:123], v[176:191]
    ds_read_b64_tr_b16 v[90:91], v38 offset:38912
    ds_read_b64_tr_b16 v[92:93], v39 offset:36864
    ds_read_b64_tr_b16 v[94:95], v39 offset:38912
    s_waitcnt lgkmcnt(15)
    s_waitcnt lgkmcnt(9)
    s_waitcnt vmcnt(16)
    v_mfma_f32_32x32x16_bf16 v[128:143], v[64:67], v[112:115], v[128:143]
    s_add_u32 s45, s39, 10
    s_and_b32 s45, s45, 15
    s_lshl_b32 s45, s45, 11
    v_mfma_f32_32x32x16_bf16 v[144:159], v[68:71], v[112:115], v[144:159]
    s_add_u32 s45, s45, 65536
    v_add_u32 v30, s45, v7
    ds_read_b128 v[120:123], v30 offset:0
    ds_read_b64_tr_b16 v[96:97], v32 offset:0
    v_mfma_f32_32x32x16_bf16 v[160:175], v[72:75], v[112:115], v[160:175]
    ds_read_b64_tr_b16 v[98:99], v32 offset:2048
    ds_read_b64_tr_b16 v[100:101], v33 offset:0
    ds_read_b64_tr_b16 v[102:103], v33 offset:2048
    v_mfma_f32_32x32x16_bf16 v[176:191], v[76:79], v[112:115], v[176:191]
    ds_read_b64_tr_b16 v[104:105], v34 offset:0
    ds_read_b64_tr_b16 v[106:107], v34 offset:2048
    ds_read_b64_tr_b16 v[108:109], v35 offset:0
    ds_read_b64_tr_b16 v[110:111], v35 offset:2048
    s_waitcnt lgkmcnt(15)
    s_waitcnt lgkmcnt(9)
    s_add_u32 s44, s39, 13
    s_and_b32 s44, s44, 15
    s_lshl_b32 s44, s44, 15
    s_add_u32 m0, s48, 98304
    s_nop 0
    buffer_load_dwordx4 v20, s[24:27], s44 offen lds
    buffer_load_dwordx4 v21, s[24:27], s44 offen offset:1024 lds
    buffer_load_dwordx4 v22, s[24:27], s44 offen offset:2048 lds
    buffer_load_dwordx4 v23, s[24:27], s44 offen offset:3072 lds
    s_add_u32 m0, s48, 102400
    s_add_u32 s44, s44, 16384
    buffer_load_dwordx4 v20, s[24:27], s44 offen lds
    buffer_load_dwordx4 v21, s[24:27], s44 offen offset:1024 lds
    buffer_load_dwordx4 v22, s[24:27], s44 offen offset:2048 lds
    buffer_load_dwordx4 v23, s[24:27], s44 offen offset:3072 lds
    v_mfma_f32_32x32x16_bf16 v[128:143], v[80:83], v[116:119], v[128:143]
    ds_read_b128 v[112:115], v30 offset:1024
    ds_read_b64_tr_b16 v[64:65], v32 offset:4096
    v_mfma_f32_32x32x16_bf16 v[144:159], v[84:87], v[116:119], v[144:159]
    ds_read_b64_tr_b16 v[66:67], v32 offset:6144
    ds_read_b64_tr_b16 v[68:69], v33 offset:4096
    v_mfma_f32_32x32x16_bf16 v[160:175], v[88:91], v[116:119], v[160:175]
    ds_read_b64_tr_b16 v[70:71], v33 offset:6144
    ds_read_b64_tr_b16 v[72:73], v34 offset:4096
    v_mfma_f32_32x32x16_bf16 v[176:191], v[92:95], v[116:119], v[176:191]
    ds_read_b64_tr_b16 v[74:75], v34 offset:6144
    ds_read_b64_tr_b16 v[76:77], v35 offset:4096
    ds_read_b64_tr_b16 v[78:79], v35 offset:6144
    s_waitcnt lgkmcnt(15)
    s_waitcnt lgkmcnt(9)
    s_waitcnt vmcnt(16)
    v_mfma_f32_32x32x16_bf16 v[128:143], v[96:99], v[120:123], v[128:143]
    s_add_u32 s45, s39, 11
    s_and_b32 s45, s45, 15
    s_lshl_b32 s45, s45, 11
    v_mfma_f32_32x32x16_bf16 v[144:159], v[100:103], v[120:123], v[144:159]
    s_add_u32 s45, s45, 65536
    v_add_u32 v30, s45, v7
    ds_read_b128 v[116:119], v30 offset:0
    ds_read_b64_tr_b16 v[80:81], v40 offset:0
    v_mfma_f32_32x32x16_bf16 v[160:175], v[104:107], v[120:123], v[160:175]
    ds_read_b64_tr_b16 v[82:83], v40 offset:2048
    ds_read_b64_tr_b16 v[84:85], v41 offset:0
    ds_read_b64_tr_b16 v[86:87], v41 offset:2048
    v_mfma_f32_32x32x16_bf16 v[176:191], v[108:111], v[120:123], v[176:191]
    ds_read_b64_tr_b16 v[88:89], v42 offset:0
    ds_read_b64_tr_b16 v[90:91], v42 offset:2048
    ds_read_b64_tr_b16 v[92:93], v43 offset:0
    ds_read_b64_tr_b16 v[94:95], v43 offset:2048
    s_waitcnt lgkmcnt(15)
    s_waitcnt lgkmcnt(9)
    s_add_u32 s44, s39, 14
    s_and_b32 s44, s44, 15
    s_lshl_b32 s44, s44, 15
    s_add_u32 m0, s48, 0
    s_nop 0
    buffer_load_dwordx4 v20, s[24:27], s44 offen lds
    buffer_load_dwordx4 v21, s[24:27], s44 offen offset:1024 lds
    buffer_load_dwordx4 v22, s[24:27], s44 offen offset:2048 lds
    buffer_load_dwordx4 v23, s[24:27], s44 offen offset:3072 lds
    s_add_u32 m0, s48, 4096
    s_add_u32 s44, s44, 16384
    buffer_load_dwordx4 v20, s[24:27], s44 offen lds
    buffer_load_dwordx4 v21, s[24:27], s44 offen offset:1024 lds
    buffer_load_dwordx4 v22, s[24:27], s44 offen offset:2048 lds
    buffer_load_dwordx4 v23, s[24:27], s44 offen offset:3072 lds
    v_mfma_f32_32x32x16_bf16 v[128:143], v[64:67], v[112:115], v[128:143]
    ds_read_b128 v[120:123], v30 offset:1024
    ds_read_b64_tr_b16 v[96:97], v40 offset:4096
    v_mfma_f32_32x32x16_bf16 v[144:159], v[68:71], v[112:115], v[144:159]
    ds_read_b64_tr_b16 v[98:99], v40 offset:6144
    ds_read_b64_tr_b16 v[100:101], v41 offset:4096
    v_mfma_f32_32x32x16_bf16 v[160:175], v[72:75], v[112:115], v[160:175]
    ds_read_b64_tr_b16 v[102:103], v41 offset:6144
    ds_read_b64_tr_b16 v[104:105], v42 offset:4096
    v_mfma_f32_32x32x16_bf16 v[176:191], v[76:79], v[112:115], v[176:191]
    ds_read_b64_tr_b16 v[106:107], v42 offset:6144
    ds_read_b64_tr_b16 v[108:109], v43 offset:4096
    ds_read_b64_tr_b16 v[110:111], v43 offset:6144
    s_waitcnt lgkmcnt(15)
    s_waitcnt lgkmcnt(9)
    s_waitcnt vmcnt(16)
    v_mfma_f32_32x32x16_bf16 v[128:143], v[80:83], v[116:119], v[128:143]
    s_add_u32 s45, s39, 12
    s_and_b32 s45, s45, 15
    s_lshl_b32 s45, s45, 11
    v_mfma_f32_32x32x16_bf16 v[144:159], v[84:87], v[116:119], v[144:159]
    s_add_u32 s45, s45, 65536
    v_add_u32 v30, s45, v7
    ds_read_b128 v[112:115], v30 offset:0
    ds_read_b64_tr_b16 v[64:65], v32 offset:32768
    v_mfma_f32_32x32x16_bf16 v[160:175], v[88:91], v[116:119], v[160:175]
    ds_read_b64_tr_b16 v[66:67], v32 offset:34816
    ds_read_b64_tr_b16 v[68:69], v33 offset:32768
    ds_read_b64_tr_b16 v[70:71], v33 offset:34816
    v_mfma_f32_32x32x16_bf16 v[176:191], v[92:95], v[116:119], v[176:191]
    ds_read_b64_tr_b16 v[72:73], v34 offset:32768
    ds_read_b64_tr_b16 v[74:75], v34 offset:34816
    ds_read_b64_tr_b16 v[76:77], v35 offset:32768
    ds_read_b64_tr_b16 v[78:79], v35 offset:34816
    s_waitcnt lgkmcnt(15)
    s_waitcnt lgkmcnt(9)
    s_add_u32 s44, s39, 15
    s_and_b32 s44, s44, 15
    s_lshl_b32 s44, s44, 15
    s_add_u32 m0, s48, 131072
    s_nop 0
    buffer_load_dwordx4 v20, s[24:27], s44 offen lds
    buffer_load_dwordx4 v21, s[24:27], s44 offen offset:1024 lds
    buffer_load_dwordx4 v22, s[24:27], s44 offen offset:2048 lds
    buffer_load_dwordx4 v23, s[24:27], s44 offen offset:3072 lds
    s_add_u32 m0, s48, 135168
    s_add_u32 s44, s44, 16384
    buffer_load_dwordx4 v20, s[24:27], s44 offen lds
    buffer_load_dwordx4 v21, s[24:27], s44 offen offset:1024 lds
    buffer_load_dwordx4 v22, s[24:27], s44 offen offset:2048 lds
    buffer_load_dwordx4 v23, s[24:27], s44 offen offset:3072 lds
    v_mfma_f32_32x32x16_bf16 v[128:143], v[96:99], v[120:123], v[128:143]
    ds_read_b128 v[116:119], v30 offset:1024
    ds_read_b64_tr_b16 v[80:81], v32 offset:36864
    v_mfma_f32_32x32x16_bf16 v[144:159], v[100:103], v[120:123], v[144:159]
    ds_read_b64_tr_b16 v[82:83], v32 offset:38912
    ds_read_b64_tr_b16 v[84:85], v33 offset:36864
    v_mfma_f32_32x32x16_bf16 v[160:175], v[104:107], v[120:123], v[160:175]
    ds_read_b64_tr_b16 v[86:87], v33 offset:38912
    ds_read_b64_tr_b16 v[88:89], v34 offset:36864
    v_mfma_f32_32x32x16_bf16 v[176:191], v[108:111], v[120:123], v[176:191]
    ds_read_b64_tr_b16 v[90:91], v34 offset:38912
    ds_read_b64_tr_b16 v[92:93], v35 offset:36864
    ds_read_b64_tr_b16 v[94:95], v35 offset:38912
    s_waitcnt lgkmcnt(15)
    s_waitcnt lgkmcnt(9)
    s_waitcnt vmcnt(16)
    v_mfma_f32_32x32x16_bf16 v[128:143], v[64:67], v[112:115], v[128:143]
    s_add_u32 s45, s39, 13
    s_and_b32 s45, s45, 15
    s_lshl_b32 s45, s45, 11
    v_mfma_f32_32x32x16_bf16 v[144:159], v[68:71], v[112:115], v[144:159]
    s_add_u32 s45, s45, 65536
    v_add_u32 v30, s45, v7
    ds_read_b128 v[120:123], v30 offset:0
    ds_read_b64_tr_b16 v[96:97], v36 offset:32768
    v_mfma_f32_32x32x16_bf16 v[160:175], v[72:75], v[112:115], v[160:175]
    ds_read_b64_tr_b16 v[98:99], v36 offset:34816
    ds_read_b64_tr_b16 v[100:101], v37 offset:32768
    ds_read_b64_tr_b16 v[102:103], v37 offset:34816
    v_mfma_f32_32x32x16_bf16 v[176:191], v[76:79], v[112:115], v[176:191]
    ds_read_b64_tr_b16 v[104:105], v38 offset:32768
    ds_read_b64_tr_b16 v[106:107], v38 offset:34816
    ds_read_b64_tr_b16 v[108:109], v39 offset:32768
    ds_read_b64_tr_b16 v[110:111], v39 offset:34816
    s_waitcnt lgkmcnt(15)
    s_waitcnt lgkmcnt(9)
    v_mfma_f32_32x32x16_bf16 v[128:143], v[80:83], v[116:119], v[128:143]
    ds_read_b128 v[112:115], v30 offset:1024
    ds_read_b64_tr_b16 v[64:65], v36 offset:36864
    v_mfma_f32_32x32x16_bf16 v[144:159], v[84:87], v[116:119], v[144:159]
    ds_read_b64_tr_b16 v[66:67], v36 offset:38912
    ds_read_b64_tr_b16 v[68:69], v37 offset:36864
    v_mfma_f32_32x32x16_bf16 v[160:175], v[88:91], v[116:119], v[160:175]
    ds_read_b64_tr_b16 v[70:71], v37 offset:38912
    ds_read_b64_tr_b16 v[72:73], v38 offset:36864
    v_mfma_f32_32x32x16_bf16 v[176:191], v[92:95], v[116:119], v[176:191]
    ds_read_b64_tr_b16 v[74:75], v38 offset:38912
    ds_read_b64_tr_b16 v[76:77], v39 offset:36864
    ds_read_b64_tr_b16 v[78:79], v39 offset:38912
    s_waitcnt lgkmcnt(15)
    s_waitcnt lgkmcnt(9)
    s_waitcnt vmcnt(8)
    v_mfma_f32_32x32x16_bf16 v[128:143], v[96:99], v[120:123], v[128:143]
    s_add_u32 s45, s39, 14
    s_and_b32 s45, s45, 15
    s_lshl_b32 s45, s45, 11
    v_mfma_f32_32x32x16_bf16 v[144:159], v[100:103], v[120:123], v[144:159]
    s_add_u32 s45, s45, 65536
    v_add_u32 v30, s45, v7
    ds_read_b128 v[116:119], v30 offset:0
    ds_read_b64_tr_b16 v[80:81], v32 offset:0
    v_mfma_f32_32x32x16_bf16 v[160:175], v[104:107], v[120:123], v[160:175]
    ds_read_b64_tr_b16 v[82:83], v32 offset:2048
    ds_read_b64_tr_b16 v[84:85], v33 offset:0
    ds_read_b64_tr_b16 v[86:87], v33 offset:2048
    v_mfma_f32_32x32x16_bf16 v[176:191], v[108:111], v[120:123], v[176:191]
    ds_read_b64_tr_b16 v[88:89], v34 offset:0
    ds_read_b64_tr_b16 v[90:91], v34 offset:2048
    ds_read_b64_tr_b16 v[92:93], v35 offset:0
    ds_read_b64_tr_b16 v[94:95], v35 offset:2048
    s_waitcnt lgkmcnt(15)
    s_waitcnt lgkmcnt(9)
    v_mfma_f32_32x32x16_bf16 v[128:143], v[64:67], v[112:115], v[128:143]
    ds_read_b128 v[120:123], v30 offset:1024
    ds_read_b64_tr_b16 v[96:97], v32 offset:4096
    v_mfma_f32_32x32x16_bf16 v[144:159], v[68:71], v[112:115], v[144:159]
    ds_read_b64_tr_b16 v[98:99], v32 offset:6144
    ds_read_b64_tr_b16 v[100:101], v33 offset:4096
    v_mfma_f32_32x32x16_bf16 v[160:175], v[72:75], v[112:115], v[160:175]
    ds_read_b64_tr_b16 v[102:103], v33 offset:6144
    ds_read_b64_tr_b16 v[104:105], v34 offset:4096
    v_mfma_f32_32x32x16_bf16 v[176:191], v[76:79], v[112:115], v[176:191]
    ds_read_b64_tr_b16 v[106:107], v34 offset:6144
    ds_read_b64_tr_b16 v[108:109], v35 offset:4096
    ds_read_b64_tr_b16 v[110:111], v35 offset:6144
    s_waitcnt lgkmcnt(15)
    s_waitcnt lgkmcnt(9)
    s_waitcnt vmcnt(0)
    v_mfma_f32_32x32x16_bf16 v[128:143], v[80:83], v[116:119], v[128:143]
    s_add_u32 s45, s39, 15
    s_and_b32 s45, s45, 15
    s_lshl_b32 s45, s45, 11
    v_mfma_f32_32x32x16_bf16 v[144:159], v[84:87], v[116:119], v[144:159]
    s_add_u32 s45, s45, 65536
    v_add_u32 v30, s45, v7
    ds_read_b128 v[112:115], v30 offset:0
    ds_read_b64_tr_b16 v[64:65], v40 offset:0
    v_mfma_f32_32x32x16_bf16 v[160:175], v[88:91], v[116:119], v[160:175]
    ds_read_b64_tr_b16 v[66:67], v40 offset:2048
    ds_read_b64_tr_b16 v[68:69], v41 offset:0
    ds_read_b64_tr_b16 v[70:71], v41 offset:2048
    v_mfma_f32_32x32x16_bf16 v[176:191], v[92:95], v[116:119], v[176:191]
    ds_read_b64_tr_b16 v[72:73], v42 offset:0
    ds_read_b64_tr_b16 v[74:75], v42 offset:2048
    ds_read_b64_tr_b16 v[76:77], v43 offset:0
    ds_read_b64_tr_b16 v[78:79], v43 offset:2048
    s_waitcnt lgkmcnt(15)
    s_waitcnt lgkmcnt(9)
    v_mfma_f32_32x32x16_bf16 v[128:143], v[96:99], v[120:123], v[128:143]
    ds_read_b128 v[116:119], v30 offset:1024
    ds_read_b64_tr_b16 v[80:81], v40 offset:4096
    v_mfma_f32_32x32x16_bf16 v[144:159], v[100:103], v[120:123], v[144:159]
    ds_read_b64_tr_b16 v[82:83], v40 offset:6144
    ds_read_b64_tr_b16 v[84:85], v41 offset:4096
    v_mfma_f32_32x32x16_bf16 v[160:175], v[104:107], v[120:123], v[160:175]
    ds_read_b64_tr_b16 v[86:87], v41 offset:6144
    ds_read_b64_tr_b16 v[88:89], v42 offset:4096
    v_mfma_f32_32x32x16_bf16 v[176:191], v[108:111], v[120:123], v[176:191]
    ds_read_b64_tr_b16 v[90:91], v42 offset:6144
    ds_read_b64_tr_b16 v[92:93], v43 offset:4096
    ds_read_b64_tr_b16 v[94:95], v43 offset:6144
    s_waitcnt lgkmcnt(15)
    s_waitcnt lgkmcnt(9)
    v_mfma_f32_32x32x16_bf16 v[128:143], v[64:67], v[112:115], v[128:143]
    v_mfma_f32_32x32x16_bf16 v[144:159], v[68:71], v[112:115], v[144:159]
    v_mfma_f32_32x32x16_bf16 v[160:175], v[72:75], v[112:115], v[160:175]
    v_mfma_f32_32x32x16_bf16 v[176:191], v[76:79], v[112:115], v[176:191]
    s_waitcnt lgkmcnt(8)
    s_waitcnt lgkmcnt(0)
    v_mfma_f32_32x32x16_bf16 v[128:143], v[80:83], v[116:119], v[128:143]
    v_mfma_f32_32x32x16_bf16 v[144:159], v[84:87], v[116:119], v[144:159]
    v_mfma_f32_32x32x16_bf16 v[160:175], v[88:91], v[116:119], v[160:175]
    v_mfma_f32_32x32x16_bf16 v[176:191], v[92:95], v[116:119], v[176:191]
    s_lshl_b32 s44, s38, 13
    v_add_u32 v29, s44, v7
    s_nop 6
    v_cvt_pk_bf16_f32 v64, v128, v129
    v_cvt_pk_bf16_f32 v65, v130, v131
    v_cvt_pk_bf16_f32 v66, v132, v133
    v_cvt_pk_bf16_f32 v67, v134, v135
    v_cvt_pk_bf16_f32 v68, v136, v137
    v_cvt_pk_bf16_f32 v69, v138, v139
    v_cvt_pk_bf16_f32 v70, v140, v141
    v_cvt_pk_bf16_f32 v71, v142, v143
    s_mov_b32 s45, 0
    buffer_store_dwordx4 v[64:67], v29, s[28:31], s45 offen sc1
    buffer_store_dwordx4 v[68:71], v29, s[28:31], s45 offen offset:1024 sc1
    v_cvt_pk_bf16_f32 v72, v144, v145
    v_cvt_pk_bf16_f32 v73, v146, v147
    v_cvt_pk_bf16_f32 v74, v148, v149
    v_cvt_pk_bf16_f32 v75, v150, v151
    v_cvt_pk_bf16_f32 v76, v152, v153
    v_cvt_pk_bf16_f32 v77, v154, v155
    v_cvt_pk_bf16_f32 v78, v156, v157
    v_cvt_pk_bf16_f32 v79, v158, v159
    s_mov_b32 s45, 2048
    buffer_store_dwordx4 v[72:75], v29, s[28:31], s45 offen sc1
    buffer_store_dwordx4 v[76:79], v29, s[28:31], s45 offen offset:1024 sc1
    v_cvt_pk_bf16_f32 v80, v160, v161
    v_cvt_pk_bf16_f32 v81, v162, v163
    v_cvt_pk_bf16_f32 v82, v164, v165
    v_cvt_pk_bf16_f32 v83, v166, v167
    v_cvt_pk_bf16_f32 v84, v168, v169
    v_cvt_pk_bf16_f32 v85, v170, v171
    v_cvt_pk_bf16_f32 v86, v172, v173
    v_cvt_pk_bf16_f32 v87, v174, v175
    s_mov_b32 s45, 4096
    buffer_store_dwordx4 v[80:83], v29, s[28:31], s45 offen sc1
    buffer_store_dwordx4 v[84:87], v29, s[28:31], s45 offen offset:1024 sc1
    v_cvt_pk_bf16_f32 v88, v176, v177
    v_cvt_pk_bf16_f32 v89, v178, v179
    v_cvt_pk_bf16_f32 v90, v180, v181
    v_cvt_pk_bf16_f32 v91, v182, v183
    v_cvt_pk_bf16_f32 v92, v184, v185
    v_cvt_pk_bf16_f32 v93, v186, v187
    v_cvt_pk_bf16_f32 v94, v188, v189
    v_cvt_pk_bf16_f32 v95, v190, v191
    s_mov_b32 s45, 6144
    buffer_store_dwordx4 v[88:91], v29, s[28:31], s45 offen sc1
    buffer_store_dwordx4 v[92:95], v29, s[28:31], s45 offen offset:1024 sc1
    s_waitcnt vmcnt(0)
    s_barrier
    s_lshl_b32 s44, s36, 3
    v_mov_b32 v6, s44
    s_lshl_b32 s45, s36, 7
    s_add_u32 s45, s45, 16777216
    v_lshl_add_u32 v20, v1, 2, s45
    s_lshl_b32 s46, s37, 2
    s_add_u32 s46, s46, s45
    v_mov_b32 v2, s46
    v_readfirstlane_b32 s51, v0
    s_cmp_lg_u32 s38, 0
    s_cbranch_scc1 L_nosig
    s_mov_b64 exec, 1
    s_mov_b32 s50, 0x10000
L_npoll:
    s_cmp_lg_u32 s51, 0
    s_cbranch_scc1 L_ngot
    global_load_dword v8, v6, s[92:93] sc1
    s_waitcnt vmcnt(0)
    v_readfirstlane_b32 s51, v8
    s_sub_u32 s50, s50, 1
    s_cmp_lg_u32 s50, 0
    s_cbranch_scc1 L_npoll
L_ngot:
    v_mov_b32 v3, s51
    global_store_dword v2, v3, s[94:95] sc1
    s_mov_b64 exec, 0xff
    s_mov_b32 s50, 0x10000
L_poll:
    global_load_dword v8, v20, s[94:95] sc1
    s_waitcnt vmcnt(0)
    v_cmp_ne_u32 vcc, s51, v8
    s_nop 4
    s_cmp_eq_u64 vcc, 0
    s_cbranch_scc1 L_go
    s_sleep 2
    s_sub_u32 s50, s50, 1
    s_cmp_lg_u32 s50, 0
    s_cbranch_scc1 L_poll
L_go:
    s_mov_b64 exec, -1
L_nosig:
    s_lshl_b32 s45, s37, 2
    s_add_u32 s45, s45, s38
    s_lshl_b32 s46, s45, 10
    v_add_u32 v4, s46, v7
    s_lshl_b32 s33, s36, 19
    s_add_u32 s50, s94, s33
    s_addc_u32 s51, s95, 0
    s_mov_b32 s8, s50
    s_and_b32 s9, s51, 0xffff
    s_mov_b32 s10, 524288
    s_mov_b32 s11, 0x20000
    s_lshl_b32 s33, s36, 15
    s_add_u32 s50, s96, s33
    s_addc_u32 s51, s97, 0
    s_mov_b32 s12, s50
    s_and_b32 s13, s51, 0xffff
    s_mov_b32 s14, 32768
    s_mov_b32 s15, 0x20000
    v_and_b32 v5, 31, v1
    v_lshlrev_b32 v5, 10, v5
    v_lshrrev_b32 v6, 5, v1
    v_lshl_add_u32 v5, v6, 4, v5
    s_lshl_b32 s46, s45, 5
    v_add_u32 v5, s46, v5
    s_barrier
    s_mov_b32 s52, 0
    buffer_load_dwordx4 v[32:35], v4, s[8:11], s52 offen sc1
    s_mov_b32 s52, 65536
    buffer_load_dwordx4 v[36:39], v4, s[8:11], s52 offen sc1
    s_mov_b32 s52, 131072
    buffer_load_dwordx4 v[40:43], v4, s[8:11], s52 offen sc1
    s_mov_b32 s52, 196608
    buffer_load_dwordx4 v[44:47], v4, s[8:11], s52 offen sc1
    s_mov_b32 s52, 262144
    buffer_load_dwordx4 v[48:51], v4, s[8:11], s52 offen sc1
    s_mov_b32 s52, 327680
    buffer_load_dwordx4 v[52:55], v4, s[8:11], s52 offen sc1
    s_mov_b32 s52, 393216
    buffer_load_dwordx4 v[56:59], v4, s[8:11], s52 offen sc1
    s_mov_b32 s52, 458752
    buffer_load_dwordx4 v[60:63], v4, s[8:11], s52 offen sc1
    s_mov_b32 s53, 0xffff0000
    s_waitcnt vmcnt(7)
    v_lshlrev_b32 v8, 16, v32
    v_and_b32 v9, s53, v32
    v_lshlrev_b32 v10, 16, v33
    v_and_b32 v11, s53, v33
    v_lshlrev_b32 v12, 16, v34
    v_and_b32 v13, s53, v34
    v_lshlrev_b32 v14, 16, v35
    v_and_b32 v15, s53, v35
    s_waitcnt vmcnt(6)
    v_lshlrev_b32 v16, 16, v36
    v_and_b32 v17, s53, v36
    v_add_f32 v8, v8, v16
    v_add_f32 v9, v9, v17
    v_lshlrev_b32 v18, 16, v37
    v_and_b32 v19, s53, v37
    v_add_f32 v10, v10, v18
    v_add_f32 v11, v11, v19
    v_lshlrev_b32 v20, 16, v38
    v_and_b32 v21, s53, v38
    v_add_f32 v12, v12, v20
    v_add_f32 v13, v13, v21
    v_lshlrev_b32 v22, 16, v39
    v_and_b32 v23, s53, v39
    v_add_f32 v14, v14, v22
    v_add_f32 v15, v15, v23
    s_waitcnt vmcnt(5)
    v_lshlrev_b32 v16, 16, v40
    v_and_b32 v17, s53, v40
    v_add_f32 v8, v8, v16
    v_add_f32 v9, v9, v17
    v_lshlrev_b32 v18, 16, v41
    v_and_b32 v19, s53, v41
    v_add_f32 v10, v10, v18
    v_add_f32 v11, v11, v19
    v_lshlrev_b32 v20, 16, v42
    v_and_b32 v21, s53, v42
    v_add_f32 v12, v12, v20
    v_add_f32 v13, v13, v21
    v_lshlrev_b32 v22, 16, v43
    v_and_b32 v23, s53, v43
    v_add_f32 v14, v14, v22
    v_add_f32 v15, v15, v23
    s_waitcnt vmcnt(4)
    v_lshlrev_b32 v16, 16, v44
    v_and_b32 v17, s53, v44
    v_add_f32 v8, v8, v16
    v_add_f32 v9, v9, v17
    v_lshlrev_b32 v18, 16, v45
    v_and_b32 v19, s53, v45
    v_add_f32 v10, v10, v18
    v_add_f32 v11, v11, v19
    v_lshlrev_b32 v20, 16, v46
    v_and_b32 v21, s53, v46
    v_add_f32 v12, v12, v20
    v_add_f32 v13, v13, v21
    v_lshlrev_b32 v22, 16, v47
    v_and_b32 v23, s53, v47
    v_add_f32 v14, v14, v22
    v_add_f32 v15, v15, v23
    s_waitcnt vmcnt(3)
    v_lshlrev_b32 v16, 16, v48
    v_and_b32 v17, s53, v48
    v_add_f32 v8, v8, v16
    v_add_f32 v9, v9, v17
    v_lshlrev_b32 v18, 16, v49
    v_and_b32 v19, s53, v49
    v_add_f32 v10, v10, v18
    v_add_f32 v11, v11, v19
    v_lshlrev_b32 v20, 16, v50
    v_and_b32 v21, s53, v50
    v_add_f32 v12, v12, v20
    v_add_f32 v13, v13, v21
    v_lshlrev_b32 v22, 16, v51
    v_and_b32 v23, s53, v51
    v_add_f32 v14, v14, v22
    v_add_f32 v15, v15, v23
    s_waitcnt vmcnt(2)
    v_lshlrev_b32 v16, 16, v52
    v_and_b32 v17, s53, v52
    v_add_f32 v8, v8, v16
    v_add_f32 v9, v9, v17
    v_lshlrev_b32 v18, 16, v53
    v_and_b32 v19, s53, v53
    v_add_f32 v10, v10, v18
    v_add_f32 v11, v11, v19
    v_lshlrev_b32 v20, 16, v54
    v_and_b32 v21, s53, v54
    v_add_f32 v12, v12, v20
    v_add_f32 v13, v13, v21
    v_lshlrev_b32 v22, 16, v55
    v_and_b32 v23, s53, v55
    v_add_f32 v14, v14, v22
    v_add_f32 v15, v15, v23
    s_waitcnt vmcnt(1)
    v_lshlrev_b32 v16, 16, v56
    v_and_b32 v17, s53, v56
    v_add_f32 v8, v8, v16
    v_add_f32 v9, v9, v17
    v_lshlrev_b32 v18, 16, v57
    v_and_b32 v19, s53, v57
    v_add_f32 v10, v10, v18
    v_add_f32 v11, v11, v19
    v_lshlrev_b32 v20, 16, v58
    v_and_b32 v21, s53, v58
    v_add_f32 v12, v12, v20
    v_add_f32 v13, v13, v21
    v_lshlrev_b32 v22, 16, v59
    v_and_b32 v23, s53, v59
    v_add_f32 v14, v14, v22
    v_add_f32 v15, v15, v23
    s_waitcnt vmcnt(0)
    v_lshlrev_b32 v16, 16, v60
    v_and_b32 v17, s53, v60
    v_add_f32 v8, v8, v16
    v_add_f32 v9, v9, v17
    v_lshlrev_b32 v18, 16, v61
    v_and_b32 v19, s53, v61
    v_add_f32 v10, v10, v18
    v_add_f32 v11, v11, v19
    v_lshlrev_b32 v20, 16, v62
    v_and_b32 v21, s53, v62
    v_add_f32 v12, v12, v20
    v_add_f32 v13, v13, v21
    v_lshlrev_b32 v22, 16, v63
    v_and_b32 v23, s53, v63
    v_add_f32 v14, v14, v22
    v_add_f32 v15, v15, v23
    v_cvt_pk_bf16_f32 v80, v8, v9
    v_cvt_pk_bf16_f32 v81, v10, v11
    v_cvt_pk_bf16_f32 v82, v12, v13
    v_cvt_pk_bf16_f32 v83, v14, v15
    s_nop 0
    v_permlane32_swap_b32 v80, v82
    v_permlane32_swap_b32 v81, v83
    buffer_store_dwordx4 v[80:83], v5, s[12:15], 0 offen
L_end:
    s_endpgm
L_rg1:
    v_max_f32 v26, v64, v65
    v_max3_f32 v26, v26, v66, v67
    v_max3_f32 v26, v26, v68, v69
    v_max3_f32 v26, v26, v70, v71
    v_max3_f32 v26, v26, v72, v73
    v_max3_f32 v26, v26, v74, v75
    v_max3_f32 v26, v26, v76, v77
    v_max3_f32 v26, v26, v78, v79
    v_max3_f32 v26, v26, v80, v81
    v_max3_f32 v26, v26, v82, v83
    v_max3_f32 v26, v26, v84, v85
    v_max3_f32 v26, v26, v86, v87
    v_max3_f32 v26, v26, v88, v89
    v_max3_f32 v26, v26, v90, v91
    v_max3_f32 v26, v26, v92, v93
    v_max3_f32 v26, v26, v94, v95
    v_mov_b32 v27, v26
    s_nop 1
    v_permlane32_swap_b32 v26, v27
    v_max3_f32 v27, v26, v27, 0
    v_sub_f32 v64, v64, v27
    v_sub_f32 v65, v65, v27
    v_sub_f32 v66, v66, v27
    v_sub_f32 v67, v67, v27
    v_sub_f32 v68, v68, v27
    v_sub_f32 v69, v69, v27
    v_sub_f32 v70, v70, v27
    v_sub_f32 v71, v71, v27
    v_sub_f32 v72, v72, v27
    v_sub_f32 v73, v73, v27
    v_sub_f32 v74, v74, v27
    v_sub_f32 v75, v75, v27
    v_sub_f32 v76, v76, v27
    v_sub_f32 v77, v77, v27
    v_sub_f32 v78, v78, v27
    v_sub_f32 v79, v79, v27
    v_sub_f32 v80, v80, v27
    v_sub_f32 v81, v81, v27
    v_sub_f32 v82, v82, v27
    v_sub_f32 v83, v83, v27
    v_sub_f32 v84, v84, v27
    v_sub_f32 v85, v85, v27
    v_sub_f32 v86, v86, v27
    v_sub_f32 v87, v87, v27
    v_sub_f32 v88, v88, v27
    v_sub_f32 v89, v89, v27
    v_sub_f32 v90, v90, v27
    v_sub_f32 v91, v91, v27
    v_sub_f32 v92, v92, v27
    v_sub_f32 v93, v93, v27
    v_sub_f32 v94, v94, v27
    v_sub_f32 v95, v95, v27
    v_sub_f32 v32, v32, v27
    v_sub_f32 v33, v33, v27
    v_sub_f32 v34, v34, v27
    v_sub_f32 v35, v35, v27
    v_sub_f32 v36, v36, v27
    v_sub_f32 v37, v37, v27
    v_sub_f32 v38, v38, v27
    v_sub_f32 v39, v39, v27
    v_sub_f32 v40, v40, v27
    v_sub_f32 v41, v41, v27
    v_sub_f32 v42, v42, v27
    v_sub_f32 v43, v43, v27
    v_sub_f32 v44, v44, v27
    v_sub_f32 v45, v45, v27
    v_sub_f32 v46, v46, v27
    v_sub_f32 v47, v47, v27
    v_sub_f32 v48, v48, v27
    v_sub_f32 v49, v49, v27
    v_sub_f32 v50, v50, v27
    v_sub_f32 v51, v51, v27
    v_sub_f32 v52, v52, v27
    v_sub_f32 v53, v53, v27
    v_sub_f32 v54, v54, v27
    v_sub_f32 v55, v55, v27
    v_sub_f32 v56, v56, v27
    v_sub_f32 v57, v57, v27
    v_sub_f32 v58, v58, v27
    v_sub_f32 v59, v59, v27
    v_sub_f32 v60, v60, v27
    v_sub_f32 v61, v61, v27
    v_sub_f32 v62, v62, v27
    v_sub_f32 v63, v63, v27
    v_sub_f32 v192, v192, v27
    v_sub_f32 v193, v193, v27
    v_sub_f32 v194, v194, v27
    v_sub_f32 v195, v195, v27
    v_sub_f32 v196, v196, v27
    v_sub_f32 v197, v197, v27
    v_sub_f32 v198, v198, v27
    v_sub_f32 v199, v199, v27
    v_sub_f32 v200, v200, v27
    v_sub_f32 v201, v201, v27
    v_sub_f32 v202, v202, v27
    v_sub_f32 v203, v203, v27
    v_sub_f32 v204, v204, v27
    v_sub_f32 v205, v205, v27
    v_sub_f32 v206, v206, v27
    v_sub_f32 v207, v207, v27
    v_sub_f32 v27, 0, v27
    v_exp_f32 v25, v27
    s_nop 0
    v_mul_f32 v24, v24, v25
    v_mul_f32 v128, v25, v128
    v_mul_f32 v129, v25, v129
    v_mul_f32 v130, v25, v130
    v_mul_f32 v131, v25, v131
    v_mul_f32 v132, v25, v132
    v_mul_f32 v133, v25, v133
    v_mul_f32 v134, v25, v134
    v_mul_f32 v135, v25, v135
    v_mul_f32 v136, v25, v136
    v_mul_f32 v137, v25, v137
    v_mul_f32 v138, v25, v138
    v_mul_f32 v139, v25, v139
    v_mul_f32 v140, v25, v140
    v_mul_f32 v141, v25, v141
    v_mul_f32 v142, v25, v142
    v_mul_f32 v143, v25, v143
    v_mul_f32 v144, v25, v144
    v_mul_f32 v145, v25, v145
    v_mul_f32 v146, v25, v146
    v_mul_f32 v147, v25, v147
    v_mul_f32 v148, v25, v148
    v_mul_f32 v149, v25, v149
    v_mul_f32 v150, v25, v150
    v_mul_f32 v151, v25, v151
    v_mul_f32 v152, v25, v152
    v_mul_f32 v153, v25, v153
    v_mul_f32 v154, v25, v154
    v_mul_f32 v155, v25, v155
    v_mul_f32 v156, v25, v156
    v_mul_f32 v157, v25, v157
    v_mul_f32 v158, v25, v158
    v_mul_f32 v159, v25, v159
    v_mul_f32 v160, v25, v160
    v_mul_f32 v161, v25, v161
    v_mul_f32 v162, v25, v162
    v_mul_f32 v163, v25, v163
    v_mul_f32 v164, v25, v164
    v_mul_f32 v165, v25, v165
    v_mul_f32 v166, v25, v166
    v_mul_f32 v167, v25, v167
    v_mul_f32 v168, v25, v168
    v_mul_f32 v169, v25, v169
    v_mul_f32 v170, v25, v170
    v_mul_f32 v171, v25, v171
    v_mul_f32 v172, v25, v172
    v_mul_f32 v173, v25, v173
    v_mul_f32 v174, v25, v174
    v_mul_f32 v175, v25, v175
    v_mul_f32 v176, v25, v176
    v_mul_f32 v177, v25, v177
    v_mul_f32 v178, v25, v178
    v_mul_f32 v179, v25, v179
    v_mul_f32 v180, v25, v180
    v_mul_f32 v181, v25, v181
    v_mul_f32 v182, v25, v182
    v_mul_f32 v183, v25, v183
    v_mul_f32 v184, v25, v184
    v_mul_f32 v185, v25, v185
    v_mul_f32 v186, v25, v186
    v_mul_f32 v187, v25, v187
    v_mul_f32 v188, v25, v188
    v_mul_f32 v189, v25, v189
    v_mul_f32 v190, v25, v190
    v_mul_f32 v191, v25, v191
    v_exp_f32 v210, v64
    v_exp_f32 v211, v65
    s_nop 0
    v_add_f32 v208, v210, v211
    v_cvt_pk_bf16_f32 v112, v210, v211
    v_exp_f32 v210, v66
    v_exp_f32 v211, v67
    v_add_f32 v208, v208, v210
    v_add_f32 v208, v208, v211
    v_cvt_pk_bf16_f32 v113, v210, v211
    v_exp_f32 v210, v68
    v_exp_f32 v211, v69
    v_add_f32 v208, v208, v210
    v_add_f32 v208, v208, v211
    v_cvt_pk_bf16_f32 v114, v210, v211
    v_exp_f32 v210, v70
    v_exp_f32 v211, v71
    v_add_f32 v208, v208, v210
    v_add_f32 v208, v208, v211
    v_cvt_pk_bf16_f32 v115, v210, v211
    v_exp_f32 v210, v72
    v_exp_f32 v211, v73
    v_add_f32 v208, v208, v210
    v_add_f32 v208, v208, v211
    v_cvt_pk_bf16_f32 v116, v210, v211
    v_exp_f32 v210, v74
    v_exp_f32 v211, v75
    v_add_f32 v208, v208, v210
    v_add_f32 v208, v208, v211
    v_cvt_pk_bf16_f32 v117, v210, v211
    v_exp_f32 v210, v76
    v_exp_f32 v211, v77
    v_add_f32 v208, v208, v210
    v_add_f32 v208, v208, v211
    v_cvt_pk_bf16_f32 v118, v210, v211
    v_exp_f32 v210, v78
    v_exp_f32 v211, v79
    v_add_f32 v208, v208, v210
    v_add_f32 v208, v208, v211
    v_cvt_pk_bf16_f32 v119, v210, v211
    v_exp_f32 v210, v80
    v_exp_f32 v211, v81
    v_add_f32 v208, v208, v210
    v_add_f32 v208, v208, v211
    v_cvt_pk_bf16_f32 v120, v210, v211
    v_exp_f32 v210, v82
    v_exp_f32 v211, v83
    v_add_f32 v208, v208, v210
    v_add_f32 v208, v208, v211
    v_cvt_pk_bf16_f32 v121, v210, v211
    v_exp_f32 v210, v84
    v_exp_f32 v211, v85
    v_add_f32 v208, v208, v210
    v_add_f32 v208, v208, v211
    v_cvt_pk_bf16_f32 v122, v210, v211
    v_exp_f32 v210, v86
    v_exp_f32 v211, v87
    v_add_f32 v208, v208, v210
    v_add_f32 v208, v208, v211
    v_cvt_pk_bf16_f32 v123, v210, v211
    v_exp_f32 v210, v88
    v_exp_f32 v211, v89
    v_add_f32 v208, v208, v210
    v_add_f32 v208, v208, v211
    v_cvt_pk_bf16_f32 v124, v210, v211
    v_exp_f32 v210, v90
    v_exp_f32 v211, v91
    v_add_f32 v208, v208, v210
    v_add_f32 v208, v208, v211
    v_cvt_pk_bf16_f32 v125, v210, v211
    v_exp_f32 v210, v92
    v_exp_f32 v211, v93
    v_add_f32 v208, v208, v210
    v_add_f32 v208, v208, v211
    v_cvt_pk_bf16_f32 v126, v210, v211
    v_exp_f32 v210, v94
    v_exp_f32 v211, v95
    v_add_f32 v208, v208, v210
    v_add_f32 v208, v208, v211
    v_cvt_pk_bf16_f32 v127, v210, v211
    s_branch L_rg1_back
L_rg2:
    v_max_f32 v26, v32, v33
    v_max3_f32 v26, v26, v34, v35
    v_max3_f32 v26, v26, v36, v37
    v_max3_f32 v26, v26, v38, v39
    v_max3_f32 v26, v26, v40, v41
    v_max3_f32 v26, v26, v42, v43
    v_max3_f32 v26, v26, v44, v45
    v_max3_f32 v26, v26, v46, v47
    v_max3_f32 v26, v26, v48, v49
    v_max3_f32 v26, v26, v50, v51
    v_max3_f32 v26, v26, v52, v53
    v_max3_f32 v26, v26, v54, v55
    v_max3_f32 v26, v26, v56, v57
    v_max3_f32 v26, v26, v58, v59
    v_max3_f32 v26, v26, v60, v61
    v_max3_f32 v26, v26, v62, v63
    v_mov_b32 v27, v26
    s_nop 1
    v_permlane32_swap_b32 v26, v27
    v_max3_f32 v27, v26, v27, 0
    v_sub_f32 v32, v32, v27
    v_sub_f32 v33, v33, v27
    v_sub_f32 v34, v34, v27
    v_sub_f32 v35, v35, v27
    v_sub_f32 v36, v36, v27
    v_sub_f32 v37, v37, v27
    v_sub_f32 v38, v38, v27
    v_sub_f32 v39, v39, v27
    v_sub_f32 v40, v40, v27
    v_sub_f32 v41, v41, v27
    v_sub_f32 v42, v42, v27
    v_sub_f32 v43, v43, v27
    v_sub_f32 v44, v44, v27
    v_sub_f32 v45, v45, v27
    v_sub_f32 v46, v46, v27
    v_sub_f32 v47, v47, v27
    v_sub_f32 v48, v48, v27
    v_sub_f32 v49, v49, v27
    v_sub_f32 v50, v50, v27
    v_sub_f32 v51, v51, v27
    v_sub_f32 v52, v52, v27
    v_sub_f32 v53, v53, v27
    v_sub_f32 v54, v54, v27
    v_sub_f32 v55, v55, v27
    v_sub_f32 v56, v56, v27
    v_sub_f32 v57, v57, v27
    v_sub_f32 v58, v58, v27
    v_sub_f32 v59, v59, v27
    v_sub_f32 v60, v60, v27
    v_sub_f32 v61, v61, v27
    v_sub_f32 v62, v62, v27
    v_sub_f32 v63, v63, v27
    v_sub_f32 v64, v64, v27
    v_sub_f32 v65, v65, v27
    v_sub_f32 v66, v66, v27
    v_sub_f32 v67, v67, v27
    v_sub_f32 v68, v68, v27
    v_sub_f32 v69, v69, v27
    v_sub_f32 v70, v70, v27
    v_sub_f32 v71, v71, v27
    v_sub_f32 v72, v72, v27
    v_sub_f32 v73, v73, v27
    v_sub_f32 v74, v74, v27
    v_sub_f32 v75, v75, v27
    v_sub_f32 v76, v76, v27
    v_sub_f32 v77, v77, v27
    v_sub_f32 v78, v78, v27
    v_sub_f32 v79, v79, v27
    v_sub_f32 v80, v80, v27
    v_sub_f32 v81, v81, v27
    v_sub_f32 v82, v82, v27
    v_sub_f32 v83, v83, v27
    v_sub_f32 v84, v84, v27
    v_sub_f32 v85, v85, v27
    v_sub_f32 v86, v86, v27
    v_sub_f32 v87, v87, v27
    v_sub_f32 v88, v88, v27
    v_sub_f32 v89, v89, v27
    v_sub_f32 v90, v90, v27
    v_sub_f32 v91, v91, v27
    v_sub_f32 v92, v92, v27
    v_sub_f32 v93, v93, v27
    v_sub_f32 v94, v94, v27
    v_sub_f32 v95, v95, v27
    v_sub_f32 v192, v192, v27
    v_sub_f32 v193, v193, v27
    v_sub_f32 v194, v194, v27
    v_sub_f32 v195, v195, v27
    v_sub_f32 v196, v196, v27
    v_sub_f32 v197, v197, v27
    v_sub_f32 v198, v198, v27
    v_sub_f32 v199, v199, v27
    v_sub_f32 v200, v200, v27
    v_sub_f32 v201, v201, v27
    v_sub_f32 v202, v202, v27
    v_sub_f32 v203, v203, v27
    v_sub_f32 v204, v204, v27
    v_sub_f32 v205, v205, v27
    v_sub_f32 v206, v206, v27
    v_sub_f32 v207, v207, v27
    v_sub_f32 v27, 0, v27
    v_exp_f32 v25, v27
    s_nop 0
    v_mul_f32 v24, v24, v25
    v_mul_f32 v128, v25, v128
    v_mul_f32 v129, v25, v129
    v_mul_f32 v130, v25, v130
    v_mul_f32 v131, v25, v131
    v_mul_f32 v132, v25, v132
    v_mul_f32 v133, v25, v133
    v_mul_f32 v134, v25, v134
    v_mul_f32 v135, v25, v135
    v_mul_f32 v136, v25, v136
    v_mul_f32 v137, v25, v137
    v_mul_f32 v138, v25, v138
    v_mul_f32 v139, v25, v139
    v_mul_f32 v140, v25, v140
    v_mul_f32 v141, v25, v141
    v_mul_f32 v142, v25, v142
    v_mul_f32 v143, v25, v143
    v_mul_f32 v144, v25, v144
    v_mul_f32 v145, v25, v145
    v_mul_f32 v146, v25, v146
    v_mul_f32 v147, v25, v147
    v_mul_f32 v148, v25, v148
    v_mul_f32 v149, v25, v149
    v_mul_f32 v150, v25, v150
    v_mul_f32 v151, v25, v151
    v_mul_f32 v152, v25, v152
    v_mul_f32 v153, v25, v153
    v_mul_f32 v154, v25, v154
    v_mul_f32 v155, v25, v155
    v_mul_f32 v156, v25, v156
    v_mul_f32 v157, v25, v157
    v_mul_f32 v158, v25, v158
    v_mul_f32 v159, v25, v159
    v_mul_f32 v160, v25, v160
    v_mul_f32 v161, v25, v161
    v_mul_f32 v162, v25, v162
    v_mul_f32 v163, v25, v163
    v_mul_f32 v164, v25, v164
    v_mul_f32 v165, v25, v165
    v_mul_f32 v166, v25, v166
    v_mul_f32 v167, v25, v167
    v_mul_f32 v168, v25, v168
    v_mul_f32 v169, v25, v169
    v_mul_f32 v170, v25, v170
    v_mul_f32 v171, v25, v171
    v_mul_f32 v172, v25, v172
    v_mul_f32 v173, v25, v173
    v_mul_f32 v174, v25, v174
    v_mul_f32 v175, v25, v175
    v_mul_f32 v176, v25, v176
    v_mul_f32 v177, v25, v177
    v_mul_f32 v178, v25, v178
    v_mul_f32 v179, v25, v179
    v_mul_f32 v180, v25, v180
    v_mul_f32 v181, v25, v181
    v_mul_f32 v182, v25, v182
    v_mul_f32 v183, v25, v183
    v_mul_f32 v184, v25, v184
    v_mul_f32 v185, v25, v185
    v_mul_f32 v186, v25, v186
    v_mul_f32 v187, v25, v187
    v_mul_f32 v188, v25, v188
    v_mul_f32 v189, v25, v189
    v_mul_f32 v190, v25, v190
    v_mul_f32 v191, v25, v191
    v_exp_f32 v210, v32
    v_exp_f32 v211, v33
    s_nop 0
    v_add_f32 v208, v210, v211
    v_cvt_pk_bf16_f32 v96, v210, v211
    v_exp_f32 v210, v34
    v_exp_f32 v211, v35
    v_add_f32 v208, v208, v210
    v_add_f32 v208, v208, v211
    v_cvt_pk_bf16_f32 v97, v210, v211
    v_exp_f32 v210, v36
    v_exp_f32 v211, v37
    v_add_f32 v208, v208, v210
    v_add_f32 v208, v208, v211
    v_cvt_pk_bf16_f32 v98, v210, v211
    v_exp_f32 v210, v38
    v_exp_f32 v211, v39
    v_add_f32 v208, v208, v210
    v_add_f32 v208, v208, v211
    v_cvt_pk_bf16_f32 v99, v210, v211
    v_exp_f32 v210, v40
    v_exp_f32 v211, v41
    v_add_f32 v208, v208, v210
    v_add_f32 v208, v208, v211
    v_cvt_pk_bf16_f32 v100, v210, v211
    v_exp_f32 v210, v42
    v_exp_f32 v211, v43
    v_add_f32 v208, v208, v210
    v_add_f32 v208, v208, v211
    v_cvt_pk_bf16_f32 v101, v210, v211
    v_exp_f32 v210, v44
    v_exp_f32 v211, v45
    v_add_f32 v208, v208, v210
    v_add_f32 v208, v208, v211
    v_cvt_pk_bf16_f32 v102, v210, v211
    v_exp_f32 v210, v46
    v_exp_f32 v211, v47
    v_add_f32 v208, v208, v210
    v_add_f32 v208, v208, v211
    v_cvt_pk_bf16_f32 v103, v210, v211
    v_exp_f32 v210, v48
    v_exp_f32 v211, v49
    v_add_f32 v208, v208, v210
    v_add_f32 v208, v208, v211
    v_cvt_pk_bf16_f32 v104, v210, v211
    v_exp_f32 v210, v50
    v_exp_f32 v211, v51
    v_add_f32 v208, v208, v210
    v_add_f32 v208, v208, v211
    v_cvt_pk_bf16_f32 v105, v210, v211
    v_exp_f32 v210, v52
    v_exp_f32 v211, v53
    v_add_f32 v208, v208, v210
    v_add_f32 v208, v208, v211
    v_cvt_pk_bf16_f32 v106, v210, v211
    v_exp_f32 v210, v54
    v_exp_f32 v211, v55
    v_add_f32 v208, v208, v210
    v_add_f32 v208, v208, v211
    v_cvt_pk_bf16_f32 v107, v210, v211
    v_exp_f32 v210, v56
    v_exp_f32 v211, v57
    v_add_f32 v208, v208, v210
    v_add_f32 v208, v208, v211
    v_cvt_pk_bf16_f32 v108, v210, v211
    v_exp_f32 v210, v58
    v_exp_f32 v211, v59
    v_add_f32 v208, v208, v210
    v_add_f32 v208, v208, v211
    v_cvt_pk_bf16_f32 v109, v210, v211
    v_exp_f32 v210, v60
    v_exp_f32 v211, v61
    v_add_f32 v208, v208, v210
    v_add_f32 v208, v208, v211
    v_cvt_pk_bf16_f32 v110, v210, v211
    v_exp_f32 v210, v62
    v_exp_f32 v211, v63
    v_add_f32 v208, v208, v210
    v_add_f32 v208, v208, v211
    v_cvt_pk_bf16_f32 v111, v210, v211
    s_branch L_rg2_back
L_rg3:
    v_max_f32 v26, v64, v65
    v_max3_f32 v26, v26, v66, v67
    v_max3_f32 v26, v26, v68, v69
    v_max3_f32 v26, v26, v70, v71
    v_max3_f32 v26, v26, v72, v73
    v_max3_f32 v26, v26, v74, v75
    v_max3_f32 v26, v26, v76, v77
    v_max3_f32 v26, v26, v78, v79
    v_max3_f32 v26, v26, v80, v81
    v_max3_f32 v26, v26, v82, v83
    v_max3_f32 v26, v26, v84, v85
    v_max3_f32 v26, v26, v86, v87
    v_max3_f32 v26, v26, v88, v89
    v_max3_f32 v26, v26, v90, v91
    v_max3_f32 v26, v26, v92, v93
    v_max3_f32 v26, v26, v94, v95
    v_mov_b32 v27, v26
    s_nop 1
    v_permlane32_swap_b32 v26, v27
    v_max3_f32 v27, v26, v27, 0
    v_sub_f32 v64, v64, v27
    v_sub_f32 v65, v65, v27
    v_sub_f32 v66, v66, v27
    v_sub_f32 v67, v67, v27
    v_sub_f32 v68, v68, v27
    v_sub_f32 v69, v69, v27
    v_sub_f32 v70, v70, v27
    v_sub_f32 v71, v71, v27
    v_sub_f32 v72, v72, v27
    v_sub_f32 v73, v73, v27
    v_sub_f32 v74, v74, v27
    v_sub_f32 v75, v75, v27
    v_sub_f32 v76, v76, v27
    v_sub_f32 v77, v77, v27
    v_sub_f32 v78, v78, v27
    v_sub_f32 v79, v79, v27
    v_sub_f32 v80, v80, v27
    v_sub_f32 v81, v81, v27
    v_sub_f32 v82, v82, v27
    v_sub_f32 v83, v83, v27
    v_sub_f32 v84, v84, v27
    v_sub_f32 v85, v85, v27
    v_sub_f32 v86, v86, v27
    v_sub_f32 v87, v87, v27
    v_sub_f32 v88, v88, v27
    v_sub_f32 v89, v89, v27
    v_sub_f32 v90, v90, v27
    v_sub_f32 v91, v91, v27
    v_sub_f32 v92, v92, v27
    v_sub_f32 v93, v93, v27
    v_sub_f32 v94, v94, v27
    v_sub_f32 v95, v95, v27
    v_sub_f32 v32, v32, v27
    v_sub_f32 v33, v33, v27
    v_sub_f32 v34, v34, v27
    v_sub_f32 v35, v35, v27
    v_sub_f32 v36, v36, v27
    v_sub_f32 v37, v37, v27
    v_sub_f32 v38, v38, v27
    v_sub_f32 v39, v39, v27
    v_sub_f32 v40, v40, v27
    v_sub_f32 v41, v41, v27
    v_sub_f32 v42, v42, v27
    v_sub_f32 v43, v43, v27
    v_sub_f32 v44, v44, v27
    v_sub_f32 v45, v45, v27
    v_sub_f32 v46, v46, v27
    v_sub_f32 v47, v47, v27
    v_sub_f32 v48, v48, v27
    v_sub_f32 v49, v49, v27
    v_sub_f32 v50, v50, v27
    v_sub_f32 v51, v51, v27
    v_sub_f32 v52, v52, v27
    v_sub_f32 v53, v53, v27
    v_sub_f32 v54, v54, v27
    v_sub_f32 v55, v55, v27
    v_sub_f32 v56, v56, v27
    v_sub_f32 v57, v57, v27
    v_sub_f32 v58, v58, v27
    v_sub_f32 v59, v59, v27
    v_sub_f32 v60, v60, v27
    v_sub_f32 v61, v61, v27
    v_sub_f32 v62, v62, v27
    v_sub_f32 v63, v63, v27
    v_sub_f32 v192, v192, v27
    v_sub_f32 v193, v193, v27
    v_sub_f32 v194, v194, v27
    v_sub_f32 v195, v195, v27
    v_sub_f32 v196, v196, v27
    v_sub_f32 v197, v197, v27
    v_sub_f32 v198, v198, v27
    v_sub_f32 v199, v199, v27
    v_sub_f32 v200, v200, v27
    v_sub_f32 v201, v201, v27
    v_sub_f32 v202, v202, v27
    v_sub_f32 v203, v203, v27
    v_sub_f32 v204, v204, v27
    v_sub_f32 v205, v205, v27
    v_sub_f32 v206, v206, v27
    v_sub_f32 v207, v207, v27
    v_sub_f32 v27, 0, v27
    v_exp_f32 v25, v27
    s_nop 0
    v_mul_f32 v24, v24, v25
    v_mul_f32 v128, v25, v128
    v_mul_f32 v129, v25, v129
    v_mul_f32 v130, v25, v130
    v_mul_f32 v131, v25, v131
    v_mul_f32 v132, v25, v132
    v_mul_f32 v133, v25, v133
    v_mul_f32 v134, v25, v134
    v_mul_f32 v135, v25, v135
    v_mul_f32 v136, v25, v136
    v_mul_f32 v137, v25, v137
    v_mul_f32 v138, v25, v138
    v_mul_f32 v139, v25, v139
    v_mul_f32 v140, v25, v140
    v_mul_f32 v141, v25, v141
    v_mul_f32 v142, v25, v142
    v_mul_f32 v143, v25, v143
    v_mul_f32 v144, v25, v144
    v_mul_f32 v145, v25, v145
    v_mul_f32 v146, v25, v146
    v_mul_f32 v147, v25, v147
    v_mul_f32 v148, v25, v148
    v_mul_f32 v149, v25, v149
    v_mul_f32 v150, v25, v150
    v_mul_f32 v151, v25, v151
    v_mul_f32 v152, v25, v152
    v_mul_f32 v153, v25, v153
    v_mul_f32 v154, v25, v154
    v_mul_f32 v155, v25, v155
    v_mul_f32 v156, v25, v156
    v_mul_f32 v157, v25, v157
    v_mul_f32 v158, v25, v158
    v_mul_f32 v159, v25, v159
    v_mul_f32 v160, v25, v160
    v_mul_f32 v161, v25, v161
    v_mul_f32 v162, v25, v162
    v_mul_f32 v163, v25, v163
    v_mul_f32 v164, v25, v164
    v_mul_f32 v165, v25, v165
    v_mul_f32 v166, v25, v166
    v_mul_f32 v167, v25, v167
    v_mul_f32 v168, v25, v168
    v_mul_f32 v169, v25, v169
    v_mul_f32 v170, v25, v170
    v_mul_f32 v171, v25, v171
    v_mul_f32 v172, v25, v172
    v_mul_f32 v173, v25, v173
    v_mul_f32 v174, v25, v174
    v_mul_f32 v175, v25, v175
    v_mul_f32 v176, v25, v176
    v_mul_f32 v177, v25, v177
    v_mul_f32 v178, v25, v178
    v_mul_f32 v179, v25, v179
    v_mul_f32 v180, v25, v180
    v_mul_f32 v181, v25, v181
    v_mul_f32 v182, v25, v182
    v_mul_f32 v183, v25, v183
    v_mul_f32 v184, v25, v184
    v_mul_f32 v185, v25, v185
    v_mul_f32 v186, v25, v186
    v_mul_f32 v187, v25, v187
    v_mul_f32 v188, v25, v188
    v_mul_f32 v189, v25, v189
    v_mul_f32 v190, v25, v190
    v_mul_f32 v191, v25, v191
    v_exp_f32 v210, v64
    v_exp_f32 v211, v65
    s_nop 0
    v_add_f32 v208, v210, v211
    v_cvt_pk_bf16_f32 v112, v210, v211
    v_exp_f32 v210, v66
    v_exp_f32 v211, v67
    v_add_f32 v208, v208, v210
    v_add_f32 v208, v208, v211
    v_cvt_pk_bf16_f32 v113, v210, v211
    v_exp_f32 v210, v68
    v_exp_f32 v211, v69
    v_add_f32 v208, v208, v210
    v_add_f32 v208, v208, v211
    v_cvt_pk_bf16_f32 v114, v210, v211
    v_exp_f32 v210, v70
    v_exp_f32 v211, v71
    v_add_f32 v208, v208, v210
    v_add_f32 v208, v208, v211
    v_cvt_pk_bf16_f32 v115, v210, v211
    v_exp_f32 v210, v72
    v_exp_f32 v211, v73
    v_add_f32 v208, v208, v210
    v_add_f32 v208, v208, v211
    v_cvt_pk_bf16_f32 v116, v210, v211
    v_exp_f32 v210, v74
    v_exp_f32 v211, v75
    v_add_f32 v208, v208, v210
    v_add_f32 v208, v208, v211
    v_cvt_pk_bf16_f32 v117, v210, v211
    v_exp_f32 v210, v76
    v_exp_f32 v211, v77
    v_add_f32 v208, v208, v210
    v_add_f32 v208, v208, v211
    v_cvt_pk_bf16_f32 v118, v210, v211
    v_exp_f32 v210, v78
    v_exp_f32 v211, v79
    v_add_f32 v208, v208, v210
    v_add_f32 v208, v208, v211
    v_cvt_pk_bf16_f32 v119, v210, v211
    v_exp_f32 v210, v80
    v_exp_f32 v211, v81
    v_add_f32 v208, v208, v210
    v_add_f32 v208, v208, v211
    v_cvt_pk_bf16_f32 v120, v210, v211
    v_exp_f32 v210, v82
    v_exp_f32 v211, v83
    v_add_f32 v208, v208, v210
    v_add_f32 v208, v208, v211
    v_cvt_pk_bf16_f32 v121, v210, v211
    v_exp_f32 v210, v84
    v_exp_f32 v211, v85
    v_add_f32 v208, v208, v210
    v_add_f32 v208, v208, v211
    v_cvt_pk_bf16_f32 v122, v210, v211
    v_exp_f32 v210, v86
    v_exp_f32 v211, v87
    v_add_f32 v208, v208, v210
    v_add_f32 v208, v208, v211
    v_cvt_pk_bf16_f32 v123, v210, v211
    v_exp_f32 v210, v88
    v_exp_f32 v211, v89
    v_add_f32 v208, v208, v210
    v_add_f32 v208, v208, v211
    v_cvt_pk_bf16_f32 v124, v210, v211
    v_exp_f32 v210, v90
    v_exp_f32 v211, v91
    v_add_f32 v208, v208, v210
    v_add_f32 v208, v208, v211
    v_cvt_pk_bf16_f32 v125, v210, v211
    v_exp_f32 v210, v92
    v_exp_f32 v211, v93
    v_add_f32 v208, v208, v210
    v_add_f32 v208, v208, v211
    v_cvt_pk_bf16_f32 v126, v210, v211
    v_exp_f32 v210, v94
    v_exp_f32 v211, v95
    v_add_f32 v208, v208, v210
    v_add_f32 v208, v208, v211
    v_cvt_pk_bf16_f32 v127, v210, v211
    s_branch L_rg3_back
L_rg4:
    v_max_f32 v26, v32, v33
    v_max3_f32 v26, v26, v34, v35
    v_max3_f32 v26, v26, v36, v37
    v_max3_f32 v26, v26, v38, v39
    v_max3_f32 v26, v26, v40, v41
    v_max3_f32 v26, v26, v42, v43
    v_max3_f32 v26, v26, v44, v45
    v_max3_f32 v26, v26, v46, v47
    v_max3_f32 v26, v26, v48, v49
    v_max3_f32 v26, v26, v50, v51
    v_max3_f32 v26, v26, v52, v53
    v_max3_f32 v26, v26, v54, v55
    v_max3_f32 v26, v26, v56, v57
    v_max3_f32 v26, v26, v58, v59
    v_max3_f32 v26, v26, v60, v61
    v_max3_f32 v26, v26, v62, v63
    v_mov_b32 v27, v26
    s_nop 1
    v_permlane32_swap_b32 v26, v27
    v_max3_f32 v27, v26, v27, 0
    v_sub_f32 v32, v32, v27
    v_sub_f32 v33, v33, v27
    v_sub_f32 v34, v34, v27
    v_sub_f32 v35, v35, v27
    v_sub_f32 v36, v36, v27
    v_sub_f32 v37, v37, v27
    v_sub_f32 v38, v38, v27
    v_sub_f32 v39, v39, v27
    v_sub_f32 v40, v40, v27
    v_sub_f32 v41, v41, v27
    v_sub_f32 v42, v42, v27
    v_sub_f32 v43, v43, v27
    v_sub_f32 v44, v44, v27
    v_sub_f32 v45, v45, v27
    v_sub_f32 v46, v46, v27
    v_sub_f32 v47, v47, v27
    v_sub_f32 v48, v48, v27
    v_sub_f32 v49, v49, v27
    v_sub_f32 v50, v50, v27
    v_sub_f32 v51, v51, v27
    v_sub_f32 v52, v52, v27
    v_sub_f32 v53, v53, v27
    v_sub_f32 v54, v54, v27
    v_sub_f32 v55, v55, v27
    v_sub_f32 v56, v56, v27
    v_sub_f32 v57, v57, v27
    v_sub_f32 v58, v58, v27
    v_sub_f32 v59, v59, v27
    v_sub_f32 v60, v60, v27
    v_sub_f32 v61, v61, v27
    v_sub_f32 v62, v62, v27
    v_sub_f32 v63, v63, v27
    v_sub_f32 v64, v64, v27
    v_sub_f32 v65, v65, v27
    v_sub_f32 v66, v66, v27
    v_sub_f32 v67, v67, v27
    v_sub_f32 v68, v68, v27
    v_sub_f32 v69, v69, v27
    v_sub_f32 v70, v70, v27
    v_sub_f32 v71, v71, v27
    v_sub_f32 v72, v72, v27
    v_sub_f32 v73, v73, v27
    v_sub_f32 v74, v74, v27
    v_sub_f32 v75, v75, v27
    v_sub_f32 v76, v76, v27
    v_sub_f32 v77, v77, v27
    v_sub_f32 v78, v78, v27
    v_sub_f32 v79, v79, v27
    v_sub_f32 v80, v80, v27
    v_sub_f32 v81, v81, v27
    v_sub_f32 v82, v82, v27
    v_sub_f32 v83, v83, v27
    v_sub_f32 v84, v84, v27
    v_sub_f32 v85, v85, v27
    v_sub_f32 v86, v86, v27
    v_sub_f32 v87, v87, v27
    v_sub_f32 v88, v88, v27
    v_sub_f32 v89, v89, v27
    v_sub_f32 v90, v90, v27
    v_sub_f32 v91, v91, v27
    v_sub_f32 v92, v92, v27
    v_sub_f32 v93, v93, v27
    v_sub_f32 v94, v94, v27
    v_sub_f32 v95, v95, v27
    v_sub_f32 v192, v192, v27
    v_sub_f32 v193, v193, v27
    v_sub_f32 v194, v194, v27
    v_sub_f32 v195, v195, v27
    v_sub_f32 v196, v196, v27
    v_sub_f32 v197, v197, v27
    v_sub_f32 v198, v198, v27
    v_sub_f32 v199, v199, v27
    v_sub_f32 v200, v200, v27
    v_sub_f32 v201, v201, v27
    v_sub_f32 v202, v202, v27
    v_sub_f32 v203, v203, v27
    v_sub_f32 v204, v204, v27
    v_sub_f32 v205, v205, v27
    v_sub_f32 v206, v206, v27
    v_sub_f32 v207, v207, v27
    v_sub_f32 v27, 0, v27
    v_exp_f32 v25, v27
    s_nop 0
    v_mul_f32 v24, v24, v25
    v_mul_f32 v128, v25, v128
    v_mul_f32 v129, v25, v129
    v_mul_f32 v130, v25, v130
    v_mul_f32 v131, v25, v131
    v_mul_f32 v132, v25, v132
    v_mul_f32 v133, v25, v133
    v_mul_f32 v134, v25, v134
    v_mul_f32 v135, v25, v135
    v_mul_f32 v136, v25, v136
    v_mul_f32 v137, v25, v137
    v_mul_f32 v138, v25, v138
    v_mul_f32 v139, v25, v139
    v_mul_f32 v140, v25, v140
    v_mul_f32 v141, v25, v141
    v_mul_f32 v142, v25, v142
    v_mul_f32 v143, v25, v143
    v_mul_f32 v144, v25, v144
    v_mul_f32 v145, v25, v145
    v_mul_f32 v146, v25, v146
    v_mul_f32 v147, v25, v147
    v_mul_f32 v148, v25, v148
    v_mul_f32 v149, v25, v149
    v_mul_f32 v150, v25, v150
    v_mul_f32 v151, v25, v151
    v_mul_f32 v152, v25, v152
    v_mul_f32 v153, v25, v153
    v_mul_f32 v154, v25, v154
    v_mul_f32 v155, v25, v155
    v_mul_f32 v156, v25, v156
    v_mul_f32 v157, v25, v157
    v_mul_f32 v158, v25, v158
    v_mul_f32 v159, v25, v159
    v_mul_f32 v160, v25, v160
    v_mul_f32 v161, v25, v161
    v_mul_f32 v162, v25, v162
    v_mul_f32 v163, v25, v163
    v_mul_f32 v164, v25, v164
    v_mul_f32 v165, v25, v165
    v_mul_f32 v166, v25, v166
    v_mul_f32 v167, v25, v167
    v_mul_f32 v168, v25, v168
    v_mul_f32 v169, v25, v169
    v_mul_f32 v170, v25, v170
    v_mul_f32 v171, v25, v171
    v_mul_f32 v172, v25, v172
    v_mul_f32 v173, v25, v173
    v_mul_f32 v174, v25, v174
    v_mul_f32 v175, v25, v175
    v_mul_f32 v176, v25, v176
    v_mul_f32 v177, v25, v177
    v_mul_f32 v178, v25, v178
    v_mul_f32 v179, v25, v179
    v_mul_f32 v180, v25, v180
    v_mul_f32 v181, v25, v181
    v_mul_f32 v182, v25, v182
    v_mul_f32 v183, v25, v183
    v_mul_f32 v184, v25, v184
    v_mul_f32 v185, v25, v185
    v_mul_f32 v186, v25, v186
    v_mul_f32 v187, v25, v187
    v_mul_f32 v188, v25, v188
    v_mul_f32 v189, v25, v189
    v_mul_f32 v190, v25, v190
    v_mul_f32 v191, v25, v191
    v_exp_f32 v210, v32
    v_exp_f32 v211, v33
    s_nop 0
    v_add_f32 v208, v210, v211
    v_cvt_pk_bf16_f32 v96, v210, v211
    v_exp_f32 v210, v34
    v_exp_f32 v211, v35
    v_add_f32 v208, v208, v210
    v_add_f32 v208, v208, v211
    v_cvt_pk_bf16_f32 v97, v210, v211
    v_exp_f32 v210, v36
    v_exp_f32 v211, v37
    v_add_f32 v208, v208, v210
    v_add_f32 v208, v208, v211
    v_cvt_pk_bf16_f32 v98, v210, v211
    v_exp_f32 v210, v38
    v_exp_f32 v211, v39
    v_add_f32 v208, v208, v210
    v_add_f32 v208, v208, v211
    v_cvt_pk_bf16_f32 v99, v210, v211
    v_exp_f32 v210, v40
    v_exp_f32 v211, v41
    v_add_f32 v208, v208, v210
    v_add_f32 v208, v208, v211
    v_cvt_pk_bf16_f32 v100, v210, v211
    v_exp_f32 v210, v42
    v_exp_f32 v211, v43
    v_add_f32 v208, v208, v210
    v_add_f32 v208, v208, v211
    v_cvt_pk_bf16_f32 v101, v210, v211
    v_exp_f32 v210, v44
    v_exp_f32 v211, v45
    v_add_f32 v208, v208, v210
    v_add_f32 v208, v208, v211
    v_cvt_pk_bf16_f32 v102, v210, v211
    v_exp_f32 v210, v46
    v_exp_f32 v211, v47
    v_add_f32 v208, v208, v210
    v_add_f32 v208, v208, v211
    v_cvt_pk_bf16_f32 v103, v210, v211
    v_exp_f32 v210, v48
    v_exp_f32 v211, v49
    v_add_f32 v208, v208, v210
    v_add_f32 v208, v208, v211
    v_cvt_pk_bf16_f32 v104, v210, v211
    v_exp_f32 v210, v50
    v_exp_f32 v211, v51
    v_add_f32 v208, v208, v210
    v_add_f32 v208, v208, v211
    v_cvt_pk_bf16_f32 v105, v210, v211
    v_exp_f32 v210, v52
    v_exp_f32 v211, v53
    v_add_f32 v208, v208, v210
    v_add_f32 v208, v208, v211
    v_cvt_pk_bf16_f32 v106, v210, v211
    v_exp_f32 v210, v54
    v_exp_f32 v211, v55
    v_add_f32 v208, v208, v210
    v_add_f32 v208, v208, v211
    v_cvt_pk_bf16_f32 v107, v210, v211
    v_exp_f32 v210, v56
    v_exp_f32 v211, v57
    v_add_f32 v208, v208, v210
    v_add_f32 v208, v208, v211
    v_cvt_pk_bf16_f32 v108, v210, v211
    v_exp_f32 v210, v58
    v_exp_f32 v211, v59
    v_add_f32 v208, v208, v210
    v_add_f32 v208, v208, v211
    v_cvt_pk_bf16_f32 v109, v210, v211
    v_exp_f32 v210, v60
    v_exp_f32 v211, v61
    v_add_f32 v208, v208, v210
    v_add_f32 v208, v208, v211
    v_cvt_pk_bf16_f32 v110, v210, v211
    v_exp_f32 v210, v62
    v_exp_f32 v211, v63
    v_add_f32 v208, v208, v210
    v_add_f32 v208, v208, v211
    v_cvt_pk_bf16_f32 v111, v210, v211
    s_branch L_rg4_back
L_rg5:
    v_max_f32 v26, v64, v65
    v_max3_f32 v26, v26, v66, v67
    v_max3_f32 v26, v26, v68, v69
    v_max3_f32 v26, v26, v70, v71
    v_max3_f32 v26, v26, v72, v73
    v_max3_f32 v26, v26, v74, v75
    v_max3_f32 v26, v26, v76, v77
    v_max3_f32 v26, v26, v78, v79
    v_max3_f32 v26, v26, v80, v81
    v_max3_f32 v26, v26, v82, v83
    v_max3_f32 v26, v26, v84, v85
    v_max3_f32 v26, v26, v86, v87
    v_max3_f32 v26, v26, v88, v89
    v_max3_f32 v26, v26, v90, v91
    v_max3_f32 v26, v26, v92, v93
    v_max3_f32 v26, v26, v94, v95
    v_mov_b32 v27, v26
    s_nop 1
    v_permlane32_swap_b32 v26, v27
    v_max3_f32 v27, v26, v27, 0
    v_sub_f32 v64, v64, v27
    v_sub_f32 v65, v65, v27
    v_sub_f32 v66, v66, v27
    v_sub_f32 v67, v67, v27
    v_sub_f32 v68, v68, v27
    v_sub_f32 v69, v69, v27
    v_sub_f32 v70, v70, v27
    v_sub_f32 v71, v71, v27
    v_sub_f32 v72, v72, v27
    v_sub_f32 v73, v73, v27
    v_sub_f32 v74, v74, v27
    v_sub_f32 v75, v75, v27
    v_sub_f32 v76, v76, v27
    v_sub_f32 v77, v77, v27
    v_sub_f32 v78, v78, v27
    v_sub_f32 v79, v79, v27
    v_sub_f32 v80, v80, v27
    v_sub_f32 v81, v81, v27
    v_sub_f32 v82, v82, v27
    v_sub_f32 v83, v83, v27
    v_sub_f32 v84, v84, v27
    v_sub_f32 v85, v85, v27
    v_sub_f32 v86, v86, v27
    v_sub_f32 v87, v87, v27
    v_sub_f32 v88, v88, v27
    v_sub_f32 v89, v89, v27
    v_sub_f32 v90, v90, v27
    v_sub_f32 v91, v91, v27
    v_sub_f32 v92, v92, v27
    v_sub_f32 v93, v93, v27
    v_sub_f32 v94, v94, v27
    v_sub_f32 v95, v95, v27
    v_sub_f32 v32, v32, v27
    v_sub_f32 v33, v33, v27
    v_sub_f32 v34, v34, v27
    v_sub_f32 v35, v35, v27
    v_sub_f32 v36, v36, v27
    v_sub_f32 v37, v37, v27
    v_sub_f32 v38, v38, v27
    v_sub_f32 v39, v39, v27
    v_sub_f32 v40, v40, v27
    v_sub_f32 v41, v41, v27
    v_sub_f32 v42, v42, v27
    v_sub_f32 v43, v43, v27
    v_sub_f32 v44, v44, v27
    v_sub_f32 v45, v45, v27
    v_sub_f32 v46, v46, v27
    v_sub_f32 v47, v47, v27
    v_sub_f32 v48, v48, v27
    v_sub_f32 v49, v49, v27
    v_sub_f32 v50, v50, v27
    v_sub_f32 v51, v51, v27
    v_sub_f32 v52, v52, v27
    v_sub_f32 v53, v53, v27
    v_sub_f32 v54, v54, v27
    v_sub_f32 v55, v55, v27
    v_sub_f32 v56, v56, v27
    v_sub_f32 v57, v57, v27
    v_sub_f32 v58, v58, v27
    v_sub_f32 v59, v59, v27
    v_sub_f32 v60, v60, v27
    v_sub_f32 v61, v61, v27
    v_sub_f32 v62, v62, v27
    v_sub_f32 v63, v63, v27
    v_sub_f32 v192, v192, v27
    v_sub_f32 v193, v193, v27
    v_sub_f32 v194, v194, v27
    v_sub_f32 v195, v195, v27
    v_sub_f32 v196, v196, v27
    v_sub_f32 v197, v197, v27
    v_sub_f32 v198, v198, v27
    v_sub_f32 v199, v199, v27
    v_sub_f32 v200, v200, v27
    v_sub_f32 v201, v201, v27
    v_sub_f32 v202, v202, v27
    v_sub_f32 v203, v203, v27
    v_sub_f32 v204, v204, v27
    v_sub_f32 v205, v205, v27
    v_sub_f32 v206, v206, v27
    v_sub_f32 v207, v207, v27
    v_sub_f32 v27, 0, v27
    v_exp_f32 v25, v27
    s_nop 0
    v_mul_f32 v24, v24, v25
    v_mul_f32 v128, v25, v128
    v_mul_f32 v129, v25, v129
    v_mul_f32 v130, v25, v130
    v_mul_f32 v131, v25, v131
    v_mul_f32 v132, v25, v132
    v_mul_f32 v133, v25, v133
    v_mul_f32 v134, v25, v134
    v_mul_f32 v135, v25, v135
    v_mul_f32 v136, v25, v136
    v_mul_f32 v137, v25, v137
    v_mul_f32 v138, v25, v138
    v_mul_f32 v139, v25, v139
    v_mul_f32 v140, v25, v140
    v_mul_f32 v141, v25, v141
    v_mul_f32 v142, v25, v142
    v_mul_f32 v143, v25, v143
    v_mul_f32 v144, v25, v144
    v_mul_f32 v145, v25, v145
    v_mul_f32 v146, v25, v146
    v_mul_f32 v147, v25, v147
    v_mul_f32 v148, v25, v148
    v_mul_f32 v149, v25, v149
    v_mul_f32 v150, v25, v150
    v_mul_f32 v151, v25, v151
    v_mul_f32 v152, v25, v152
    v_mul_f32 v153, v25, v153
    v_mul_f32 v154, v25, v154
    v_mul_f32 v155, v25, v155
    v_mul_f32 v156, v25, v156
    v_mul_f32 v157, v25, v157
    v_mul_f32 v158, v25, v158
    v_mul_f32 v159, v25, v159
    v_mul_f32 v160, v25, v160
    v_mul_f32 v161, v25, v161
    v_mul_f32 v162, v25, v162
    v_mul_f32 v163, v25, v163
    v_mul_f32 v164, v25, v164
    v_mul_f32 v165, v25, v165
    v_mul_f32 v166, v25, v166
    v_mul_f32 v167, v25, v167
    v_mul_f32 v168, v25, v168
    v_mul_f32 v169, v25, v169
    v_mul_f32 v170, v25, v170
    v_mul_f32 v171, v25, v171
    v_mul_f32 v172, v25, v172
    v_mul_f32 v173, v25, v173
    v_mul_f32 v174, v25, v174
    v_mul_f32 v175, v25, v175
    v_mul_f32 v176, v25, v176
    v_mul_f32 v177, v25, v177
    v_mul_f32 v178, v25, v178
    v_mul_f32 v179, v25, v179
    v_mul_f32 v180, v25, v180
    v_mul_f32 v181, v25, v181
    v_mul_f32 v182, v25, v182
    v_mul_f32 v183, v25, v183
    v_mul_f32 v184, v25, v184
    v_mul_f32 v185, v25, v185
    v_mul_f32 v186, v25, v186
    v_mul_f32 v187, v25, v187
    v_mul_f32 v188, v25, v188
    v_mul_f32 v189, v25, v189
    v_mul_f32 v190, v25, v190
    v_mul_f32 v191, v25, v191
    v_exp_f32 v210, v64
    v_exp_f32 v211, v65
    s_nop 0
    v_add_f32 v208, v210, v211
    v_cvt_pk_bf16_f32 v112, v210, v211
    v_exp_f32 v210, v66
    v_exp_f32 v211, v67
    v_add_f32 v208, v208, v210
    v_add_f32 v208, v208, v211
    v_cvt_pk_bf16_f32 v113, v210, v211
    v_exp_f32 v210, v68
    v_exp_f32 v211, v69
    v_add_f32 v208, v208, v210
    v_add_f32 v208, v208, v211
    v_cvt_pk_bf16_f32 v114, v210, v211
    v_exp_f32 v210, v70
    v_exp_f32 v211, v71
    v_add_f32 v208, v208, v210
    v_add_f32 v208, v208, v211
    v_cvt_pk_bf16_f32 v115, v210, v211
    v_exp_f32 v210, v72
    v_exp_f32 v211, v73
    v_add_f32 v208, v208, v210
    v_add_f32 v208, v208, v211
    v_cvt_pk_bf16_f32 v116, v210, v211
    v_exp_f32 v210, v74
    v_exp_f32 v211, v75
    v_add_f32 v208, v208, v210
    v_add_f32 v208, v208, v211
    v_cvt_pk_bf16_f32 v117, v210, v211
    v_exp_f32 v210, v76
    v_exp_f32 v211, v77
    v_add_f32 v208, v208, v210
    v_add_f32 v208, v208, v211
    v_cvt_pk_bf16_f32 v118, v210, v211
    v_exp_f32 v210, v78
    v_exp_f32 v211, v79
    v_add_f32 v208, v208, v210
    v_add_f32 v208, v208, v211
    v_cvt_pk_bf16_f32 v119, v210, v211
    v_exp_f32 v210, v80
    v_exp_f32 v211, v81
    v_add_f32 v208, v208, v210
    v_add_f32 v208, v208, v211
    v_cvt_pk_bf16_f32 v120, v210, v211
    v_exp_f32 v210, v82
    v_exp_f32 v211, v83
    v_add_f32 v208, v208, v210
    v_add_f32 v208, v208, v211
    v_cvt_pk_bf16_f32 v121, v210, v211
    v_exp_f32 v210, v84
    v_exp_f32 v211, v85
    v_add_f32 v208, v208, v210
    v_add_f32 v208, v208, v211
    v_cvt_pk_bf16_f32 v122, v210, v211
    v_exp_f32 v210, v86
    v_exp_f32 v211, v87
    v_add_f32 v208, v208, v210
    v_add_f32 v208, v208, v211
    v_cvt_pk_bf16_f32 v123, v210, v211
    v_exp_f32 v210, v88
    v_exp_f32 v211, v89
    v_add_f32 v208, v208, v210
    v_add_f32 v208, v208, v211
    v_cvt_pk_bf16_f32 v124, v210, v211
    v_exp_f32 v210, v90
    v_exp_f32 v211, v91
    v_add_f32 v208, v208, v210
    v_add_f32 v208, v208, v211
    v_cvt_pk_bf16_f32 v125, v210, v211
    v_exp_f32 v210, v92
    v_exp_f32 v211, v93
    v_add_f32 v208, v208, v210
    v_add_f32 v208, v208, v211
    v_cvt_pk_bf16_f32 v126, v210, v211
    v_exp_f32 v210, v94
    v_exp_f32 v211, v95
    v_add_f32 v208, v208, v210
    v_add_f32 v208, v208, v211
    v_cvt_pk_bf16_f32 v127, v210, v211
    s_branch L_rg5_back
L_rg6:
    v_max_f32 v26, v32, v33
    v_max3_f32 v26, v26, v34, v35
    v_max3_f32 v26, v26, v36, v37
    v_max3_f32 v26, v26, v38, v39
    v_max3_f32 v26, v26, v40, v41
    v_max3_f32 v26, v26, v42, v43
    v_max3_f32 v26, v26, v44, v45
    v_max3_f32 v26, v26, v46, v47
    v_max3_f32 v26, v26, v48, v49
    v_max3_f32 v26, v26, v50, v51
    v_max3_f32 v26, v26, v52, v53
    v_max3_f32 v26, v26, v54, v55
    v_max3_f32 v26, v26, v56, v57
    v_max3_f32 v26, v26, v58, v59
    v_max3_f32 v26, v26, v60, v61
    v_max3_f32 v26, v26, v62, v63
    v_mov_b32 v27, v26
    s_nop 1
    v_permlane32_swap_b32 v26, v27
    v_max3_f32 v27, v26, v27, 0
    v_sub_f32 v32, v32, v27
    v_sub_f32 v33, v33, v27
    v_sub_f32 v34, v34, v27
    v_sub_f32 v35, v35, v27
    v_sub_f32 v36, v36, v27
    v_sub_f32 v37, v37, v27
    v_sub_f32 v38, v38, v27
    v_sub_f32 v39, v39, v27
    v_sub_f32 v40, v40, v27
    v_sub_f32 v41, v41, v27
    v_sub_f32 v42, v42, v27
    v_sub_f32 v43, v43, v27
    v_sub_f32 v44, v44, v27
    v_sub_f32 v45, v45, v27
    v_sub_f32 v46, v46, v27
    v_sub_f32 v47, v47, v27
    v_sub_f32 v48, v48, v27
    v_sub_f32 v49, v49, v27
    v_sub_f32 v50, v50, v27
    v_sub_f32 v51, v51, v27
    v_sub_f32 v52, v52, v27
    v_sub_f32 v53, v53, v27
    v_sub_f32 v54, v54, v27
    v_sub_f32 v55, v55, v27
    v_sub_f32 v56, v56, v27
    v_sub_f32 v57, v57, v27
    v_sub_f32 v58, v58, v27
    v_sub_f32 v59, v59, v27
    v_sub_f32 v60, v60, v27
    v_sub_f32 v61, v61, v27
    v_sub_f32 v62, v62, v27
    v_sub_f32 v63, v63, v27
    v_sub_f32 v64, v64, v27
    v_sub_f32 v65, v65, v27
    v_sub_f32 v66, v66, v27
    v_sub_f32 v67, v67, v27
    v_sub_f32 v68, v68, v27
    v_sub_f32 v69, v69, v27
    v_sub_f32 v70, v70, v27
    v_sub_f32 v71, v71, v27
    v_sub_f32 v72, v72, v27
    v_sub_f32 v73, v73, v27
    v_sub_f32 v74, v74, v27
    v_sub_f32 v75, v75, v27
    v_sub_f32 v76, v76, v27
    v_sub_f32 v77, v77, v27
    v_sub_f32 v78, v78, v27
    v_sub_f32 v79, v79, v27
    v_sub_f32 v80, v80, v27
    v_sub_f32 v81, v81, v27
    v_sub_f32 v82, v82, v27
    v_sub_f32 v83, v83, v27
    v_sub_f32 v84, v84, v27
    v_sub_f32 v85, v85, v27
    v_sub_f32 v86, v86, v27
    v_sub_f32 v87, v87, v27
    v_sub_f32 v88, v88, v27
    v_sub_f32 v89, v89, v27
    v_sub_f32 v90, v90, v27
    v_sub_f32 v91, v91, v27
    v_sub_f32 v92, v92, v27
    v_sub_f32 v93, v93, v27
    v_sub_f32 v94, v94, v27
    v_sub_f32 v95, v95, v27
    v_sub_f32 v192, v192, v27
    v_sub_f32 v193, v193, v27
    v_sub_f32 v194, v194, v27
    v_sub_f32 v195, v195, v27
    v_sub_f32 v196, v196, v27
    v_sub_f32 v197, v197, v27
    v_sub_f32 v198, v198, v27
    v_sub_f32 v199, v199, v27
    v_sub_f32 v200, v200, v27
    v_sub_f32 v201, v201, v27
    v_sub_f32 v202, v202, v27
    v_sub_f32 v203, v203, v27
    v_sub_f32 v204, v204, v27
    v_sub_f32 v205, v205, v27
    v_sub_f32 v206, v206, v27
    v_sub_f32 v207, v207, v27
    v_sub_f32 v27, 0, v27
    v_exp_f32 v25, v27
    s_nop 0
    v_mul_f32 v24, v24, v25
    v_mul_f32 v128, v25, v128
    v_mul_f32 v129, v25, v129
    v_mul_f32 v130, v25, v130
    v_mul_f32 v131, v25, v131
    v_mul_f32 v132, v25, v132
    v_mul_f32 v133, v25, v133
    v_mul_f32 v134, v25, v134
    v_mul_f32 v135, v25, v135
    v_mul_f32 v136, v25, v136
    v_mul_f32 v137, v25, v137
    v_mul_f32 v138, v25, v138
    v_mul_f32 v139, v25, v139
    v_mul_f32 v140, v25, v140
    v_mul_f32 v141, v25, v141
    v_mul_f32 v142, v25, v142
    v_mul_f32 v143, v25, v143
    v_mul_f32 v144, v25, v144
    v_mul_f32 v145, v25, v145
    v_mul_f32 v146, v25, v146
    v_mul_f32 v147, v25, v147
    v_mul_f32 v148, v25, v148
    v_mul_f32 v149, v25, v149
    v_mul_f32 v150, v25, v150
    v_mul_f32 v151, v25, v151
    v_mul_f32 v152, v25, v152
    v_mul_f32 v153, v25, v153
    v_mul_f32 v154, v25, v154
    v_mul_f32 v155, v25, v155
    v_mul_f32 v156, v25, v156
    v_mul_f32 v157, v25, v157
    v_mul_f32 v158, v25, v158
    v_mul_f32 v159, v25, v159
    v_mul_f32 v160, v25, v160
    v_mul_f32 v161, v25, v161
    v_mul_f32 v162, v25, v162
    v_mul_f32 v163, v25, v163
    v_mul_f32 v164, v25, v164
    v_mul_f32 v165, v25, v165
    v_mul_f32 v166, v25, v166
    v_mul_f32 v167, v25, v167
    v_mul_f32 v168, v25, v168
    v_mul_f32 v169, v25, v169
    v_mul_f32 v170, v25, v170
    v_mul_f32 v171, v25, v171
    v_mul_f32 v172, v25, v172
    v_mul_f32 v173, v25, v173
    v_mul_f32 v174, v25, v174
    v_mul_f32 v175, v25, v175
    v_mul_f32 v176, v25, v176
    v_mul_f32 v177, v25, v177
    v_mul_f32 v178, v25, v178
    v_mul_f32 v179, v25, v179
    v_mul_f32 v180, v25, v180
    v_mul_f32 v181, v25, v181
    v_mul_f32 v182, v25, v182
    v_mul_f32 v183, v25, v183
    v_mul_f32 v184, v25, v184
    v_mul_f32 v185, v25, v185
    v_mul_f32 v186, v25, v186
    v_mul_f32 v187, v25, v187
    v_mul_f32 v188, v25, v188
    v_mul_f32 v189, v25, v189
    v_mul_f32 v190, v25, v190
    v_mul_f32 v191, v25, v191
    v_exp_f32 v210, v32
    v_exp_f32 v211, v33
    s_nop 0
    v_add_f32 v208, v210, v211
    v_cvt_pk_bf16_f32 v96, v210, v211
    v_exp_f32 v210, v34
    v_exp_f32 v211, v35
    v_add_f32 v208, v208, v210
    v_add_f32 v208, v208, v211
    v_cvt_pk_bf16_f32 v97, v210, v211
    v_exp_f32 v210, v36
    v_exp_f32 v211, v37
    v_add_f32 v208, v208, v210
    v_add_f32 v208, v208, v211
    v_cvt_pk_bf16_f32 v98, v210, v211
    v_exp_f32 v210, v38
    v_exp_f32 v211, v39
    v_add_f32 v208, v208, v210
    v_add_f32 v208, v208, v211
    v_cvt_pk_bf16_f32 v99, v210, v211
    v_exp_f32 v210, v40
    v_exp_f32 v211, v41
    v_add_f32 v208, v208, v210
    v_add_f32 v208, v208, v211
    v_cvt_pk_bf16_f32 v100, v210, v211
    v_exp_f32 v210, v42
    v_exp_f32 v211, v43
    v_add_f32 v208, v208, v210
    v_add_f32 v208, v208, v211
    v_cvt_pk_bf16_f32 v101, v210, v211
    v_exp_f32 v210, v44
    v_exp_f32 v211, v45
    v_add_f32 v208, v208, v210
    v_add_f32 v208, v208, v211
    v_cvt_pk_bf16_f32 v102, v210, v211
    v_exp_f32 v210, v46
    v_exp_f32 v211, v47
    v_add_f32 v208, v208, v210
    v_add_f32 v208, v208, v211
    v_cvt_pk_bf16_f32 v103, v210, v211
    v_exp_f32 v210, v48
    v_exp_f32 v211, v49
    v_add_f32 v208, v208, v210
    v_add_f32 v208, v208, v211
    v_cvt_pk_bf16_f32 v104, v210, v211
    v_exp_f32 v210, v50
    v_exp_f32 v211, v51
    v_add_f32 v208, v208, v210
    v_add_f32 v208, v208, v211
    v_cvt_pk_bf16_f32 v105, v210, v211
    v_exp_f32 v210, v52
    v_exp_f32 v211, v53
    v_add_f32 v208, v208, v210
    v_add_f32 v208, v208, v211
    v_cvt_pk_bf16_f32 v106, v210, v211
    v_exp_f32 v210, v54
    v_exp_f32 v211, v55
    v_add_f32 v208, v208, v210
    v_add_f32 v208, v208, v211
    v_cvt_pk_bf16_f32 v107, v210, v211
    v_exp_f32 v210, v56
    v_exp_f32 v211, v57
    v_add_f32 v208, v208, v210
    v_add_f32 v208, v208, v211
    v_cvt_pk_bf16_f32 v108, v210, v211
    v_exp_f32 v210, v58
    v_exp_f32 v211, v59
    v_add_f32 v208, v208, v210
    v_add_f32 v208, v208, v211
    v_cvt_pk_bf16_f32 v109, v210, v211
    v_exp_f32 v210, v60
    v_exp_f32 v211, v61
    v_add_f32 v208, v208, v210
    v_add_f32 v208, v208, v211
    v_cvt_pk_bf16_f32 v110, v210, v211
    v_exp_f32 v210, v62
    v_exp_f32 v211, v63
    v_add_f32 v208, v208, v210
    v_add_f32 v208, v208, v211
    v_cvt_pk_bf16_f32 v111, v210, v211
    s_branch L_rg6_back
L_rg7:
    v_max_f32 v26, v64, v65
    v_max3_f32 v26, v26, v66, v67
    v_max3_f32 v26, v26, v68, v69
    v_max3_f32 v26, v26, v70, v71
    v_max3_f32 v26, v26, v72, v73
    v_max3_f32 v26, v26, v74, v75
    v_max3_f32 v26, v26, v76, v77
    v_max3_f32 v26, v26, v78, v79
    v_max3_f32 v26, v26, v80, v81
    v_max3_f32 v26, v26, v82, v83
    v_max3_f32 v26, v26, v84, v85
    v_max3_f32 v26, v26, v86, v87
    v_max3_f32 v26, v26, v88, v89
    v_max3_f32 v26, v26, v90, v91
    v_max3_f32 v26, v26, v92, v93
    v_max3_f32 v26, v26, v94, v95
    v_mov_b32 v27, v26
    s_nop 1
    v_permlane32_swap_b32 v26, v27
    v_max3_f32 v27, v26, v27, 0
    v_sub_f32 v64, v64, v27
    v_sub_f32 v65, v65, v27
    v_sub_f32 v66, v66, v27
    v_sub_f32 v67, v67, v27
    v_sub_f32 v68, v68, v27
    v_sub_f32 v69, v69, v27
    v_sub_f32 v70, v70, v27
    v_sub_f32 v71, v71, v27
    v_sub_f32 v72, v72, v27
    v_sub_f32 v73, v73, v27
    v_sub_f32 v74, v74, v27
    v_sub_f32 v75, v75, v27
    v_sub_f32 v76, v76, v27
    v_sub_f32 v77, v77, v27
    v_sub_f32 v78, v78, v27
    v_sub_f32 v79, v79, v27
    v_sub_f32 v80, v80, v27
    v_sub_f32 v81, v81, v27
    v_sub_f32 v82, v82, v27
    v_sub_f32 v83, v83, v27
    v_sub_f32 v84, v84, v27
    v_sub_f32 v85, v85, v27
    v_sub_f32 v86, v86, v27
    v_sub_f32 v87, v87, v27
    v_sub_f32 v88, v88, v27
    v_sub_f32 v89, v89, v27
    v_sub_f32 v90, v90, v27
    v_sub_f32 v91, v91, v27
    v_sub_f32 v92, v92, v27
    v_sub_f32 v93, v93, v27
    v_sub_f32 v94, v94, v27
    v_sub_f32 v95, v95, v27
    v_sub_f32 v192, v192, v27
    v_sub_f32 v193, v193, v27
    v_sub_f32 v194, v194, v27
    v_sub_f32 v195, v195, v27
    v_sub_f32 v196, v196, v27
    v_sub_f32 v197, v197, v27
    v_sub_f32 v198, v198, v27
    v_sub_f32 v199, v199, v27
    v_sub_f32 v200, v200, v27
    v_sub_f32 v201, v201, v27
    v_sub_f32 v202, v202, v27
    v_sub_f32 v203, v203, v27
    v_sub_f32 v204, v204, v27
    v_sub_f32 v205, v205, v27
    v_sub_f32 v206, v206, v27
    v_sub_f32 v207, v207, v27
    v_sub_f32 v27, 0, v27
    v_exp_f32 v25, v27
    s_nop 0
    v_mul_f32 v24, v24, v25
    v_mul_f32 v128, v25, v128
    v_mul_f32 v129, v25, v129
    v_mul_f32 v130, v25, v130
    v_mul_f32 v131, v25, v131
    v_mul_f32 v132, v25, v132
    v_mul_f32 v133, v25, v133
    v_mul_f32 v134, v25, v134
    v_mul_f32 v135, v25, v135
    v_mul_f32 v136, v25, v136
    v_mul_f32 v137, v25, v137
    v_mul_f32 v138, v25, v138
    v_mul_f32 v139, v25, v139
    v_mul_f32 v140, v25, v140
    v_mul_f32 v141, v25, v141
    v_mul_f32 v142, v25, v142
    v_mul_f32 v143, v25, v143
    v_mul_f32 v144, v25, v144
    v_mul_f32 v145, v25, v145
    v_mul_f32 v146, v25, v146
    v_mul_f32 v147, v25, v147
    v_mul_f32 v148, v25, v148
    v_mul_f32 v149, v25, v149
    v_mul_f32 v150, v25, v150
    v_mul_f32 v151, v25, v151
    v_mul_f32 v152, v25, v152
    v_mul_f32 v153, v25, v153
    v_mul_f32 v154, v25, v154
    v_mul_f32 v155, v25, v155
    v_mul_f32 v156, v25, v156
    v_mul_f32 v157, v25, v157
    v_mul_f32 v158, v25, v158
    v_mul_f32 v159, v25, v159
    v_mul_f32 v160, v25, v160
    v_mul_f32 v161, v25, v161
    v_mul_f32 v162, v25, v162
    v_mul_f32 v163, v25, v163
    v_mul_f32 v164, v25, v164
    v_mul_f32 v165, v25, v165
    v_mul_f32 v166, v25, v166
    v_mul_f32 v167, v25, v167
    v_mul_f32 v168, v25, v168
    v_mul_f32 v169, v25, v169
    v_mul_f32 v170, v25, v170
    v_mul_f32 v171, v25, v171
    v_mul_f32 v172, v25, v172
    v_mul_f32 v173, v25, v173
    v_mul_f32 v174, v25, v174
    v_mul_f32 v175, v25, v175
    v_mul_f32 v176, v25, v176
    v_mul_f32 v177, v25, v177
    v_mul_f32 v178, v25, v178
    v_mul_f32 v179, v25, v179
    v_mul_f32 v180, v25, v180
    v_mul_f32 v181, v25, v181
    v_mul_f32 v182, v25, v182
    v_mul_f32 v183, v25, v183
    v_mul_f32 v184, v25, v184
    v_mul_f32 v185, v25, v185
    v_mul_f32 v186, v25, v186
    v_mul_f32 v187, v25, v187
    v_mul_f32 v188, v25, v188
    v_mul_f32 v189, v25, v189
    v_mul_f32 v190, v25, v190
    v_mul_f32 v191, v25, v191
    v_exp_f32 v210, v64
    v_exp_f32 v211, v65
    s_nop 0
    v_add_f32 v208, v210, v211
    v_cvt_pk_bf16_f32 v112, v210, v211
    v_exp_f32 v210, v66
    v_exp_f32 v211, v67
    v_add_f32 v208, v208, v210
    v_add_f32 v208, v208, v211
    v_cvt_pk_bf16_f32 v113, v210, v211
    v_exp_f32 v210, v68
    v_exp_f32 v211, v69
    v_add_f32 v208, v208, v210
    v_add_f32 v208, v208, v211
    v_cvt_pk_bf16_f32 v114, v210, v211
    v_exp_f32 v210, v70
    v_exp_f32 v211, v71
    v_add_f32 v208, v208, v210
    v_add_f32 v208, v208, v211
    v_cvt_pk_bf16_f32 v115, v210, v211
    v_exp_f32 v210, v72
    v_exp_f32 v211, v73
    v_add_f32 v208, v208, v210
    v_add_f32 v208, v208, v211
    v_cvt_pk_bf16_f32 v116, v210, v211
    v_exp_f32 v210, v74
    v_exp_f32 v211, v75
    v_add_f32 v208, v208, v210
    v_add_f32 v208, v208, v211
    v_cvt_pk_bf16_f32 v117, v210, v211
    v_exp_f32 v210, v76
    v_exp_f32 v211, v77
    v_add_f32 v208, v208, v210
    v_add_f32 v208, v208, v211
    v_cvt_pk_bf16_f32 v118, v210, v211
    v_exp_f32 v210, v78
    v_exp_f32 v211, v79
    v_add_f32 v208, v208, v210
    v_add_f32 v208, v208, v211
    v_cvt_pk_bf16_f32 v119, v210, v211
    v_exp_f32 v210, v80
    v_exp_f32 v211, v81
    v_add_f32 v208, v208, v210
    v_add_f32 v208, v208, v211
    v_cvt_pk_bf16_f32 v120, v210, v211
    v_exp_f32 v210, v82
    v_exp_f32 v211, v83
    v_add_f32 v208, v208, v210
    v_add_f32 v208, v208, v211
    v_cvt_pk_bf16_f32 v121, v210, v211
    v_exp_f32 v210, v84
    v_exp_f32 v211, v85
    v_add_f32 v208, v208, v210
    v_add_f32 v208, v208, v211
    v_cvt_pk_bf16_f32 v122, v210, v211
    v_exp_f32 v210, v86
    v_exp_f32 v211, v87
    v_add_f32 v208, v208, v210
    v_add_f32 v208, v208, v211
    v_cvt_pk_bf16_f32 v123, v210, v211
    v_exp_f32 v210, v88
    v_exp_f32 v211, v89
    v_add_f32 v208, v208, v210
    v_add_f32 v208, v208, v211
    v_cvt_pk_bf16_f32 v124, v210, v211
    v_exp_f32 v210, v90
    v_exp_f32 v211, v91
    v_add_f32 v208, v208, v210
    v_add_f32 v208, v208, v211
    v_cvt_pk_bf16_f32 v125, v210, v211
    v_exp_f32 v210, v92
    v_exp_f32 v211, v93
    v_add_f32 v208, v208, v210
    v_add_f32 v208, v208, v211
    v_cvt_pk_bf16_f32 v126, v210, v211
    v_exp_f32 v210, v94
    v_exp_f32 v211, v95
    v_add_f32 v208, v208, v210
    v_add_f32 v208, v208, v211
    v_cvt_pk_bf16_f32 v127, v210, v211
    s_branch L_rg7_back
L_code_end:
.section .rodata,"a"
.p2align 6
.amdhsa_kernel standalone__sliding_block_cached__sampling_kernel
  .amdhsa_next_free_vgpr 512
  .amdhsa_next_free_sgpr 100
  .amdhsa_accum_offset 256
  .amdhsa_group_segment_fixed_size 0
  .amdhsa_kernarg_size 64
  .amdhsa_user_sgpr_count 2
  .amdhsa_user_sgpr_kernarg_segment_ptr 1
  .amdhsa_system_sgpr_workgroup_id_x 1
.end_amdhsa_kernel
```
